```python
import torch

def _softmax(x, axis=-1):
    return torch.softmax(x, dim=axis)
def _gelu(x):
    return torch.nn.functional.gelu(x, approximate="tanh")
def _silu(x):
    return torch.nn.functional.silu(x)
def _sigmoid(x):
    return torch.sigmoid(x)
def _layernorm(x, axis=-1, eps=1e-5):
    m = x.mean(dim=axis, keepdim=True)
    v = x.var(dim=axis, keepdim=True, unbiased=False)
    return (x - m) / torch.sqrt(v + eps)
def _scatter_add(tgt, idx, src, axis=0):
    return tgt.clone().index_add_(axis, idx, src)
def _segment_sum(src, seg, n):
    out = torch.zeros((n,) + src.shape[1:], dtype=src.dtype)
    return out.index_add_(0, seg, src)
def _pad(x, pw):
    flat = tuple(v for pair in reversed(pw) for v in pair)
    return torch.nn.functional.pad(x, flat)

kernel_name = 'interleave_layers__sliding_local_dilated__mixer_channel_mlp__prompt'

def setup_inputs():

    _w = (lambda a: (lambda t: t.to(torch.bfloat16) if t.is_floating_point() else t)(torch.as_tensor(a)))
    def _A_setup():
        B, S, D = 1, 2048, 448
        return {
            "x": _w((lambda *s: torch.randn(*s, dtype=torch.bfloat16) * 0.05)(B, S, D)),
            "wqkv": _w((lambda *s: torch.randn(*s, dtype=torch.bfloat16) * 0.05)(D, 3 * D)),
            "wo": _w((lambda *s: torch.randn(*s, dtype=torch.bfloat16) * 0.05)(D, D)),
        }
    _A_in = _A_setup()

    def _B_setup():
        B, S, D, F = 1, 2048, 448, 1792
        return {
            "x": _w((lambda *s: torch.randn(*s, dtype=torch.bfloat16) * 0.05)(B, S, D)),
            "w1": _w((lambda *s: torch.randn(*s, dtype=torch.bfloat16) * 1.6)(D, F) * (D ** -0.5)),
            "b1": _w((lambda *s: torch.randn(*s, dtype=torch.bfloat16) * 0.8)(F)),
            "w2": _w((lambda *s: torch.randn(*s, dtype=torch.bfloat16) * 0.2)(F, D) * (F ** -0.5)),
            "b2": _w((lambda *s: torch.randn(*s, dtype=torch.bfloat16) * 0.2)(D)),
        }
    _B_in = _B_setup()

    return {
        "A_x": _A_in["x"],
        "A_wqkv": _A_in["wqkv"],
        "A_wo": _A_in["wo"],
        "B_x": _B_in["x"],
        "B_w1": _B_in["w1"],
        "B_b1": _B_in["b1"],
        "B_w2": _B_in["w2"],
        "B_b2": _B_in["b2"],
    }

def reference(A_x, A_wqkv, A_wo, B_x, B_w1, B_b1, B_w2, B_b2):
    def _A_ref(x, wqkv, wo):
        B, S, D = x.shape
        H = 16; Dh = D // H
        W, dil = 8, 2
        qkv = (lambda x, *d: x.permute(*d))((x @ wqkv).reshape(B, S, 3, H, Dh), 2, 0, 3, 1, 4)
        q, k, v = qkv[0], qkv[1], qkv[2]
        scale = Dh ** -0.5
        pos = torch.arange(S)
        off = torch.arange(W) * dil
        idx = pos[:, None] - off[None, :]
        mask = idx >= 0
        idx_c = torch.where(mask, idx, 0).reshape(-1)
        kg = k[:, :, idx_c, :].reshape(B, H, S, W, Dh)
        vg = v[:, :, idx_c, :].reshape(B, H, S, W, Dh)
        logits = torch.einsum("bhsd,bhswd->bhsw", q, kg) * scale
        logits = torch.where(mask[None, None, :, :], logits, -1e9)
        attn = _softmax(logits, axis=-1)
        o = torch.einsum("bhsw,bhswd->bhsd", attn, vg)
        return (lambda x, *d: x.permute(*d))(o, 0, 2, 1, 3).reshape(B, S, D) @ wo

    def _B_ref(x, w1, b1, w2, b2):
        y = _layernorm(x, axis=-1)
        h = _gelu(torch.einsum("bsd,df->bsf", y, w1) + b1)
        return torch.einsum("bsf,fd->bsd", h, w2) + b2

    x = A_x
    x = x + _A_ref(_layernorm(x, axis=-1), A_wqkv, A_wo)
    x = x + _B_ref(_layernorm(x, axis=-1), B_w1, B_b1, B_w2, B_b2)
    x = x + _A_ref(_layernorm(x, axis=-1), A_wqkv, A_wo)
    x = x + _B_ref(_layernorm(x, axis=-1), B_w1, B_b1, B_w2, B_b2)
    return x
```

```asm
; @launch grid=(256,1,1) block=(256,1,1) lds=163840
.amdgcn_target "amdgcn-amd-amdhsa--gfx950"
.text
.globl interleave_layers__sliding_local_dilated__mixer_channel_mlp__prompt_kernel
.p2align 8
.type interleave_layers__sliding_local_dilated__mixer_channel_mlp__prompt_kernel,@function
interleave_layers__sliding_local_dilated__mixer_channel_mlp__prompt_kernel:
    s_cmp_ge_u32 s2, 256
    s_cbranch_scc1 L_end
    s_load_dwordx16 s[72:87], s[0:1], 0
    s_load_dwordx4 s[88:91], s[0:1], 64
    s_load_dwordx2 s[92:93], s[0:1], 80
    v_and_b32 v57, 63, v0
    v_lshrrev_b32 v1, 6, v0
    s_and_b32 s40, s2, 7
    s_lshl_b32 s40, s40, 1
    s_lshr_b32 s94, s2, 7
    s_or_b32 s40, s40, s94
    s_lshr_b32 s41, s2, 3
    s_and_b32 s41, s41, 15
    v_readfirstlane_b32 s42, v1
    v_lshlrev_b32 v2, 4, v57
    v_lshlrev_b32 v3, 2, v57
    s_cmp_ge_u32 s41, 7
    s_cselect_b32 s46, 1, 0
    s_mul_i32 s47, s46, 7
    s_sub_u32 s47, s41, s47
    s_cmp_lt_u32 s41, 14
    s_cselect_b32 s66, 1, 0
    s_lshl_b32 s71, s47, 1
    s_and_b32 s48, s42, 1
    s_lshr_b32 s49, s42, 1
    s_mov_b32 s45, 0
    s_mov_b32 s44, 0
    s_lshl_b32 s70, s40, 9
    s_add_u32 s70, s70, 14155776
    s_mov_b32 s98, 0xffff
    s_mov_b32 s99, 0
    s_getpc_b64 s[36:37]
L_pc0:
    s_mov_b32 s38, L_end-L_pc0
    s_mov_b32 s39, 0x20000
    s_lshr_b32 s95, s2, 3
    s_lshl_b32 s95, s95, 2
    s_add_u32 s95, s95, s42
    s_mul_i32 s95, s95, 5
    v_min_u32 v243, 4, v57
    v_add_u32 v243, s95, v243
    v_lshlrev_b32 v243, 7, v243
    s_mov_b32 exec_lo, 0x1f
    s_mov_b32 exec_hi, 0x0
    buffer_load_dword a63, v243, s[36:39], 0 offen
    s_mov_b64 exec, -1
    s_lshr_b32 s95, s2, 3
    s_lshl_b32 s94, s95, 2
    s_nop 1
    v_readfirstlane_b32 s97, v1
    v_min_u32 v240, 20, v57
    v_lshlrev_b32 v240, 7, v240
    s_nop 1
    s_add_u32 s94, s94, s97
    s_mul_i32 s94, s94, 2688
    v_add_u32 v240, s94, v240
    s_and_b32 s94, s2, 7
    s_mul_i32 s94, s94, 256*7
    s_sub_u32 s94, s94, 16*7
    s_max_i32 s94, s94, 0
    s_lshl_b32 s95, s95, 2
    s_add_u32 s95, s95, s97
    s_mul_i32 s97, s95, 15
    s_add_u32 s94, s94, s97
    v_min_u32 v241, 14, v57
    v_add_u32 v241, s94, v241
    v_lshlrev_b32 v241, 7, v241
    s_mul_i32 s94, s95, 25
    v_min_u32 v242, 24, v57
    v_add_u32 v242, s94, v242
    v_lshlrev_b32 v242, 7, v242
    s_waitcnt lgkmcnt(0)
    s_mov_b32 s8, s74
    s_mov_b32 s9, s75
    s_mov_b32 s10, 1204224
    s_mov_b32 s11, 0x20000
    s_mov_b32 s4, s72
    s_mov_b32 s5, s73
    s_mov_b32 s6, 1835008
    s_mov_b32 s7, 0x20000
    s_mov_b32 exec_lo, 0x1fffff
    s_mov_b32 exec_hi, 0x0
    buffer_load_dword a64, v240, s[8:11], 0 offen
    s_mov_b64 exec, -1
    s_mov_b32 exec_lo, 0x7fff
    s_mov_b32 exec_hi, 0x0
    buffer_load_dword a65, v241, s[4:7], 0 offen
    s_mov_b64 exec, -1
    s_mov_b32 s12, s76
    s_mov_b32 s13, s77
    s_mov_b32 s14, 401408
    s_mov_b32 s15, 0x20000
    s_mov_b32 s16, s80
    s_mov_b32 s17, s81
    s_mov_b32 s18, 1605632
    s_mov_b32 s19, 0x20000
    s_mov_b32 s20, s84
    s_mov_b32 s21, s85
    s_mov_b32 s22, 1605632
    s_mov_b32 s23, 0x20000
    s_mov_b32 s24, s92
    s_mov_b32 s25, s93
    s_mov_b32 s26, 268435456
    s_mov_b32 s27, 0x20000
    s_mov_b32 s28, s88
    s_mov_b32 s29, s89
    s_mov_b32 s30, 1835008
    s_mov_b32 s31, 0x20000
    s_mov_b32 s32, s90
    s_mov_b32 s33, s91
    s_mov_b32 s34, 256
    s_mov_b32 s35, 0x20000
    s_mov_b32 s36, s82
    s_mov_b32 s37, s83
    s_mov_b32 s38, 3584
    s_mov_b32 s39, 0x20000
    v_lshlrev_b32 v243, 20, v57
    s_mov_b32 exec_lo, 0x7fff
    s_mov_b32 exec_hi, 0x0
    buffer_load_dword a66, v243, s[24:27], 0 offen
    s_mov_b64 exec, -1
    v_mov_b32 v243, 0
    s_mov_b32 exec_lo, 0x1
    s_mov_b32 exec_hi, 0x0
    buffer_load_dword a67, v243, s[16:19], 0 offen
    s_mov_b64 exec, -1
    s_mov_b32 exec_lo, 0x1
    s_mov_b32 exec_hi, 0x0
    buffer_load_dword a68, v243, s[20:23], 0 offen
    s_mov_b64 exec, -1
    s_mov_b32 exec_lo, 0x1
    s_mov_b32 exec_hi, 0x0
    buffer_load_dword a69, v243, s[12:15], 0 offen
    s_mov_b64 exec, -1
    s_mov_b32 exec_lo, 0x1
    s_mov_b32 exec_hi, 0x0
    buffer_load_dword a70, v243, s[28:31], 0 offen
    s_mov_b64 exec, -1
    s_mov_b32 s96, s86
    s_mov_b32 s97, s87
    s_lshl_b32 s93, s42, 10
    s_lshl_b32 s94, s41, 2
    s_add_u32 s94, s94, s42
    s_lshl_b32 s94, s94, 2
    s_add_u32 s94, s94, s70
    s_lshl_b32 s3, s40, 3
    s_lshl_b32 s72, s42, 1
    s_add_u32 s3, s3, s72
    s_lshl_b32 s0, s40, 3
    s_lshl_b32 s72, s46, 2
    s_add_u32 s0, s0, s72
    s_lshl_b32 s72, s48, 1
    s_add_u32 s0, s0, s72
    s_add_u32 s0, s0, s49
    s_mul_i32 s72, s41, 56
    s_lshl_b32 s73, s42, 6
    s_add_u32 s74, s73, 0
    v_add_u32 v64, s74, v57
    v_mul_u32_u24 v65, 683, v64
    v_lshrrev_b32 v65, 13, v65
    v_mul_u32_u24 v66, 12, v65
    v_sub_u32 v64, v64, v66
    v_and_b32 v66, 4, v65
    v_lshrrev_b32 v66, 1, v66
    v_sub_u32 v64, v64, v66
    v_add_u32 v64, 12, v64
    v_subrev_u32 v66, 12, v64
    v_min_u32 v64, v64, v66
    v_and_b32 v66, 12, v65
    v_lshlrev_b32 v66, 1, v66
    v_and_or_b32 v66, v65, 35, v66
    v_lshrrev_b32 v65, 2, v65
    v_and_or_b32 v65, v65, 4, v66
    v_mul_u32_u24 v65, 2688, v65
    v_lshrrev_b32 v66, 2, v64
    v_mul_u32_u24 v66, 896, v66
    v_add_u32 v65, v65, v66
    v_and_b32 v64, 3, v64
    v_lshlrev_b32 v64, 4, v64
    v_add3_u32 v4, v65, v64, s72
    s_add_u32 s74, s73, 256
    v_add_u32 v64, s74, v57
    v_mul_u32_u24 v65, 683, v64
    v_lshrrev_b32 v65, 13, v65
    v_mul_u32_u24 v66, 12, v65
    v_sub_u32 v64, v64, v66
    v_and_b32 v66, 4, v65
    v_lshrrev_b32 v66, 1, v66
    v_sub_u32 v64, v64, v66
    v_add_u32 v64, 12, v64
    v_subrev_u32 v66, 12, v64
    v_min_u32 v64, v64, v66
    v_and_b32 v66, 12, v65
    v_lshlrev_b32 v66, 1, v66
    v_and_or_b32 v66, v65, 35, v66
    v_lshrrev_b32 v65, 2, v65
    v_and_or_b32 v65, v65, 4, v66
    v_mul_u32_u24 v65, 2688, v65
    v_lshrrev_b32 v66, 2, v64
    v_mul_u32_u24 v66, 896, v66
    v_add_u32 v65, v65, v66
    v_and_b32 v64, 3, v64
    v_lshlrev_b32 v64, 4, v64
    v_add3_u32 v5, v65, v64, s72
    s_add_u32 s74, s73, 512
    v_add_u32 v64, s74, v57
    v_mul_u32_u24 v65, 683, v64
    v_lshrrev_b32 v65, 13, v65
    v_mul_u32_u24 v66, 12, v65
    v_sub_u32 v64, v64, v66
    v_and_b32 v66, 4, v65
    v_lshrrev_b32 v66, 1, v66
    v_sub_u32 v64, v64, v66
    v_add_u32 v64, 12, v64
    v_subrev_u32 v66, 12, v64
    v_min_u32 v64, v64, v66
    v_and_b32 v66, 12, v65
    v_lshlrev_b32 v66, 1, v66
    v_and_or_b32 v66, v65, 35, v66
    v_lshrrev_b32 v65, 2, v65
    v_and_or_b32 v65, v65, 4, v66
    v_mul_u32_u24 v65, 2688, v65
    v_lshrrev_b32 v66, 2, v64
    v_mul_u32_u24 v66, 896, v66
    v_add_u32 v65, v65, v66
    v_and_b32 v64, 3, v64
    v_lshlrev_b32 v64, 4, v64
    v_add3_u32 v6, v65, v64, s72
    s_mov_b32 s90, 0
    s_add_u32 m0, s93, 6144
    s_nop 0
    buffer_load_dwordx4 v4, s[8:11], s90 offen lds
    s_add_u32 m0, s93, 10240
    s_nop 0
    buffer_load_dwordx4 v5, s[8:11], s90 offen lds
    s_add_u32 m0, s93, 14336
    s_nop 0
    buffer_load_dwordx4 v6, s[8:11], s90 offen lds
    s_mov_b32 s90, 172032
    s_add_u32 m0, s93, 18432
    s_nop 0
    buffer_load_dwordx4 v4, s[8:11], s90 offen lds
    s_add_u32 m0, s93, 22528
    s_nop 0
    buffer_load_dwordx4 v5, s[8:11], s90 offen lds
    s_add_u32 m0, s93, 26624
    s_nop 0
    buffer_load_dwordx4 v6, s[8:11], s90 offen lds
    v_and_b32 v84, 15, v57
    v_lshrrev_b32 v85, 4, v57
    s_lshl_b32 s72, s3, 4
    v_lshrrev_b32 v87, 3, v57
    v_add_u32 v87, 0, v87
    v_bfe_u32 v88, v87, 1, 3
    v_xor_b32 v88, v88, v57
    v_and_b32 v88, 7, v88
    v_lshl_add_u32 v87, v87, 1, s72
    v_mul_u32_u24 v87, 896, v87
    v_lshl_add_u32 v112, v88, 4, v87
    v_lshrrev_b32 v87, 3, v57
    v_add_u32 v87, 8, v87
    v_bfe_u32 v88, v87, 1, 3
    v_xor_b32 v88, v88, v57
    v_and_b32 v88, 7, v88
    v_lshl_add_u32 v87, v87, 1, s72
    v_mul_u32_u24 v87, 896, v87
    v_lshl_add_u32 v113, v88, 4, v87
    s_mul_i32 s88, s42, 12288
    s_add_u32 s88, s88, 106496
    s_mov_b32 s90, 0
    s_add_u32 m0, s88, 0
    s_nop 0
    buffer_load_dwordx4 v112, s[4:7], s90 offen lds
    s_mov_b32 s90, 0
    s_add_u32 m0, s88, 1024
    s_nop 0
    buffer_load_dwordx4 v113, s[4:7], s90 offen lds
    s_mov_b32 s90, 896
    s_add_u32 m0, s88, 2048
    s_nop 0
    buffer_load_dwordx4 v112, s[4:7], s90 offen lds
    s_mov_b32 s90, 896
    s_add_u32 m0, s88, 3072
    s_nop 0
    buffer_load_dwordx4 v113, s[4:7], s90 offen lds
    s_mov_b32 s90, 128
    s_add_u32 m0, s88, 4096
    s_nop 0
    buffer_load_dwordx4 v112, s[4:7], s90 offen lds
    s_mov_b32 s90, 128
    s_add_u32 m0, s88, 5120
    s_nop 0
    buffer_load_dwordx4 v113, s[4:7], s90 offen lds
    s_mov_b32 s90, 1024
    s_add_u32 m0, s88, 6144
    s_nop 0
    buffer_load_dwordx4 v112, s[4:7], s90 offen lds
    s_mov_b32 s90, 1024
    s_add_u32 m0, s88, 7168
    s_nop 0
    buffer_load_dwordx4 v113, s[4:7], s90 offen lds
    v_bfe_u32 v87, v84, 1, 3
    v_add_u32 v88, 0, v85
    v_xor_b32 v87, v87, v88
    v_lshlrev_b32 v87, 4, v87
    v_lshl_add_u32 v87, v84, 7, v87
    v_add_u32 v114, s88, v87
    v_bfe_u32 v87, v84, 1, 3
    v_add_u32 v88, 4, v85
    v_xor_b32 v87, v87, v88
    v_lshlrev_b32 v87, 4, v87
    v_lshl_add_u32 v87, v84, 7, v87
    v_add_u32 v115, s88, v87
    v_mov_b32 v94, 0
    s_mov_b64 exec, 1
    buffer_store_dword v94, v94, s[24:27], s94 offen sc1
    s_lshl_b32 s72, s47, 1
    s_add_u32 s72, s72, s49
    s_lshl_b32 s72, s72, 2
    s_add_u32 s72, s72, s70
    s_add_u32 s72, s72, 256
    s_and_b32 s73, s46, s48
    s_cmp_eq_u32 s73, 0
    s_cbranch_scc1 L_nohz_1
    buffer_store_dword v94, v94, s[24:27], s72 offen sc1
L_nohz_1:
    s_mov_b64 exec, -1
    s_lshl_b32 s72, 1, s41
    s_sub_u32 s73, s72, 1
    s_and_b32 s73, s73, 0x55ab
    s_bcnt1_i32_b32 s73, s73
    s_lshr_b32 s74, s2, 7
    s_mul_i32 s74, s74, 9
    s_add_u32 s73, s73, s74
    s_lshl_b32 s73, s73, 2
    s_add_u32 s73, s73, s42
    s_mul_i32 s73, s73, 5376
    v_min_u32 v240, 41, v57
    v_lshlrev_b32 v240, 7, v240
    v_add_u32 v240, s73, v240
    s_and_b32 s72, s72, 0x55ab
    s_cmp_eq_u32 s72, 0
    s_cbranch_scc1 L_tbal_2
    s_mov_b32 exec_lo, 0xffffffff
    s_mov_b32 exec_hi, 0x3ff
    s_mov_b32 s90, 344064
    buffer_load_dword a71, v240, s[8:11], s90 offen
    s_mov_b64 exec, -1
    s_mov_b32 exec_lo, 0xffffffff
    s_mov_b32 exec_hi, 0x3ff
    s_mov_b32 s90, 688128
    buffer_load_dword a244, v240, s[8:11], s90 offen
    s_mov_b64 exec, -1
    s_mov_b32 exec_lo, 0xffffffff
    s_mov_b32 exec_hi, 0x3ff
    s_mov_b32 s90, 1032192
    buffer_load_dword a245, v240, s[8:11], s90 offen
    s_mov_b64 exec, -1
L_tbal_2:
    v_lshlrev_b32 v13, 1, v84
    v_cmp_gt_u32 vcc, 8, v84
    v_mov_b32 v86, 15
    s_nop 0
    v_cndmask_b32 v86, v86, 0, vcc
    v_sub_u32 v13, v13, v86
    s_lshl_b32 s72, s40, 7
    s_sub_u32 s72, s72, 16
    v_add_u32 v13, s72, v13
    v_mul_u32_u24 v13, 896, v13
    v_lshl_add_u32 v13, v85, 4, v13
    s_cmp_eq_u32 s40, 0
    s_cselect_b64 vcc, -1, 0
    v_mov_b32 v86, 0x7ff00000
    v_cndmask_b32 v13, v13, v86, vcc
    v_and_b32 v74, 15, v57
    v_lshrrev_b32 v75, 4, v57
    v_lshrrev_b32 v76, 2, v74
    v_and_b32 v77, 3, v74
    v_and_b32 v78, 1, v75
    v_lshrrev_b32 v79, 1, v75
    v_lshl_add_u32 v64, v75, 2, v76
    v_mul_u32_u24 v65, 192, v64
    v_and_b32 v66, 1, v77
    v_lshl_add_u32 v65, v66, 3, v65
    v_add_u32 v65, 6144, v65
    v_lshrrev_b32 v66, 1, v77
    v_lshl_add_u32 v67, v78, 1, v66
    v_lshl_add_u32 v28, v67, 4, v65
    v_add_u32 v29, 49152, v28
    v_add_u32 v67, 10, v66
    v_cmp_eq_u32 vcc, 1, v78
    s_nop 1
    v_cndmask_b32 v67, v67, v66, vcc
    v_lshl_add_u32 v30, v67, 4, v65
    v_add_u32 v31, 49152, v30
    s_add_u32 s72, s42, 2
    s_lshl_b32 s72, s72, 5
    v_add_u32 v32, s72, v28
    s_cmp_eq_u32 s42, 3
    s_cselect_b64 vcc, -1, 0
    v_cndmask_b32 v32, v32, v30, vcc
    v_add_u32 v33, 49152, v32
    s_and_b32 s72, s42, 1
    s_lshl_b32 s72, s72, 5
    v_add_u32 v34, s72, v28
    v_add_u32 v35, 49152, v34
    v_and_b32 v74, 15, v57
    v_lshrrev_b32 v75, 4, v57
    v_lshrrev_b32 v76, 2, v74
    v_and_b32 v77, 3, v74
    v_and_b32 v78, 1, v75
    v_lshrrev_b32 v79, 1, v75
    v_lshl_add_u32 v64, v75, 2, v76
    v_mul_u32_u24 v65, 224, v64
    v_lshl_add_u32 v65, v77, 3, v65
    v_add_u32 v38, 6144, v65
    v_add_u32 v39, 64512, v38
    s_lshl_b32 s72, s42, 6
    v_add_u32 v58, s72, v38
    v_add_u32 v59, 64512, v58
    v_lshlrev_b32 v65, 7, v64
    v_lshl_add_u32 v65, v77, 3, v65
    v_bfe_u32 v66, v64, 1, 2
    v_lshl_add_u32 v65, v66, 5, v65
    s_mul_i32 s72, s49, 28672
    s_add_u32 s72, s72, 106496
    s_mul_i32 s73, s49, 49152
    s_add_u32 s73, s73, 6144
    v_xor_b32 v66, 0, v65
    v_add_u32 v8, s72, v66
    v_add_u32 v21, s73, v66
    v_xor_b32 v66, 32, v65
    v_add_u32 v9, s72, v66
    v_add_u32 v22, s73, v66
    v_xor_b32 v66, 64, v65
    v_add_u32 v10, s72, v66
    v_add_u32 v23, s73, v66
    v_xor_b32 v66, 96, v65
    v_add_u32 v11, s72, v66
    v_add_u32 v24, s73, v66
    v_lshrrev_b32 v65, 3, v57
    s_lshl_b32 s72, s42, 3
    v_add_u32 v65, s72, v65
    v_bfe_u32 v66, v65, 1, 2
    v_lshlrev_b32 v66, 1, v66
    v_and_b32 v67, 7, v57
    v_xor_b32 v66, v66, v67
    v_mul_u32_u24 v65, 896, v65
    v_lshl_add_u32 v65, v66, 4, v65
    s_lshl_b32 s72, s47, 7
    v_add_u32 v7, s72, v65
    s_mul_i32 s73, s41, 224
    s_lshl_b32 s74, s42, 6
    s_add_u32 s75, s74, 0
    v_add_u32 v68, s75, v57
    v_mul_u32_u24 v69, 4682, v68
    v_lshrrev_b32 v69, 16, v69
    v_mul_u32_u24 v70, 14, v69
    v_sub_u32 v70, v68, v70
    v_lshlrev_b32 v70, 4, v70
    v_mul_u32_u24 v69, 3584, v69
    v_add3_u32 v14, v69, v70, s73
    s_add_u32 s75, s74, 256
    v_add_u32 v68, s75, v57
    v_mul_u32_u24 v69, 4682, v68
    v_lshrrev_b32 v69, 16, v69
    v_mul_u32_u24 v70, 14, v69
    v_sub_u32 v70, v68, v70
    v_lshlrev_b32 v70, 4, v70
    v_mul_u32_u24 v69, 3584, v69
    v_add3_u32 v15, v69, v70, s73
    s_add_u32 s75, s74, 512
    v_add_u32 v68, s75, v57
    v_mul_u32_u24 v69, 4682, v68
    v_lshrrev_b32 v69, 16, v69
    v_mul_u32_u24 v70, 14, v69
    v_sub_u32 v70, v68, v70
    v_lshlrev_b32 v70, 4, v70
    v_mul_u32_u24 v69, 3584, v69
    v_add3_u32 v16, v69, v70, s73
    s_add_u32 s75, s74, 768
    v_add_u32 v68, s75, v57
    v_mul_u32_u24 v69, 4682, v68
    v_lshrrev_b32 v69, 16, v69
    v_mul_u32_u24 v70, 14, v69
    v_sub_u32 v70, v68, v70
    v_lshlrev_b32 v70, 4, v70
    v_mul_u32_u24 v69, 3584, v69
    v_add3_u32 v17, v69, v70, s73
    s_add_u32 s75, s74, 1024
    v_add_u32 v68, s75, v57
    v_mul_u32_u24 v69, 4682, v68
    v_lshrrev_b32 v69, 16, v69
    v_mul_u32_u24 v70, 14, v69
    v_sub_u32 v70, v68, v70
    v_lshlrev_b32 v70, 4, v70
    v_mul_u32_u24 v69, 3584, v69
    v_add3_u32 v18, v69, v70, s73
    s_add_u32 s75, s74, 1280
    v_add_u32 v68, s75, v57
    v_mul_u32_u24 v69, 4682, v68
    v_lshrrev_b32 v69, 16, v69
    v_mul_u32_u24 v70, 14, v69
    v_sub_u32 v70, v68, v70
    v_lshlrev_b32 v70, 4, v70
    v_mul_u32_u24 v69, 3584, v69
    v_add3_u32 v19, v69, v70, s73
    s_add_u32 s75, s74, 1536
    v_add_u32 v68, s75, v57
    v_mul_u32_u24 v69, 4682, v68
    v_lshrrev_b32 v69, 16, v69
    v_mul_u32_u24 v70, 14, v69
    v_sub_u32 v70, v68, v70
    v_lshlrev_b32 v70, 4, v70
    v_mul_u32_u24 v69, 3584, v69
    v_add3_u32 v20, v69, v70, s73
    s_mul_i32 s72, s2, 49
    v_add_u32 v127, s72, v57
    v_lshlrev_b32 v127, 7, v127
    s_mul_i32 s72, s2, 13
    v_min_u32 v126, 12, v57
    v_add_u32 v126, s72, v126
    v_lshlrev_b32 v126, 7, v126
    v_lshlrev_b32 v64, 2, v75
    s_or_b32 s72, s40, s42
    v_add_u32 v65, 0, v64
    v_add_u32 v66, 9, v74
    v_cmp_ge_u32 s[50:51], v65, v66
    v_sub_u32 v66, v74, v65
    v_cmp_gt_u32 s[58:59], 8, v66
    v_add_u32 v65, 1, v64
    v_add_u32 v66, 9, v74
    v_cmp_ge_u32 s[52:53], v65, v66
    v_sub_u32 v66, v74, v65
    v_cmp_gt_u32 s[60:61], 8, v66
    v_add_u32 v65, 2, v64
    v_add_u32 v66, 9, v74
    v_cmp_ge_u32 s[54:55], v65, v66
    v_sub_u32 v66, v74, v65
    v_cmp_gt_u32 s[62:63], 8, v66
    v_add_u32 v65, 3, v64
    v_add_u32 v66, 9, v74
    v_cmp_ge_u32 s[56:57], v65, v66
    v_sub_u32 v66, v74, v65
    v_cmp_gt_u32 s[64:65], 8, v66
    s_cmp_eq_u32 s72, 0
    s_cselect_b64 s[100:101], 0, -1
    s_nop 1
    s_and_b64 s[50:51], s[50:51], s[100:101]
    s_or_b64 s[58:59], s[58:59], s[50:51]
    s_and_b64 s[52:53], s[52:53], s[100:101]
    s_or_b64 s[60:61], s[60:61], s[52:53]
    s_and_b64 s[54:55], s[54:55], s[100:101]
    s_or_b64 s[62:63], s[62:63], s[54:55]
    s_and_b64 s[56:57], s[56:57], s[100:101]
    s_or_b64 s[64:65], s[64:65], s[56:57]
    v_mov_b32 v65, 0xffff
    v_mov_b32 v66, 0xffff0000
    v_cndmask_b32 v40, 0, v65, s[50:51]
    v_cndmask_b32 v67, 0, v66, s[52:53]
    v_or_b32 v40, v40, v67
    v_not_b32 v42, v40
    v_cndmask_b32 v41, 0, v65, s[54:55]
    v_cndmask_b32 v67, 0, v66, s[56:57]
    v_or_b32 v41, v41, v67
    v_not_b32 v43, v41
    s_lshl_b32 s72, s42, 12
    s_add_u32 s72, s72, 94208
    v_add_u32 v44, s72, v2
    s_sub_u32 s72, s72, 4096
    v_add_u32 v45, s72, v2
    v_add_u32 v46, 1024, v45
    v_add_u32 v47, 2048, v45
    v_add_u32 v48, 3072, v45
    v_add_u32 v65, 8, v74
    v_and_b32 v65, 15, v65
    v_lshl_add_u32 v65, v75, 4, v65
    v_lshlrev_b32 v65, 4, v65
    v_add_u32 v65, 92160, v65
    v_add_u32 v66, 92160, v2
    v_xor_b32 v67, 32, v57
    v_lshlrev_b32 v67, 4, v67
    v_add_u32 v67, 93184, v67
    s_cmp_eq_u32 s42, 0
    s_cselect_b64 vcc, -1, 0
    v_cndmask_b32 v45, v45, v65, vcc
    v_cndmask_b32 v46, v46, v66, vcc
    v_cndmask_b32 v47, v47, v67, vcc
    v_add_u32 v66, 1024, v66
    v_cndmask_b32 v48, v48, v66, vcc
    s_lshl_b32 s72, s42, 12
    s_add_u32 s72, s72, 106496
    v_add_u32 v49, s72, v2
    s_xor_b32 s72, s42, 2
    s_lshl_b32 s72, s72, 12
    s_add_u32 s72, s72, 106496
    v_add_u32 v50, s72, v2
    s_lshr_b32 s72, s0, 1
    s_lshl_b32 s72, s72, 5
    s_add_u32 s72, s72, s49
    v_lshl_add_u32 v65, v74, 1, s72
    v_mul_u32_u24 v65, 896, v65
    v_lshl_add_u32 v51, v75, 3, v65
    v_lshlrev_b32 v65, 6, v74
    v_lshl_add_u32 v52, v75, 4, v65
    v_lshlrev_b32 v53, 4, v75
    s_lshl_b32 s72, s42, 9
    s_add_u32 s72, s72, 1536
    v_lshl_add_u32 v54, v74, 2, s72
    v_add_u32 v55, s72, v53
    s_lshl_b32 s72, s49, 3
    s_add_u32 s72, s72, 8
    v_add_u32 v65, s72, v74
    v_and_b32 v65, 15, v65
    v_lshl_add_u32 v65, v75, 4, v65
    v_lshlrev_b32 v56, 4, v65
    v_mov_b32 v62, 0xc0135761
    v_mov_b32 v63, 0xbdd2d3e8
    v_and_b32 v88, 7, v57
    v_lshlrev_b32 v88, 7, v88
    v_lshrrev_b32 v89, 3, v57
    s_lshl_b32 s72, s3, 4
    s_add_u32 s72, s72, s41
    s_lshl_b32 s72, s72, 10
    s_mul_i32 s73, s0, 14
    s_add_u32 s73, s73, s71
    s_lshl_b32 s73, s73, 10
    s_lshl_b32 s74, s0, 10
    v_mul_u32_u24 v90, 16384, v89
    v_add_u32 v0, s72, v90
    v_subrev_u32 v90, 2, v89
    v_lshlrev_b32 v90, 10, v90
    s_add_u32 s75, s73, 2097152
    v_add_u32 v90, s75, v90
    v_cmp_le_u32 vcc, 2, v89
    s_nop 1
    v_cndmask_b32 v0, v0, v90, vcc
    s_add_u32 s75, s74, 13631488
    v_mov_b32 v90, s75
    v_cmp_le_u32 vcc, 4, v89
    s_nop 1
    v_cndmask_b32 v0, v0, v90, vcc
    v_add_u32 v0, v0, v88
    v_and_b32 v90, 1, v57
    v_lshlrev_b32 v90, 7, v90
    v_add_u32 v90, s70, v90
    v_cmp_le_u32 vcc, 7, v89
    s_nop 1
    v_cndmask_b32 v0, v0, v90, vcc
    v_lshlrev_b32 v90, 10, v89
    s_add_u32 s75, s73, 2097152
    v_add_u32 v1, s75, v90
    s_add_u32 s75, s74, 13631488
    v_mov_b32 v90, s75
    v_cmp_le_u32 vcc, 2, v89
    s_nop 1
    v_cndmask_b32 v1, v1, v90, vcc
    v_add_u32 v1, v1, v88
    v_and_b32 v88, 7, v57
    v_lshlrev_b32 v88, 7, v88
    v_lshrrev_b32 v89, 3, v57
    s_mul_i32 s75, s41, 7
    s_lshr_b32 s75, s75, 1
    s_mul_i32 s76, s3, 56
    s_add_u32 s75, s75, s76
    s_lshl_b32 s75, s75, 10
    s_add_u32 s75, s75, 4194304
    v_lshrrev_b32 v90, 2, v89
    v_mul_u32_u24 v90, 56, v90
    v_and_b32 v89, 3, v89
    v_add_u32 v90, v90, v89
    v_lshlrev_b32 v90, 10, v90
    v_add3_u32 v12, v90, v88, s75
    v_mov_b32 v94, 0x3f803f80
    v_accvgpr_write_b32 a56, v94
    v_mov_b32 v94, 0x3f803f80
    v_accvgpr_write_b32 a57, v94
    v_mov_b32 v94, 0x3f803f80
    v_accvgpr_write_b32 a58, v94
    v_mov_b32 v94, 0x3f803f80
    v_accvgpr_write_b32 a59, v94
    s_mov_b32 s90, 344064
    s_add_u32 m0, s93, 30720
    s_nop 0
    buffer_load_dwordx4 v4, s[8:11], s90 offen lds
    s_add_u32 m0, s93, 34816
    s_nop 0
    buffer_load_dwordx4 v5, s[8:11], s90 offen lds
    s_add_u32 m0, s93, 38912
    s_nop 0
    buffer_load_dwordx4 v6, s[8:11], s90 offen lds
    s_mov_b32 s90, 516096
    s_add_u32 m0, s93, 43008
    s_nop 0
    buffer_load_dwordx4 v4, s[8:11], s90 offen lds
    s_add_u32 m0, s93, 47104
    s_nop 0
    buffer_load_dwordx4 v5, s[8:11], s90 offen lds
    s_add_u32 m0, s93, 51200
    s_nop 0
    buffer_load_dwordx4 v6, s[8:11], s90 offen lds
    s_mov_b32 s90, 256
    s_add_u32 m0, s88, 8192
    s_nop 0
    buffer_load_dwordx4 v112, s[4:7], s90 offen lds
    s_mov_b32 s90, 256
    s_add_u32 m0, s88, 9216
    s_nop 0
    buffer_load_dwordx4 v113, s[4:7], s90 offen lds
    s_mov_b32 s90, 1152
    s_add_u32 m0, s88, 10240
    s_nop 0
    buffer_load_dwordx4 v112, s[4:7], s90 offen lds
    s_mov_b32 s90, 1152
    s_add_u32 m0, s88, 11264
    s_nop 0
    buffer_load_dwordx4 v113, s[4:7], s90 offen lds
    s_mul_i32 s72, s41, 224
    v_lshlrev_b32 v95, 1, v57
    buffer_load_ushort a60, v95, s[36:39], s72 offen
    buffer_load_ushort a61, v95, s[36:39], s72 offen offset:128
    s_nop 4
    s_mov_b32 s36, s96
    s_mov_b32 s37, s97
    s_mov_b32 s38, 896
    s_mov_b32 s39, 0x20000
    s_lshl_b32 s72, s47, 7
    buffer_load_ushort a62, v95, s[36:39], s72 offen
    s_waitcnt vmcnt(14)
    s_barrier
    ds_read_b128 v[128:131], v114 offset:0
    ds_read_b128 v[184:187], v114 offset:2048
    ds_read_b128 v[132:135], v115 offset:0
    ds_read_b128 v[188:191], v115 offset:2048
    ds_read_b128 v[136:139], v114 offset:4096
    ds_read_b128 v[192:195], v114 offset:6144
    ds_read_b128 v[140:143], v115 offset:4096
    ds_read_b128 v[196:199], v115 offset:6144
    ds_read_b64_tr_b16 a[212:213], v28 offset:0
    ds_read_b64_tr_b16 a[214:215], v28 offset:3072
    ds_read_b64_tr_b16 a[216:217], v28 offset:32
    ds_read_b64_tr_b16 a[218:219], v28 offset:3104
    ds_read_b64_tr_b16 a[220:221], v28 offset:64
    ds_read_b64_tr_b16 a[222:223], v28 offset:3136
    ds_read_b64_tr_b16 a[224:225], v28 offset:96
    ds_read_b64_tr_b16 a[226:227], v28 offset:3168
    ds_read_b64_tr_b16 a[228:229], v28 offset:128
    ds_read_b64_tr_b16 a[230:231], v28 offset:3200
    ds_read_b64_tr_b16 a[232:233], v30 offset:0
    ds_read_b64_tr_b16 a[234:235], v30 offset:3072
    s_waitcnt lgkmcnt(8)
    v_mfma_f32_16x16x32_bf16 v[64:67], a[212:215], v[128:131], 0
    ds_read_b64_tr_b16 a[236:237], v28 offset:6144
    v_mfma_f32_16x16x32_bf16 v[72:75], a[212:215], v[184:187], 0
    ds_read_b64_tr_b16 a[238:239], v28 offset:9216
    ds_read_b64_tr_b16 a[156:157], v32 offset:0
    ds_read_b64_tr_b16 a[158:159], v32 offset:3072
    v_mfma_f32_16x16x32_bf16 v[240:243], a[56:59], v[128:131], 0
    s_waitcnt lgkmcnt(12)
    v_mfma_f32_16x16x32_bf16 v[68:71], a[216:219], v[128:131], 0
    ds_read_b64_tr_b16 a[240:241], v28 offset:6176
    v_mfma_f32_16x16x32_bf16 v[76:79], a[216:219], v[184:187], 0
    ds_read_b64_tr_b16 a[242:243], v28 offset:9248
    ds_read_b64_tr_b16 a[0:1], v34 offset:0
    ds_read_b64_tr_b16 a[2:3], v34 offset:3072
    v_mfma_f32_16x16x32_bf16 v[244:247], v[128:131], v[128:131], 0
    s_mov_b32 s90, 384
    s_add_u32 m0, s88, 0
    s_waitcnt lgkmcnt(8)
    buffer_load_dwordx4 v112, s[4:7], s90 offen lds
    v_mfma_f32_16x16x32_bf16 v[80:83], a[220:223], v[128:131], 0
    ds_read_b64_tr_b16 a[212:213], v28 offset:6208
    v_mfma_f32_16x16x32_bf16 v[88:91], a[220:223], v[184:187], 0
    ds_read_b64_tr_b16 a[214:215], v28 offset:9280
    v_mfma_f32_16x16x32_bf16 v[248:251], a[56:59], v[184:187], 0
    s_mov_b32 s90, 384
    s_add_u32 m0, s88, 1024
    v_mfma_f32_16x16x32_bf16 v[84:87], a[224:227], v[128:131], 0
    buffer_load_dwordx4 v113, s[4:7], s90 offen lds
    ds_read_b64_tr_b16 a[216:217], v28 offset:6240
    v_mfma_f32_16x16x32_bf16 v[92:95], a[224:227], v[184:187], 0
    ds_read_b64_tr_b16 a[218:219], v28 offset:9312
    v_mfma_f32_16x16x32_bf16 v[252:255], v[184:187], v[184:187], 0
    s_waitcnt lgkmcnt(8)
    v_mfma_f32_16x16x32_bf16 v[96:99], v[128:131], a[228:231], 0
    ds_read_b64_tr_b16 a[220:221], v28 offset:6272
    v_mfma_f32_16x16x32_bf16 v[104:107], v[184:187], a[228:231], 0
    ds_read_b64_tr_b16 a[222:223], v28 offset:9344
    s_mov_b32 s90, 1280
    s_add_u32 m0, s88, 2048
    v_mfma_f32_16x16x32_bf16 v[100:103], v[128:131], a[232:235], 0
    buffer_load_dwordx4 v112, s[4:7], s90 offen lds
    ds_read_b64_tr_b16 a[224:225], v30 offset:6144
    v_mfma_f32_16x16x32_bf16 v[108:111], v[184:187], a[232:235], 0
    ds_read_b64_tr_b16 a[226:227], v30 offset:9216
    s_mov_b32 s90, 1280
    s_add_u32 m0, s88, 3072
    s_waitcnt lgkmcnt(8)
    buffer_load_dwordx4 v113, s[4:7], s90 offen lds
    v_mfma_f32_16x16x32_bf16 v[64:67], a[236:239], v[132:135], v[64:67]
    ds_read_b64_tr_b16 a[228:229], v28 offset:12288
    v_mfma_f32_16x16x32_bf16 v[72:75], a[236:239], v[188:191], v[72:75]
    ds_read_b64_tr_b16 a[230:231], v28 offset:15360
    ds_read_b64_tr_b16 a[160:161], v32 offset:6144
    ds_read_b64_tr_b16 a[162:163], v32 offset:9216
    v_mfma_f32_16x16x32_bf16 v[240:243], a[56:59], v[132:135], v[240:243]
    v_mfma_f32_16x16x32_bf16 v[68:71], a[240:243], v[132:135], v[68:71]
    ds_read_b64_tr_b16 a[232:233], v28 offset:12320
    v_mfma_f32_16x16x32_bf16 v[76:79], a[240:243], v[188:191], v[76:79]
    ds_read_b64_tr_b16 a[234:235], v28 offset:15392
    ds_read_b64_tr_b16 a[4:5], v34 offset:6144
    ds_read_b64_tr_b16 a[6:7], v34 offset:9216
    v_mfma_f32_16x16x32_bf16 v[244:247], v[132:135], v[132:135], v[244:247]
    s_mov_b32 s90, 688128
    s_add_u32 m0, s93, 55296
    s_waitcnt lgkmcnt(8)
    buffer_load_dwordx4 v4, s[8:11], s90 offen lds
    v_mfma_f32_16x16x32_bf16 v[80:83], a[212:215], v[132:135], v[80:83]
    ds_read_b64_tr_b16 a[236:237], v28 offset:12352
    v_mfma_f32_16x16x32_bf16 v[88:91], a[212:215], v[188:191], v[88:91]
    ds_read_b64_tr_b16 a[238:239], v28 offset:15424
    v_mfma_f32_16x16x32_bf16 v[116:119], a[156:159], a[56:59], 0
    v_mfma_f32_16x16x32_bf16 v[248:251], a[56:59], v[188:191], v[248:251]
    v_mfma_f32_16x16x32_bf16 v[84:87], a[216:219], v[132:135], v[84:87]
    ds_read_b64_tr_b16 a[240:241], v28 offset:12384
    v_mfma_f32_16x16x32_bf16 v[92:95], a[216:219], v[188:191], v[92:95]
    ds_read_b64_tr_b16 a[242:243], v28 offset:15456
    v_mfma_f32_16x16x32_bf16 v[120:123], a[0:3], a[56:59], 0
    v_mfma_f32_16x16x32_bf16 v[252:255], v[188:191], v[188:191], v[252:255]
    s_add_u32 m0, s93, 59392
    s_waitcnt lgkmcnt(8)
    buffer_load_dwordx4 v5, s[8:11], s90 offen lds
    v_mfma_f32_16x16x32_bf16 v[96:99], v[132:135], a[220:223], v[96:99]
    ds_read_b64_tr_b16 a[212:213], v28 offset:12416
    v_mfma_f32_16x16x32_bf16 v[104:107], v[188:191], a[220:223], v[104:107]
    ds_read_b64_tr_b16 a[214:215], v28 offset:15488
    s_add_u32 m0, s93, 63488
    v_mfma_f32_16x16x32_bf16 v[100:103], v[132:135], a[224:227], v[100:103]
    buffer_load_dwordx4 v6, s[8:11], s90 offen lds
    ds_read_b64_tr_b16 a[216:217], v30 offset:12288
    v_mfma_f32_16x16x32_bf16 v[108:111], v[188:191], a[224:227], v[108:111]
    ds_read_b64_tr_b16 a[218:219], v30 offset:15360
    s_waitcnt lgkmcnt(8)
    v_mfma_f32_16x16x32_bf16 v[64:67], a[228:231], v[136:139], v[64:67]
    ds_read_b64_tr_b16 a[220:221], v28 offset:18432
    v_mfma_f32_16x16x32_bf16 v[72:75], a[228:231], v[192:195], v[72:75]
    ds_read_b64_tr_b16 a[222:223], v28 offset:21504
    ds_read_b64_tr_b16 a[164:165], v32 offset:12288
    ds_read_b64_tr_b16 a[166:167], v32 offset:15360
    v_mfma_f32_16x16x32_bf16 v[240:243], a[56:59], v[136:139], v[240:243]
    s_mov_b32 s90, 860160
    s_add_u32 m0, s93, 67584
    v_mfma_f32_16x16x32_bf16 v[68:71], a[232:235], v[136:139], v[68:71]
    buffer_load_dwordx4 v4, s[8:11], s90 offen lds
    ds_read_b64_tr_b16 a[224:225], v28 offset:18464
    v_mfma_f32_16x16x32_bf16 v[76:79], a[232:235], v[192:195], v[76:79]
    ds_read_b64_tr_b16 a[226:227], v28 offset:21536
    ds_read_b64_tr_b16 a[8:9], v34 offset:12288
    ds_read_b64_tr_b16 a[10:11], v34 offset:15360
    v_mfma_f32_16x16x32_bf16 v[244:247], v[136:139], v[136:139], v[244:247]
    s_waitcnt lgkmcnt(8)
    v_mfma_f32_16x16x32_bf16 v[80:83], a[236:239], v[136:139], v[80:83]
    ds_read_b64_tr_b16 a[228:229], v28 offset:18496
    v_mfma_f32_16x16x32_bf16 v[88:91], a[236:239], v[192:195], v[88:91]
    ds_read_b64_tr_b16 a[230:231], v28 offset:21568
    v_mfma_f32_16x16x32_bf16 v[116:119], a[160:163], a[56:59], v[116:119]
    v_mfma_f32_16x16x32_bf16 v[248:251], a[56:59], v[192:195], v[248:251]
    s_add_u32 m0, s93, 71680
    v_mfma_f32_16x16x32_bf16 v[84:87], a[240:243], v[136:139], v[84:87]
    buffer_load_dwordx4 v5, s[8:11], s90 offen lds
    ds_read_b64_tr_b16 a[232:233], v28 offset:18528
    v_mfma_f32_16x16x32_bf16 v[92:95], a[240:243], v[192:195], v[92:95]
    ds_read_b64_tr_b16 a[234:235], v28 offset:21600
    v_mfma_f32_16x16x32_bf16 v[120:123], a[4:7], a[56:59], v[120:123]
    v_mfma_f32_16x16x32_bf16 v[252:255], v[192:195], v[192:195], v[252:255]
    s_add_u32 m0, s93, 75776
    s_waitcnt lgkmcnt(8)
    buffer_load_dwordx4 v6, s[8:11], s90 offen lds
    v_mfma_f32_16x16x32_bf16 v[96:99], v[136:139], a[212:215], v[96:99]
    ds_read_b64_tr_b16 a[236:237], v28 offset:18560
    v_mfma_f32_16x16x32_bf16 v[104:107], v[192:195], a[212:215], v[104:107]
    ds_read_b64_tr_b16 a[238:239], v28 offset:21632
    v_mfma_f32_16x16x32_bf16 v[100:103], v[136:139], a[216:219], v[100:103]
    ds_read_b64_tr_b16 a[240:241], v30 offset:18432
    v_mfma_f32_16x16x32_bf16 v[108:111], v[192:195], a[216:219], v[108:111]
    ds_read_b64_tr_b16 a[242:243], v30 offset:21504
    s_mov_b32 s90, 512
    s_add_u32 m0, s88, 4096
    s_waitcnt lgkmcnt(8)
    buffer_load_dwordx4 v112, s[4:7], s90 offen lds
    v_mfma_f32_16x16x32_bf16 v[64:67], a[220:223], v[140:143], v[64:67]
    v_mfma_f32_16x16x32_bf16 v[72:75], a[220:223], v[196:199], v[72:75]
    ds_read_b64_tr_b16 a[168:169], v32 offset:18432
    ds_read_b64_tr_b16 a[170:171], v32 offset:21504
    v_mfma_f32_16x16x32_bf16 v[240:243], a[56:59], v[140:143], v[240:243]
    v_mfma_f32_16x16x32_bf16 v[68:71], a[224:227], v[140:143], v[68:71]
    v_mfma_f32_16x16x32_bf16 v[76:79], a[224:227], v[196:199], v[76:79]
    ds_read_b64_tr_b16 a[12:13], v34 offset:18432
    ds_read_b64_tr_b16 a[14:15], v34 offset:21504
    v_mfma_f32_16x16x32_bf16 v[244:247], v[140:143], v[140:143], v[244:247]
    s_mov_b32 s90, 512
    s_add_u32 m0, s88, 5120
    s_waitcnt lgkmcnt(4)
    buffer_load_dwordx4 v113, s[4:7], s90 offen lds
    v_mfma_f32_16x16x32_bf16 v[80:83], a[228:231], v[140:143], v[80:83]
    v_mfma_f32_16x16x32_bf16 v[88:91], a[228:231], v[196:199], v[88:91]
    v_mfma_f32_16x16x32_bf16 v[116:119], a[164:167], a[56:59], v[116:119]
    v_mfma_f32_16x16x32_bf16 v[248:251], a[56:59], v[196:199], v[248:251]
    s_mov_b32 s90, 1408
    s_add_u32 m0, s88, 6144
    v_mfma_f32_16x16x32_bf16 v[84:87], a[232:235], v[140:143], v[84:87]
    buffer_load_dwordx4 v112, s[4:7], s90 offen lds
    v_mfma_f32_16x16x32_bf16 v[92:95], a[232:235], v[196:199], v[92:95]
    v_mfma_f32_16x16x32_bf16 v[120:123], a[8:11], a[56:59], v[120:123]
    v_mfma_f32_16x16x32_bf16 v[252:255], v[196:199], v[196:199], v[252:255]
    s_waitcnt lgkmcnt(0)
    v_mfma_f32_16x16x32_bf16 v[96:99], v[140:143], a[236:239], v[96:99]
    v_mfma_f32_16x16x32_bf16 v[104:107], v[196:199], a[236:239], v[104:107]
    s_mov_b32 s90, 1408
    s_add_u32 m0, s88, 7168
    v_mfma_f32_16x16x32_bf16 v[100:103], v[140:143], a[240:243], v[100:103]
    buffer_load_dwordx4 v113, s[4:7], s90 offen lds
    v_mfma_f32_16x16x32_bf16 v[108:111], v[196:199], a[240:243], v[108:111]
    s_waitcnt vmcnt(10)
    s_barrier
    ds_read_b128 v[144:147], v114 offset:8192
    ds_read_b128 v[200:203], v114 offset:10240
    ds_read_b128 v[148:151], v115 offset:8192
    ds_read_b128 v[204:207], v115 offset:10240
    ds_read_b128 v[152:155], v114 offset:0
    ds_read_b128 v[208:211], v114 offset:2048
    ds_read_b128 v[156:159], v115 offset:0
    ds_read_b128 v[212:215], v115 offset:2048
    s_getreg_b32 s72, hwreg(HW_REG_XCC_ID)
    s_and_b32 s72, s72, 7
    s_and_b32 s73, s72, 3
    s_lshl_b32 s73, s73, 3
    s_lshl_b32 s73, 1, s73
    s_lshr_b32 s72, s72, 2
    s_lshl_b32 s74, s40, 1
    s_add_u32 s72, s72, s74
    s_lshl_b32 s72, s72, 2
    s_cmp_lg_u32 s42, 0
    s_cbranch_scc1 L_skip_3
    v_mov_b32 v36, s73
    v_mov_b32 v37, s72
    s_mov_b64 exec, 1
    buffer_atomic_add v36, v37, s[32:35], 0 offen sc1
    s_mov_b64 exec, -1
L_skip_3:
    ds_read_b64_tr_b16 a[212:213], v28 offset:24576
    ds_read_b64_tr_b16 a[214:215], v28 offset:27648
    ds_read_b64_tr_b16 a[216:217], v28 offset:24608
    ds_read_b64_tr_b16 a[218:219], v28 offset:27680
    ds_read_b64_tr_b16 a[220:221], v28 offset:24640
    ds_read_b64_tr_b16 a[222:223], v28 offset:27712
    ds_read_b64_tr_b16 a[224:225], v28 offset:24672
    ds_read_b64_tr_b16 a[226:227], v28 offset:27744
    ds_read_b64_tr_b16 a[228:229], v28 offset:24704
    ds_read_b64_tr_b16 a[230:231], v28 offset:27776
    ds_read_b64_tr_b16 a[232:233], v30 offset:24576
    ds_read_b64_tr_b16 a[234:235], v30 offset:27648
    s_waitcnt lgkmcnt(8)
    v_mfma_f32_16x16x32_bf16 v[64:67], a[212:215], v[144:147], v[64:67]
    ds_read_b64_tr_b16 a[236:237], v28 offset:30720
    v_mfma_f32_16x16x32_bf16 v[72:75], a[212:215], v[200:203], v[72:75]
    ds_read_b64_tr_b16 a[238:239], v28 offset:33792
    ds_read_b64_tr_b16 a[172:173], v32 offset:24576
    ds_read_b64_tr_b16 a[174:175], v32 offset:27648
    v_mfma_f32_16x16x32_bf16 v[240:243], a[56:59], v[144:147], v[240:243]
    s_waitcnt lgkmcnt(12)
    v_mfma_f32_16x16x32_bf16 v[68:71], a[216:219], v[144:147], v[68:71]
    ds_read_b64_tr_b16 a[240:241], v28 offset:30752
    v_mfma_f32_16x16x32_bf16 v[76:79], a[216:219], v[200:203], v[76:79]
    ds_read_b64_tr_b16 a[242:243], v28 offset:33824
    ds_read_b64_tr_b16 a[16:17], v34 offset:24576
    ds_read_b64_tr_b16 a[18:19], v34 offset:27648
    v_mfma_f32_16x16x32_bf16 v[244:247], v[144:147], v[144:147], v[244:247]
    s_mov_b32 s90, 640
    s_add_u32 m0, s88, 8192
    s_waitcnt lgkmcnt(8)
    buffer_load_dwordx4 v112, s[4:7], s90 offen lds
    v_mfma_f32_16x16x32_bf16 v[80:83], a[220:223], v[144:147], v[80:83]
    ds_read_b64_tr_b16 a[212:213], v28 offset:30784
    v_mfma_f32_16x16x32_bf16 v[88:91], a[220:223], v[200:203], v[88:91]
    ds_read_b64_tr_b16 a[214:215], v28 offset:33856
    v_mfma_f32_16x16x32_bf16 v[116:119], a[168:171], a[56:59], v[116:119]
    v_mfma_f32_16x16x32_bf16 v[248:251], a[56:59], v[200:203], v[248:251]
    s_mov_b32 s90, 640
    s_add_u32 m0, s88, 9216
    v_mfma_f32_16x16x32_bf16 v[84:87], a[224:227], v[144:147], v[84:87]
    buffer_load_dwordx4 v113, s[4:7], s90 offen lds
    ds_read_b64_tr_b16 a[216:217], v28 offset:30816
    v_mfma_f32_16x16x32_bf16 v[92:95], a[224:227], v[200:203], v[92:95]
    ds_read_b64_tr_b16 a[218:219], v28 offset:33888
    v_mfma_f32_16x16x32_bf16 v[120:123], a[12:15], a[56:59], v[120:123]
    v_mfma_f32_16x16x32_bf16 v[252:255], v[200:203], v[200:203], v[252:255]
    s_waitcnt lgkmcnt(8)
    v_mfma_f32_16x16x32_bf16 v[96:99], v[144:147], a[228:231], v[96:99]
    ds_read_b64_tr_b16 a[220:221], v28 offset:30848
    v_mfma_f32_16x16x32_bf16 v[104:107], v[200:203], a[228:231], v[104:107]
    ds_read_b64_tr_b16 a[222:223], v28 offset:33920
    s_mov_b32 s90, 1536
    s_add_u32 m0, s88, 10240
    v_mfma_f32_16x16x32_bf16 v[100:103], v[144:147], a[232:235], v[100:103]
    buffer_load_dwordx4 v112, s[4:7], s90 offen lds
    ds_read_b64_tr_b16 a[224:225], v30 offset:30720
    v_mfma_f32_16x16x32_bf16 v[108:111], v[200:203], a[232:235], v[108:111]
    ds_read_b64_tr_b16 a[226:227], v30 offset:33792
    s_mov_b32 s90, 1536
    s_add_u32 m0, s88, 11264
    s_waitcnt lgkmcnt(8)
    buffer_load_dwordx4 v113, s[4:7], s90 offen lds
    v_mfma_f32_16x16x32_bf16 v[64:67], a[236:239], v[148:151], v[64:67]
    ds_read_b64_tr_b16 a[228:229], v28 offset:36864
    v_mfma_f32_16x16x32_bf16 v[72:75], a[236:239], v[204:207], v[72:75]
    ds_read_b64_tr_b16 a[230:231], v28 offset:39936
    ds_read_b64_tr_b16 a[176:177], v32 offset:30720
    ds_read_b64_tr_b16 a[178:179], v32 offset:33792
    v_mfma_f32_16x16x32_bf16 v[240:243], a[56:59], v[148:151], v[240:243]
    v_mfma_f32_16x16x32_bf16 v[68:71], a[240:243], v[148:151], v[68:71]
    ds_read_b64_tr_b16 a[232:233], v28 offset:36896
    v_mfma_f32_16x16x32_bf16 v[76:79], a[240:243], v[204:207], v[76:79]
    ds_read_b64_tr_b16 a[234:235], v28 offset:39968
    ds_read_b64_tr_b16 a[20:21], v34 offset:30720
    ds_read_b64_tr_b16 a[22:23], v34 offset:33792
    v_mfma_f32_16x16x32_bf16 v[244:247], v[148:151], v[148:151], v[244:247]
    s_mov_b32 s90, 1032192
    s_add_u32 m0, s93, 79872
    s_waitcnt lgkmcnt(8)
    buffer_load_dwordx4 v4, s[8:11], s90 offen lds
    v_mfma_f32_16x16x32_bf16 v[80:83], a[212:215], v[148:151], v[80:83]
    ds_read_b64_tr_b16 a[236:237], v28 offset:36928
    v_mfma_f32_16x16x32_bf16 v[88:91], a[212:215], v[204:207], v[88:91]
    ds_read_b64_tr_b16 a[238:239], v28 offset:40000
    v_mfma_f32_16x16x32_bf16 v[116:119], a[172:175], a[56:59], v[116:119]
    v_mfma_f32_16x16x32_bf16 v[248:251], a[56:59], v[204:207], v[248:251]
    v_mfma_f32_16x16x32_bf16 v[84:87], a[216:219], v[148:151], v[84:87]
    ds_read_b64_tr_b16 a[240:241], v28 offset:36960
    v_mfma_f32_16x16x32_bf16 v[92:95], a[216:219], v[204:207], v[92:95]
    ds_read_b64_tr_b16 a[242:243], v28 offset:40032
    v_mfma_f32_16x16x32_bf16 v[120:123], a[16:19], a[56:59], v[120:123]
    v_mfma_f32_16x16x32_bf16 v[252:255], v[204:207], v[204:207], v[252:255]
    s_add_u32 m0, s93, 83968
    s_waitcnt lgkmcnt(8)
    buffer_load_dwordx4 v5, s[8:11], s90 offen lds
    v_mfma_f32_16x16x32_bf16 v[96:99], v[148:151], a[220:223], v[96:99]
    ds_read_b64_tr_b16 a[212:213], v28 offset:36992
    v_mfma_f32_16x16x32_bf16 v[104:107], v[204:207], a[220:223], v[104:107]
    ds_read_b64_tr_b16 a[214:215], v28 offset:40064
    s_add_u32 m0, s93, 88064
    v_mfma_f32_16x16x32_bf16 v[100:103], v[148:151], a[224:227], v[100:103]
    buffer_load_dwordx4 v6, s[8:11], s90 offen lds
    ds_read_b64_tr_b16 a[216:217], v30 offset:36864
    v_mfma_f32_16x16x32_bf16 v[108:111], v[204:207], a[224:227], v[108:111]
    ds_read_b64_tr_b16 a[218:219], v30 offset:39936
    s_waitcnt lgkmcnt(8)
    v_mfma_f32_16x16x32_bf16 v[64:67], a[228:231], v[152:155], v[64:67]
    ds_read_b64_tr_b16 a[220:221], v28 offset:43008
    v_mfma_f32_16x16x32_bf16 v[72:75], a[228:231], v[208:211], v[72:75]
    ds_read_b64_tr_b16 a[222:223], v28 offset:46080
    ds_read_b64_tr_b16 a[180:181], v32 offset:36864
    ds_read_b64_tr_b16 a[182:183], v32 offset:39936
    v_mfma_f32_16x16x32_bf16 v[240:243], a[56:59], v[152:155], v[240:243]
    s_mov_b32 s90, 768
    s_add_u32 m0, s88, 0
    v_mfma_f32_16x16x32_bf16 v[68:71], a[232:235], v[152:155], v[68:71]
    buffer_load_dwordx4 v112, s[4:7], s90 offen lds
    ds_read_b64_tr_b16 a[224:225], v28 offset:43040
    v_mfma_f32_16x16x32_bf16 v[76:79], a[232:235], v[208:211], v[76:79]
    ds_read_b64_tr_b16 a[226:227], v28 offset:46112
    ds_read_b64_tr_b16 a[24:25], v34 offset:36864
    ds_read_b64_tr_b16 a[26:27], v34 offset:39936
    v_mfma_f32_16x16x32_bf16 v[244:247], v[152:155], v[152:155], v[244:247]
    s_waitcnt lgkmcnt(8)
    v_mfma_f32_16x16x32_bf16 v[80:83], a[236:239], v[152:155], v[80:83]
    ds_read_b64_tr_b16 a[228:229], v28 offset:43072
    v_mfma_f32_16x16x32_bf16 v[88:91], a[236:239], v[208:211], v[88:91]
    ds_read_b64_tr_b16 a[230:231], v28 offset:46144
    v_mfma_f32_16x16x32_bf16 v[116:119], a[176:179], a[56:59], v[116:119]
    v_mfma_f32_16x16x32_bf16 v[248:251], a[56:59], v[208:211], v[248:251]
    s_mov_b32 s90, 768
    s_add_u32 m0, s88, 1024
    v_mfma_f32_16x16x32_bf16 v[84:87], a[240:243], v[152:155], v[84:87]
    buffer_load_dwordx4 v113, s[4:7], s90 offen lds
    ds_read_b64_tr_b16 a[232:233], v28 offset:43104
    v_mfma_f32_16x16x32_bf16 v[92:95], a[240:243], v[208:211], v[92:95]
    ds_read_b64_tr_b16 a[234:235], v28 offset:46176
    v_mfma_f32_16x16x32_bf16 v[120:123], a[20:23], a[56:59], v[120:123]
    v_mfma_f32_16x16x32_bf16 v[252:255], v[208:211], v[208:211], v[252:255]
    s_mov_b32 s90, 1664
    s_add_u32 m0, s88, 2048
    s_waitcnt lgkmcnt(8)
    buffer_load_dwordx4 v112, s[4:7], s90 offen lds
    v_mfma_f32_16x16x32_bf16 v[96:99], v[152:155], a[212:215], v[96:99]
    ds_read_b64_tr_b16 a[236:237], v28 offset:43136
    v_mfma_f32_16x16x32_bf16 v[104:107], v[208:211], a[212:215], v[104:107]
    ds_read_b64_tr_b16 a[238:239], v28 offset:46208
    v_mfma_f32_16x16x32_bf16 v[100:103], v[152:155], a[216:219], v[100:103]
    ds_read_b64_tr_b16 a[240:241], v30 offset:43008
    v_mfma_f32_16x16x32_bf16 v[108:111], v[208:211], a[216:219], v[108:111]
    ds_read_b64_tr_b16 a[242:243], v30 offset:46080
    s_mov_b32 s90, 1664
    s_add_u32 m0, s88, 3072
    s_waitcnt lgkmcnt(8)
    buffer_load_dwordx4 v113, s[4:7], s90 offen lds
    v_mfma_f32_16x16x32_bf16 v[64:67], a[220:223], v[156:159], v[64:67]
    v_mfma_f32_16x16x32_bf16 v[72:75], a[220:223], v[212:215], v[72:75]
    ds_read_b64_tr_b16 a[184:185], v32 offset:43008
    ds_read_b64_tr_b16 a[186:187], v32 offset:46080
    v_mfma_f32_16x16x32_bf16 v[240:243], a[56:59], v[156:159], v[240:243]
    v_mfma_f32_16x16x32_bf16 v[68:71], a[224:227], v[156:159], v[68:71]
    v_mfma_f32_16x16x32_bf16 v[76:79], a[224:227], v[212:215], v[76:79]
    ds_read_b64_tr_b16 a[28:29], v34 offset:43008
    ds_read_b64_tr_b16 a[30:31], v34 offset:46080
    v_mfma_f32_16x16x32_bf16 v[244:247], v[156:159], v[156:159], v[244:247]
    s_add_u32 s90, s42, 0
    s_lshl_b32 s91, s90, 6
    s_add_u32 m0, s93, 92160
    s_waitcnt lgkmcnt(4)
    buffer_load_dwordx4 v13, s[4:7], s91 offen lds
    v_mfma_f32_16x16x32_bf16 v[80:83], a[228:231], v[156:159], v[80:83]
    v_mfma_f32_16x16x32_bf16 v[88:91], a[228:231], v[212:215], v[88:91]
    v_mfma_f32_16x16x32_bf16 v[116:119], a[180:183], a[56:59], v[116:119]
    v_mfma_f32_16x16x32_bf16 v[248:251], a[56:59], v[212:215], v[248:251]
    s_add_u32 s90, s42, 4
    s_lshl_b32 s91, s90, 6
    s_add_u32 m0, s93, 96256
    v_mfma_f32_16x16x32_bf16 v[84:87], a[232:235], v[156:159], v[84:87]
    buffer_load_dwordx4 v13, s[4:7], s91 offen lds
    v_mfma_f32_16x16x32_bf16 v[92:95], a[232:235], v[212:215], v[92:95]
    v_mfma_f32_16x16x32_bf16 v[120:123], a[24:27], a[56:59], v[120:123]
    v_mfma_f32_16x16x32_bf16 v[252:255], v[212:215], v[212:215], v[252:255]
    s_waitcnt lgkmcnt(0)
    v_mfma_f32_16x16x32_bf16 v[96:99], v[156:159], a[236:239], v[96:99]
    v_mfma_f32_16x16x32_bf16 v[104:107], v[212:215], a[236:239], v[104:107]
    s_add_u32 s90, s42, 8
    s_lshl_b32 s91, s90, 6
    s_add_u32 m0, s93, 100352
    v_mfma_f32_16x16x32_bf16 v[100:103], v[156:159], a[240:243], v[100:103]
    buffer_load_dwordx4 v13, s[4:7], s91 offen lds
    v_mfma_f32_16x16x32_bf16 v[108:111], v[212:215], a[240:243], v[108:111]
    s_cmp_ge_u32 s42, 2
    s_cbranch_scc1 L_skip_4
    s_add_u32 s90, s42, 12
    s_lshl_b32 s91, s90, 6
    s_add_u32 m0, s93, 104448
    s_nop 0
    buffer_load_dwordx4 v13, s[4:7], s91 offen lds
L_skip_4:
    s_waitcnt vmcnt(10)
    s_barrier
    ds_read_b128 v[160:163], v114 offset:4096
    ds_read_b128 v[216:219], v114 offset:6144
    ds_read_b128 v[164:167], v115 offset:4096
    ds_read_b128 v[220:223], v115 offset:6144
    ds_read_b128 v[168:171], v114 offset:8192
    ds_read_b128 v[224:227], v114 offset:10240
    ds_read_b128 v[172:175], v115 offset:8192
    ds_read_b128 v[228:231], v115 offset:10240
    s_cmp_eq_u32 s42, 1
    s_cselect_b32 s75, -1, 0
    v_and_b32 v126, s75, v57
    v_min_u32 v126, 12, v126
    s_mul_i32 s75, s2, 13
    v_add_u32 v126, s75, v126
    v_lshlrev_b32 v126, 7, v126
    s_cmp_eq_u32 s42, 2
    s_cselect_b32 s75, -1, 0
    v_and_b32 v127, s75, v57
    v_min_u32 v127, 63, v127
    s_mul_i32 s75, s2, 49
    v_add_u32 v127, s75, v127
    v_lshlrev_b32 v127, 7, v127
    s_cmp_eq_u32 s42, 3
    s_cselect_b32 s75, -1, 0
    v_and_b32 v13, s75, v57
    v_min_u32 v13, 63, v13
    s_mul_i32 s75, s2, 49
    v_add_u32 v13, s75, v13
    v_lshlrev_b32 v13, 7, v13
    v_and_b32 v128, 15, v57
    v_lshrrev_b32 v129, 4, v57
    v_lshrrev_b32 v130, 2, v128
    v_and_b32 v131, 3, v128
    v_and_b32 v132, 1, v129
    v_lshl_add_u32 v130, v132, 4, v130
    v_lshrrev_b32 v129, 1, v129
    v_lshl_add_u32 v130, v129, 2, v130
    v_mul_u32_u24 v130, 192, v130
    v_and_b32 v132, 1, v131
    v_lshl_add_u32 v130, v132, 3, v130
    s_lshr_b32 s89, s42, 1
    s_mul_i32 s89, s89, 6144
    s_add_u32 s89, s89, 6144
    v_add_u32 v130, s89, v130
    v_lshrrev_b32 v131, 1, v131
    v_lshl_add_u32 v132, v129, 1, v131
    v_lshl_add_u32 v132, v132, 4, v130
    s_and_b32 s89, s42, 1
    s_mul_i32 s89, s89, 96
    v_add_u32 v124, s89, v132
    v_add_u32 v133, 10, v131
    v_cmp_eq_u32 vcc, 1, v129
    s_nop 1
    v_cndmask_b32 v133, v133, v131, vcc
    v_lshl_add_u32 v133, v133, 4, v130
    v_add_u32 v132, 64, v124
    s_bitcmp1_b32 s42, 0
    s_cselect_b64 vcc, -1, 0
    v_cndmask_b32 v125, v132, v133, vcc
    v_add_u32 v36, 61440, v124
    v_add_u32 v37, 61440, v125
    ds_read_b64_tr_b16 a[212:213], v29 offset:0
    ds_read_b64_tr_b16 a[214:215], v29 offset:3072
    ds_read_b64_tr_b16 a[216:217], v29 offset:32
    ds_read_b64_tr_b16 a[218:219], v29 offset:3104
    ds_read_b64_tr_b16 a[220:221], v29 offset:64
    ds_read_b64_tr_b16 a[222:223], v29 offset:3136
    ds_read_b64_tr_b16 a[224:225], v29 offset:96
    ds_read_b64_tr_b16 a[226:227], v29 offset:3168
    ds_read_b64_tr_b16 a[228:229], v29 offset:128
    ds_read_b64_tr_b16 a[230:231], v29 offset:3200
    ds_read_b64_tr_b16 a[232:233], v31 offset:0
    ds_read_b64_tr_b16 a[234:235], v31 offset:3072
    s_waitcnt lgkmcnt(8)
    v_mfma_f32_16x16x32_bf16 v[64:67], a[212:215], v[160:163], v[64:67]
    ds_read_b64_tr_b16 a[236:237], v29 offset:6144
    v_mfma_f32_16x16x32_bf16 v[72:75], a[212:215], v[216:219], v[72:75]
    ds_read_b64_tr_b16 a[238:239], v29 offset:9216
    ds_read_b64_tr_b16 a[188:189], v33 offset:0
    ds_read_b64_tr_b16 a[190:191], v33 offset:3072
    v_mfma_f32_16x16x32_bf16 v[240:243], a[56:59], v[160:163], v[240:243]
    ds_read_b64_tr_b16 a[72:73], v124 offset:0
    s_waitcnt lgkmcnt(12)
    v_mfma_f32_16x16x32_bf16 v[68:71], a[216:219], v[160:163], v[68:71]
    ds_read_b64_tr_b16 a[240:241], v29 offset:6176
    v_mfma_f32_16x16x32_bf16 v[76:79], a[216:219], v[216:219], v[76:79]
    ds_read_b64_tr_b16 a[242:243], v29 offset:9248
    ds_read_b64_tr_b16 a[32:33], v35 offset:0
    ds_read_b64_tr_b16 a[34:35], v35 offset:3072
    v_mfma_f32_16x16x32_bf16 v[244:247], v[160:163], v[160:163], v[244:247]
    ds_read_b64_tr_b16 a[74:75], v124 offset:1536
    buffer_load_dword a250, v0, s[24:27], 0 offen
    s_waitcnt lgkmcnt(8)
    v_mfma_f32_16x16x32_bf16 v[80:83], a[220:223], v[160:163], v[80:83]
    ds_read_b64_tr_b16 a[212:213], v29 offset:6208
    v_mfma_f32_16x16x32_bf16 v[88:91], a[220:223], v[216:219], v[88:91]
    ds_read_b64_tr_b16 a[214:215], v29 offset:9280
    v_mfma_f32_16x16x32_bf16 v[116:119], a[184:187], a[56:59], v[116:119]
    ds_read_b64_tr_b16 a[76:77], v124 offset:32
    v_mfma_f32_16x16x32_bf16 v[248:251], a[56:59], v[216:219], v[248:251]
    ds_read_b64_tr_b16 a[78:79], v124 offset:1568
    v_mfma_f32_16x16x32_bf16 v[84:87], a[224:227], v[160:163], v[84:87]
    ds_read_b64_tr_b16 a[216:217], v29 offset:6240
    v_mfma_f32_16x16x32_bf16 v[92:95], a[224:227], v[216:219], v[92:95]
    ds_read_b64_tr_b16 a[218:219], v29 offset:9312
    v_mfma_f32_16x16x32_bf16 v[120:123], a[28:31], a[56:59], v[120:123]
    ds_read_b64_tr_b16 a[80:81], v125 offset:0
    v_mfma_f32_16x16x32_bf16 v[252:255], v[216:219], v[216:219], v[252:255]
    ds_read_b64_tr_b16 a[82:83], v125 offset:1536
    s_waitcnt lgkmcnt(8)
    v_mfma_f32_16x16x32_bf16 v[96:99], v[160:163], a[228:231], v[96:99]
    ds_read_b64_tr_b16 a[220:221], v29 offset:6272
    v_mfma_f32_16x16x32_bf16 v[104:107], v[216:219], a[228:231], v[104:107]
    ds_read_b64_tr_b16 a[222:223], v29 offset:9344
    ds_read_b64_tr_b16 a[84:85], v124 offset:12288
    ds_read_b64_tr_b16 a[86:87], v124 offset:13824
    ds_read_b64_tr_b16 a[88:89], v124 offset:12320
    v_mfma_f32_16x16x32_bf16 v[100:103], v[160:163], a[232:235], v[100:103]
    ds_read_b64_tr_b16 a[224:225], v31 offset:6144
    v_mfma_f32_16x16x32_bf16 v[108:111], v[216:219], a[232:235], v[108:111]
    ds_read_b64_tr_b16 a[226:227], v31 offset:9216
    s_waitcnt lgkmcnt(8)
    v_mfma_f32_16x16x32_bf16 v[64:67], a[236:239], v[164:167], v[64:67]
    ds_read_b64_tr_b16 a[228:229], v29 offset:12288
    v_mfma_f32_16x16x32_bf16 v[72:75], a[236:239], v[220:223], v[72:75]
    ds_read_b64_tr_b16 a[230:231], v29 offset:15360
    ds_read_b64_tr_b16 a[192:193], v33 offset:6144
    ds_read_b64_tr_b16 a[194:195], v33 offset:9216
    v_mfma_f32_16x16x32_bf16 v[240:243], a[56:59], v[164:167], v[240:243]
    ds_read_b64_tr_b16 a[90:91], v124 offset:13856
    buffer_load_dword a246, v126, s[12:15], 0 offen
    v_mfma_f32_16x16x32_bf16 v[68:71], a[240:243], v[164:167], v[68:71]
    ds_read_b64_tr_b16 a[232:233], v29 offset:12320
    v_mfma_f32_16x16x32_bf16 v[76:79], a[240:243], v[220:223], v[76:79]
    ds_read_b64_tr_b16 a[234:235], v29 offset:15392
    ds_read_b64_tr_b16 a[36:37], v35 offset:6144
    ds_read_b64_tr_b16 a[38:39], v35 offset:9216
    v_mfma_f32_16x16x32_bf16 v[244:247], v[164:167], v[164:167], v[244:247]
    ds_read_b64_tr_b16 a[92:93], v125 offset:12288
    s_waitcnt lgkmcnt(8)
    v_mfma_f32_16x16x32_bf16 v[80:83], a[212:215], v[164:167], v[80:83]
    ds_read_b64_tr_b16 a[236:237], v29 offset:12352
    v_mfma_f32_16x16x32_bf16 v[88:91], a[212:215], v[220:223], v[88:91]
    ds_read_b64_tr_b16 a[238:239], v29 offset:15424
    v_mfma_f32_16x16x32_bf16 v[116:119], a[188:191], a[56:59], v[116:119]
    ds_read_b64_tr_b16 a[94:95], v125 offset:13824
    v_mfma_f32_16x16x32_bf16 v[248:251], a[56:59], v[220:223], v[248:251]
    ds_read_b64_tr_b16 a[96:97], v124 offset:24576
    v_mfma_f32_16x16x32_bf16 v[84:87], a[216:219], v[164:167], v[84:87]
    ds_read_b64_tr_b16 a[240:241], v29 offset:12384
    v_mfma_f32_16x16x32_bf16 v[92:95], a[216:219], v[220:223], v[92:95]
    ds_read_b64_tr_b16 a[242:243], v29 offset:15456
    v_mfma_f32_16x16x32_bf16 v[120:123], a[32:35], a[56:59], v[120:123]
    ds_read_b64_tr_b16 a[98:99], v124 offset:26112
    v_mfma_f32_16x16x32_bf16 v[252:255], v[220:223], v[220:223], v[252:255]
    ds_read_b64_tr_b16 a[100:101], v124 offset:24608
    s_waitcnt lgkmcnt(8)
    v_mfma_f32_16x16x32_bf16 v[96:99], v[164:167], a[220:223], v[96:99]
    ds_read_b64_tr_b16 a[212:213], v29 offset:12416
    v_mfma_f32_16x16x32_bf16 v[104:107], v[220:223], a[220:223], v[104:107]
    ds_read_b64_tr_b16 a[214:215], v29 offset:15488
    ds_read_b64_tr_b16 a[102:103], v124 offset:26144
    ds_read_b64_tr_b16 a[104:105], v125 offset:24576
    ds_read_b64_tr_b16 a[106:107], v125 offset:26112
    v_mfma_f32_16x16x32_bf16 v[100:103], v[164:167], a[224:227], v[100:103]
    ds_read_b64_tr_b16 a[216:217], v31 offset:12288
    v_mfma_f32_16x16x32_bf16 v[108:111], v[220:223], a[224:227], v[108:111]
    ds_read_b64_tr_b16 a[218:219], v31 offset:15360
    s_waitcnt lgkmcnt(8)
    v_mfma_f32_16x16x32_bf16 v[64:67], a[228:231], v[168:171], v[64:67]
    ds_read_b64_tr_b16 a[220:221], v29 offset:18432
    v_mfma_f32_16x16x32_bf16 v[72:75], a[228:231], v[224:227], v[72:75]
    ds_read_b64_tr_b16 a[222:223], v29 offset:21504
    ds_read_b64_tr_b16 a[196:197], v33 offset:12288
    ds_read_b64_tr_b16 a[198:199], v33 offset:15360
    v_mfma_f32_16x16x32_bf16 v[240:243], a[56:59], v[168:171], v[240:243]
    ds_read_b64_tr_b16 a[108:109], v124 offset:36864
    buffer_load_dword a247, v127, s[16:19], 0 offen
    v_mfma_f32_16x16x32_bf16 v[68:71], a[232:235], v[168:171], v[68:71]
    ds_read_b64_tr_b16 a[224:225], v29 offset:18464
    v_mfma_f32_16x16x32_bf16 v[76:79], a[232:235], v[224:227], v[76:79]
    ds_read_b64_tr_b16 a[226:227], v29 offset:21536
    ds_read_b64_tr_b16 a[40:41], v35 offset:12288
    ds_read_b64_tr_b16 a[42:43], v35 offset:15360
    v_mfma_f32_16x16x32_bf16 v[244:247], v[168:171], v[168:171], v[244:247]
    ds_read_b64_tr_b16 a[110:111], v124 offset:38400
    s_waitcnt lgkmcnt(8)
    v_mfma_f32_16x16x32_bf16 v[80:83], a[236:239], v[168:171], v[80:83]
    ds_read_b64_tr_b16 a[228:229], v29 offset:18496
    v_mfma_f32_16x16x32_bf16 v[88:91], a[236:239], v[224:227], v[88:91]
    ds_read_b64_tr_b16 a[230:231], v29 offset:21568
    v_mfma_f32_16x16x32_bf16 v[116:119], a[192:195], a[56:59], v[116:119]
    ds_read_b64_tr_b16 a[112:113], v124 offset:36896
    v_mfma_f32_16x16x32_bf16 v[248:251], a[56:59], v[224:227], v[248:251]
    ds_read_b64_tr_b16 a[114:115], v124 offset:38432
    v_mfma_f32_16x16x32_bf16 v[84:87], a[240:243], v[168:171], v[84:87]
    ds_read_b64_tr_b16 a[232:233], v29 offset:18528
    v_mfma_f32_16x16x32_bf16 v[92:95], a[240:243], v[224:227], v[92:95]
    ds_read_b64_tr_b16 a[234:235], v29 offset:21600
    v_mfma_f32_16x16x32_bf16 v[120:123], a[36:39], a[56:59], v[120:123]
    ds_read_b64_tr_b16 a[116:117], v125 offset:36864
    v_mfma_f32_16x16x32_bf16 v[252:255], v[224:227], v[224:227], v[252:255]
    ds_read_b64_tr_b16 a[118:119], v125 offset:38400
    s_waitcnt lgkmcnt(8)
    v_mfma_f32_16x16x32_bf16 v[96:99], v[168:171], a[212:215], v[96:99]
    ds_read_b64_tr_b16 a[236:237], v29 offset:18560
    v_mfma_f32_16x16x32_bf16 v[104:107], v[224:227], a[212:215], v[104:107]
    ds_read_b64_tr_b16 a[238:239], v29 offset:21632
    ds_read_b64_tr_b16 a[120:121], v124 offset:49152
    ds_read_b64_tr_b16 a[122:123], v124 offset:50688
    ds_read_b64_tr_b16 a[124:125], v124 offset:49184
    v_mfma_f32_16x16x32_bf16 v[100:103], v[168:171], a[216:219], v[100:103]
    ds_read_b64_tr_b16 a[240:241], v31 offset:18432
    v_mfma_f32_16x16x32_bf16 v[108:111], v[224:227], a[216:219], v[108:111]
    ds_read_b64_tr_b16 a[242:243], v31 offset:21504
    s_waitcnt lgkmcnt(8)
    v_mfma_f32_16x16x32_bf16 v[64:67], a[220:223], v[172:175], v[64:67]
    v_mfma_f32_16x16x32_bf16 v[72:75], a[220:223], v[228:231], v[72:75]
    ds_read_b64_tr_b16 a[200:201], v33 offset:18432
    ds_read_b64_tr_b16 a[202:203], v33 offset:21504
    v_mfma_f32_16x16x32_bf16 v[240:243], a[56:59], v[172:175], v[240:243]
    ds_read_b64_tr_b16 a[126:127], v124 offset:50720
    buffer_load_dword a248, v13, s[20:23], 0 offen
    v_mfma_f32_16x16x32_bf16 v[68:71], a[224:227], v[172:175], v[68:71]
    v_mfma_f32_16x16x32_bf16 v[76:79], a[224:227], v[228:231], v[76:79]
    ds_read_b64_tr_b16 a[44:45], v35 offset:18432
    ds_read_b64_tr_b16 a[46:47], v35 offset:21504
    v_mfma_f32_16x16x32_bf16 v[244:247], v[172:175], v[172:175], v[244:247]
    ds_read_b64_tr_b16 a[128:129], v125 offset:49152
    s_waitcnt lgkmcnt(4)
    v_mfma_f32_16x16x32_bf16 v[80:83], a[228:231], v[172:175], v[80:83]
    v_mfma_f32_16x16x32_bf16 v[88:91], a[228:231], v[228:231], v[88:91]
    v_mfma_f32_16x16x32_bf16 v[116:119], a[196:199], a[56:59], v[116:119]
    ds_read_b64_tr_b16 a[130:131], v125 offset:50688
    v_mfma_f32_16x16x32_bf16 v[248:251], a[56:59], v[228:231], v[248:251]
    ds_read_b64_tr_b16 a[132:133], v36 offset:0
    v_mfma_f32_16x16x32_bf16 v[84:87], a[232:235], v[172:175], v[84:87]
    v_mfma_f32_16x16x32_bf16 v[92:95], a[232:235], v[228:231], v[92:95]
    v_mfma_f32_16x16x32_bf16 v[120:123], a[40:43], a[56:59], v[120:123]
    ds_read_b64_tr_b16 a[134:135], v36 offset:1536
    v_mfma_f32_16x16x32_bf16 v[252:255], v[228:231], v[228:231], v[252:255]
    ds_read_b64_tr_b16 a[136:137], v36 offset:32
    s_waitcnt lgkmcnt(0)
    v_mfma_f32_16x16x32_bf16 v[96:99], v[172:175], a[236:239], v[96:99]
    v_mfma_f32_16x16x32_bf16 v[104:107], v[228:231], a[236:239], v[104:107]
    ds_read_b64_tr_b16 a[138:139], v36 offset:1568
    ds_read_b64_tr_b16 a[140:141], v37 offset:0
    ds_read_b64_tr_b16 a[142:143], v37 offset:1536
    v_mfma_f32_16x16x32_bf16 v[100:103], v[172:175], a[240:243], v[100:103]
    v_mfma_f32_16x16x32_bf16 v[108:111], v[228:231], a[240:243], v[108:111]
    s_waitcnt vmcnt(7)
    s_barrier
    ds_read_b128 v[176:179], v114 offset:0
    ds_read_b128 v[232:235], v114 offset:2048
    ds_read_b128 v[180:183], v115 offset:0
    ds_read_b128 v[236:239], v115 offset:2048
    ds_read_b64_tr_b16 a[212:213], v29 offset:24576
    ds_read_b64_tr_b16 a[214:215], v29 offset:27648
    ds_read_b64_tr_b16 a[216:217], v29 offset:24608
    ds_read_b64_tr_b16 a[218:219], v29 offset:27680
    ds_read_b64_tr_b16 a[220:221], v29 offset:24640
    ds_read_b64_tr_b16 a[222:223], v29 offset:27712
    ds_read_b64_tr_b16 a[224:225], v29 offset:24672
    ds_read_b64_tr_b16 a[226:227], v29 offset:27744
    ds_read_b64_tr_b16 a[228:229], v29 offset:24704
    ds_read_b64_tr_b16 a[230:231], v29 offset:27776
    ds_read_b64_tr_b16 a[232:233], v31 offset:24576
    ds_read_b64_tr_b16 a[234:235], v31 offset:27648
    s_waitcnt lgkmcnt(8)
    v_mfma_f32_16x16x32_bf16 v[64:67], a[212:215], v[176:179], v[64:67]
    ds_read_b64_tr_b16 a[236:237], v29 offset:30720
    v_mfma_f32_16x16x32_bf16 v[72:75], a[212:215], v[232:235], v[72:75]
    ds_read_b64_tr_b16 a[238:239], v29 offset:33792
    ds_read_b64_tr_b16 a[204:205], v33 offset:24576
    ds_read_b64_tr_b16 a[206:207], v33 offset:27648
    v_mfma_f32_16x16x32_bf16 v[240:243], a[56:59], v[176:179], v[240:243]
    ds_read_b64_tr_b16 a[144:145], v36 offset:12288
    s_waitcnt lgkmcnt(12)
    v_mfma_f32_16x16x32_bf16 v[68:71], a[216:219], v[176:179], v[68:71]
    ds_read_b64_tr_b16 a[240:241], v29 offset:30752
    v_mfma_f32_16x16x32_bf16 v[76:79], a[216:219], v[232:235], v[76:79]
    ds_read_b64_tr_b16 a[242:243], v29 offset:33824
    ds_read_b64_tr_b16 a[48:49], v35 offset:24576
    ds_read_b64_tr_b16 a[50:51], v35 offset:27648
    v_mfma_f32_16x16x32_bf16 v[244:247], v[176:179], v[176:179], v[244:247]
    ds_read_b64_tr_b16 a[146:147], v36 offset:13824
    s_waitcnt lgkmcnt(8)
    v_mfma_f32_16x16x32_bf16 v[80:83], a[220:223], v[176:179], v[80:83]
    ds_read_b64_tr_b16 a[212:213], v29 offset:30784
    v_mfma_f32_16x16x32_bf16 v[88:91], a[220:223], v[232:235], v[88:91]
    ds_read_b64_tr_b16 a[214:215], v29 offset:33856
    v_mfma_f32_16x16x32_bf16 v[116:119], a[200:203], a[56:59], v[116:119]
    ds_read_b64_tr_b16 a[148:149], v36 offset:12320
    v_mfma_f32_16x16x32_bf16 v[248:251], a[56:59], v[232:235], v[248:251]
    ds_read_b64_tr_b16 a[150:151], v36 offset:13856
    v_mfma_f32_16x16x32_bf16 v[84:87], a[224:227], v[176:179], v[84:87]
    ds_read_b64_tr_b16 a[216:217], v29 offset:30816
    v_mfma_f32_16x16x32_bf16 v[92:95], a[224:227], v[232:235], v[92:95]
    ds_read_b64_tr_b16 a[218:219], v29 offset:33888
    v_mfma_f32_16x16x32_bf16 v[120:123], a[44:47], a[56:59], v[120:123]
    ds_read_b64_tr_b16 a[152:153], v37 offset:12288
    v_mfma_f32_16x16x32_bf16 v[252:255], v[232:235], v[232:235], v[252:255]
    ds_read_b64_tr_b16 a[154:155], v37 offset:13824
    s_waitcnt lgkmcnt(8)
    v_mfma_f32_16x16x32_bf16 v[96:99], v[176:179], a[228:231], v[96:99]
    ds_read_b64_tr_b16 a[220:221], v29 offset:30848
    v_mfma_f32_16x16x32_bf16 v[104:107], v[232:235], a[228:231], v[104:107]
    ds_read_b64_tr_b16 a[222:223], v29 offset:33920
    v_mfma_f32_16x16x32_bf16 v[100:103], v[176:179], a[232:235], v[100:103]
    ds_read_b64_tr_b16 a[224:225], v31 offset:30720
    v_mfma_f32_16x16x32_bf16 v[108:111], v[232:235], a[232:235], v[108:111]
    ds_read_b64_tr_b16 a[226:227], v31 offset:33792
    s_waitcnt lgkmcnt(8)
    v_mfma_f32_16x16x32_bf16 v[64:67], a[236:239], v[180:183], v[64:67]
    v_mfma_f32_16x16x32_bf16 v[72:75], a[236:239], v[236:239], v[72:75]
    ds_read_b64_tr_b16 a[208:209], v33 offset:30720
    ds_read_b64_tr_b16 a[210:211], v33 offset:33792
    v_mfma_f32_16x16x32_bf16 v[240:243], a[56:59], v[180:183], v[240:243]
    v_mfma_f32_16x16x32_bf16 v[68:71], a[240:243], v[180:183], v[68:71]
    v_mfma_f32_16x16x32_bf16 v[76:79], a[240:243], v[236:239], v[76:79]
    ds_read_b64_tr_b16 a[52:53], v35 offset:30720
    ds_read_b64_tr_b16 a[54:55], v35 offset:33792
    v_mfma_f32_16x16x32_bf16 v[244:247], v[180:183], v[180:183], v[244:247]
    s_waitcnt lgkmcnt(4)
    v_mfma_f32_16x16x32_bf16 v[80:83], a[212:215], v[180:183], v[80:83]
    v_mfma_f32_16x16x32_bf16 v[88:91], a[212:215], v[236:239], v[88:91]
    v_mfma_f32_16x16x32_bf16 v[116:119], a[204:207], a[56:59], v[116:119]
    v_mfma_f32_16x16x32_bf16 v[248:251], a[56:59], v[236:239], v[248:251]
    v_mfma_f32_16x16x32_bf16 v[84:87], a[216:219], v[180:183], v[84:87]
    v_mfma_f32_16x16x32_bf16 v[92:95], a[216:219], v[236:239], v[92:95]
    v_mfma_f32_16x16x32_bf16 v[120:123], a[48:51], a[56:59], v[120:123]
    v_mfma_f32_16x16x32_bf16 v[252:255], v[236:239], v[236:239], v[252:255]
    s_waitcnt lgkmcnt(0)
    v_mfma_f32_16x16x32_bf16 v[96:99], v[180:183], a[220:223], v[96:99]
    v_mfma_f32_16x16x32_bf16 v[104:107], v[236:239], a[220:223], v[104:107]
    v_mfma_f32_16x16x32_bf16 v[100:103], v[180:183], a[224:227], v[100:103]
    v_mfma_f32_16x16x32_bf16 v[108:111], v[236:239], a[224:227], v[108:111]
    v_mfma_f32_16x16x32_bf16 v[116:119], a[208:211], a[56:59], v[116:119]
    v_mfma_f32_16x16x32_bf16 v[120:123], a[52:55], a[56:59], v[120:123]
    s_barrier
    v_accvgpr_read_b32 v168, a60
    v_accvgpr_read_b32 v169, a61
    v_accvgpr_read_b32 v170, a62
    v_lshlrev_b32 v168, 16, v168
    v_lshlrev_b32 v169, 16, v169
    v_lshlrev_b32 v170, 16, v170
    ds_write_b32 v3, v168 offset:832
    ds_write_b32 v3, v170 offset:1280
    s_mov_b32 exec_hi, 0xffff
    ds_write_b32 v3, v169 offset:1088
    s_mov_b64 exec, -1
    s_waitcnt vmcnt(4)
    s_barrier
    s_add_u32 s81, s93, 92160
    v_add_u32 v174, s81, v2
    ds_read_b128 v[128:131], v174 offset:0
    ds_read_b128 v[132:135], v174 offset:4096
    ds_read_b128 v[136:139], v174 offset:8192
    ds_read_b128 v[140:143], v174 offset:12288
    s_cmp_lt_u32 s42, 2
    s_cselect_b64 vcc, -1, 0
    s_waitcnt lgkmcnt(0)
    v_cndmask_b32 v140, 0, v140, vcc
    v_cndmask_b32 v141, 0, v141, vcc
    v_cndmask_b32 v142, 0, v142, vcc
    v_cndmask_b32 v143, 0, v143, vcc
    v_mfma_f32_16x16x32_bf16 v[144:147], a[56:59], v[128:131], 0
    v_mfma_f32_16x16x32_bf16 v[148:151], v[128:131], v[128:131], 0
    v_mfma_f32_16x16x32_bf16 v[144:147], a[56:59], v[132:135], v[144:147]
    v_mfma_f32_16x16x32_bf16 v[148:151], v[132:135], v[132:135], v[148:151]
    v_mfma_f32_16x16x32_bf16 v[144:147], a[56:59], v[136:139], v[144:147]
    v_mfma_f32_16x16x32_bf16 v[148:151], v[136:139], v[136:139], v[148:151]
    v_mfma_f32_16x16x32_bf16 v[144:147], a[56:59], v[140:143], v[144:147]
    s_mov_b32 s90, 0
    s_add_u32 m0, s93, 106496
    v_mfma_f32_16x16x32_bf16 v[148:151], v[140:143], v[140:143], v[148:151]
    buffer_load_dwordx4 v7, s[12:15], s90 offen lds
    s_mov_b32 s72, 0x100001
    s_mov_b32 s73, 0x10000100
    s_mov_b32 s74, 0x200002
    s_mov_b32 s75, 0x20000200
    s_mov_b32 s76, 0x400004
    s_mov_b32 s77, 0x40000400
    s_mov_b32 s78, 0x800008
    s_mov_b32 s79, 0x80000800
    v_cndmask_b32 v201, 0, v244, s[72:73]
    v_cndmask_b32 v201, v201, v245, s[74:75]
    v_cndmask_b32 v201, v201, v246, s[76:77]
    v_cndmask_b32 v201, v201, v247, s[78:79]
    v_cndmask_b32 v205, 0, v252, s[72:73]
    v_cndmask_b32 v205, v205, v253, s[74:75]
    v_cndmask_b32 v205, v205, v254, s[76:77]
    v_cndmask_b32 v205, v205, v255, s[78:79]
    v_mov_b32 v200, v240
    v_mov_b32 v204, v248
    v_cndmask_b32 v173, 0, v148, s[72:73]
    v_cndmask_b32 v173, v173, v149, s[74:75]
    v_cndmask_b32 v173, v173, v150, s[76:77]
    v_cndmask_b32 v173, v173, v151, s[78:79]
    v_mov_b32 v152, v201
    v_mov_b32 v153, v205
    v_mov_b32 v154, v173
    v_permlane32_swap_b32 v152, v201
    s_mov_b32 s90, 25088
    s_add_u32 m0, s93, 110592
    v_permlane32_swap_b32 v153, v205
    buffer_load_dwordx4 v7, s[12:15], s90 offen lds
    v_permlane32_swap_b32 v154, v173
    v_add_f32 v201, v152, v201
    v_add_f32 v205, v153, v205
    v_add_f32 v173, v154, v173
    v_mov_b32 v152, v201
    v_mov_b32 v153, v205
    v_mov_b32 v154, v173
    v_permlane16_swap_b32 v152, v201
    v_permlane16_swap_b32 v153, v205
    v_permlane16_swap_b32 v154, v173
    v_add_f32 v201, v152, v201
    v_add_f32 v205, v153, v205
    v_add_f32 v173, v154, v173
    v_mov_b32 v172, v144
    s_lshl_b32 s80, s42, 7
    v_and_b32 v174, 15, v57
    v_lshl_add_u32 v174, v174, 3, s80
    ds_write_b64 v174, v[172:173] offset:3584
    s_waitcnt lgkmcnt(0)
    s_barrier
    v_and_b32 v174, 15, v57
    v_lshlrev_b32 v174, 3, v174
    ds_read_b64 v[128:129], v174 offset:3584
    ds_read_b64 v[130:131], v174 offset:3712
    ds_read_b64 v[132:133], v174 offset:3840
    ds_read_b64 v[134:135], v174 offset:3968
    s_waitcnt lgkmcnt(2)
    v_add_f32 v172, v128, v130
    s_mov_b32 s90, 50176
    s_add_u32 m0, s93, 114688
    v_add_f32 v173, v129, v131
    buffer_load_dwordx4 v7, s[12:15], s90 offen lds
    s_waitcnt lgkmcnt(0)
    v_add_f32 v132, v132, v134
    v_add_f32 v133, v133, v135
    v_add_f32 v208, v172, v132
    v_add_f32 v209, v173, v133
    v_add_u32 v221, 92160, v2
    ds_read_b128 v[128:131], v221 offset:0
    ds_read_b128 v[132:135], v221 offset:1024
    ds_read_b128 v[136:139], v221 offset:2048
    ds_read_b128 v[140:143], v221 offset:3072
    ds_read_b128 v[144:147], v221 offset:4096
    ds_read_b128 v[148:151], v221 offset:5120
    ds_read_b128 v[152:155], v221 offset:6144
    ds_read_b128 v[156:159], v221 offset:7168
    ds_read_b128 v[160:163], v221 offset:8192
    ds_read_b128 v[164:167], v221 offset:9216
    ds_read_b128 v[168:171], v221 offset:10240
    ds_read_b128 v[172:175], v221 offset:11264
    ds_read_b128 v[176:179], v221 offset:12288
    ds_read_b128 v[180:183], v221 offset:13312
    s_waitcnt lgkmcnt(0)
    s_barrier
    s_cmp_ge_u32 s42, 2
    s_cbranch_scc1 L_halo_v_5
    v_mfma_f32_16x16x32_bf16 v[112:115], a[156:159], v[128:131], 0
    v_mfma_f32_16x16x32_bf16 v[112:115], a[160:163], v[132:135], v[112:115]
    v_mfma_f32_16x16x32_bf16 v[112:115], a[164:167], v[136:139], v[112:115]
    v_mfma_f32_16x16x32_bf16 v[112:115], a[168:171], v[140:143], v[112:115]
    v_mfma_f32_16x16x32_bf16 v[112:115], a[172:175], v[144:147], v[112:115]
    v_mfma_f32_16x16x32_bf16 v[112:115], a[176:179], v[148:151], v[112:115]
    v_mfma_f32_16x16x32_bf16 v[112:115], a[180:183], v[152:155], v[112:115]
    v_mfma_f32_16x16x32_bf16 v[112:115], a[184:187], v[156:159], v[112:115]
    v_mfma_f32_16x16x32_bf16 v[112:115], a[188:191], v[160:163], v[112:115]
    v_mfma_f32_16x16x32_bf16 v[112:115], a[192:195], v[164:167], v[112:115]
    v_mfma_f32_16x16x32_bf16 v[112:115], a[196:199], v[168:171], v[112:115]
    v_mfma_f32_16x16x32_bf16 v[112:115], a[200:203], v[172:175], v[112:115]
    v_mfma_f32_16x16x32_bf16 v[112:115], a[204:207], v[176:179], v[112:115]
    v_mfma_f32_16x16x32_bf16 v[112:115], a[208:211], v[180:183], v[112:115]
    s_branch L_halo_d_6
L_halo_v_5:
    s_nop 6
    v_mfma_f32_16x16x32_bf16 v[112:115], v[128:131], a[156:159], 0
    v_mfma_f32_16x16x32_bf16 v[112:115], v[132:135], a[160:163], v[112:115]
    v_mfma_f32_16x16x32_bf16 v[112:115], v[136:139], a[164:167], v[112:115]
    v_mfma_f32_16x16x32_bf16 v[112:115], v[140:143], a[168:171], v[112:115]
    v_mfma_f32_16x16x32_bf16 v[112:115], v[144:147], a[172:175], v[112:115]
    v_mfma_f32_16x16x32_bf16 v[112:115], v[148:151], a[176:179], v[112:115]
    v_mfma_f32_16x16x32_bf16 v[112:115], v[152:155], a[180:183], v[112:115]
    v_mfma_f32_16x16x32_bf16 v[112:115], v[156:159], a[184:187], v[112:115]
    v_mfma_f32_16x16x32_bf16 v[112:115], v[160:163], a[188:191], v[112:115]
    v_mfma_f32_16x16x32_bf16 v[112:115], v[164:167], a[192:195], v[112:115]
    v_mfma_f32_16x16x32_bf16 v[112:115], v[168:171], a[196:199], v[112:115]
    v_mfma_f32_16x16x32_bf16 v[112:115], v[172:175], a[200:203], v[112:115]
    v_mfma_f32_16x16x32_bf16 v[112:115], v[176:179], a[204:207], v[112:115]
    v_mfma_f32_16x16x32_bf16 v[112:115], v[180:183], a[208:211], v[112:115]
L_halo_d_6:
    s_add_u32 s72, s42, 2
    s_lshl_b32 s72, s72, 6
    v_add_u32 v220, s72, v53
    s_and_b32 s72, s42, 1
    s_lshl_b32 s72, s72, 6
    v_add_u32 v221, s72, v53
    s_mov_b32 s90, 75264
    s_add_u32 m0, s93, 118784
    s_nop 0
    buffer_load_dwordx4 v7, s[12:15], s90 offen lds
    s_mov_b32 exec_lo, 0x00010001
    s_mov_b32 exec_hi, 0x00010001
    ds_write_b128 v220, v[116:119] offset:0
    ds_write_b128 v221, v[120:123] offset:0
    s_mov_b64 exec, -1
    s_waitcnt lgkmcnt(0)
    s_barrier
    s_mov_b32 s90, 100352
    s_add_u32 m0, s93, 122880
    s_nop 0
    buffer_load_dwordx4 v7, s[12:15], s90 offen lds
    s_mov_b32 s90, 125440
    s_add_u32 m0, s93, 126976
    s_nop 0
    buffer_load_dwordx4 v7, s[12:15], s90 offen lds
    s_mov_b32 s90, 150528
    s_add_u32 m0, s93, 131072
    s_nop 0
    buffer_load_dwordx4 v7, s[12:15], s90 offen lds
    s_mov_b32 s90, 200704
    s_add_u32 m0, s93, 135168
    s_nop 0
    buffer_load_dwordx4 v7, s[12:15], s90 offen lds
    s_mov_b32 s90, 225792
    s_add_u32 m0, s93, 139264
    s_nop 0
    buffer_load_dwordx4 v7, s[12:15], s90 offen lds
    s_mov_b32 s90, 250880
    s_add_u32 m0, s93, 143360
    s_nop 0
    buffer_load_dwordx4 v7, s[12:15], s90 offen lds
    s_mov_b32 s90, 275968
    s_add_u32 m0, s93, 147456
    s_nop 0
    buffer_load_dwordx4 v7, s[12:15], s90 offen lds
    s_mov_b32 s90, 301056
    s_add_u32 m0, s93, 151552
    s_nop 0
    buffer_load_dwordx4 v7, s[12:15], s90 offen lds
    s_mov_b32 s90, 326144
    s_add_u32 m0, s93, 155648
    s_nop 0
    buffer_load_dwordx4 v7, s[12:15], s90 offen lds
    s_mov_b32 s90, 351232
    s_add_u32 m0, s93, 159744
    s_nop 0
    buffer_load_dwordx4 v7, s[12:15], s90 offen lds
    s_lshl_b32 s84, s3, 4
    s_add_u32 s84, s84, s41
    s_lshl_b32 s84, s84, 10
    s_add_u32 s84, s84, 0
    s_add_u32 s85, s84, 16384
    s_lshl_b32 s72, s46, 1
    s_lshl_b32 s68, 0x33333333, s72
    s_mov_b32 s69, s68
    s_and_b32 s72, s42, 1
    s_lshl_b32 s36, 0x05555555, s72
    s_mov_b32 s37, 0
    s_lshr_b32 s72, s42, 1
    s_mul_i32 s72, s72, 28
    s_lshl_b64 s[36:37], s[36:37], s72
    v_mul_f32 v200, 0x3b124925, v200
    v_mul_f32 v201, 0x3b124925, v201
    v_fma_f32 v201, -v200, v200, v201
    v_max_f32 v201, 0, v201
    v_add_f32 v128, 0x3727c5ac, v201
    v_rsq_f32 v212, v128
    s_nop 0
    v_mul_f32 v215, v200, v212
    v_mul_f32 v204, 0x3b124925, v204
    v_mul_f32 v205, 0x3b124925, v205
    v_fma_f32 v205, -v204, v204, v205
    v_max_f32 v205, 0, v205
    v_add_f32 v129, 0x3727c5ac, v205
    v_rsq_f32 v213, v129
    s_nop 0
    v_mul_f32 v216, v204, v213
    v_mul_f32 v208, 0x3b124925, v208
    v_mul_f32 v209, 0x3b124925, v209
    v_fma_f32 v209, -v208, v208, v209
    v_max_f32 v209, 0, v209
    v_add_f32 v130, 0x3727c5ac, v209
    v_rsq_f32 v214, v130
    s_nop 0
    v_mul_f32 v217, v208, v214
    s_mov_b64 exec, s[98:99]
    ds_write_b32 v54, v212 offset:0
    ds_write_b32 v54, v215 offset:64
    ds_write_b32 v54, v213 offset:128
    ds_write_b32 v54, v216 offset:192
    ds_write_b32 v54, v214 offset:256
    ds_write_b32 v54, v217 offset:320
    s_mov_b64 exec, -1
    ds_read_b128 v[132:135], v53 offset:0
    ds_read_b128 v[136:139], v53 offset:64
    ds_read_b128 v[140:143], v53 offset:128
    ds_read_b128 v[144:147], v53 offset:192
    v_and_b32 v128, 15, v57
    v_lshlrev_b32 v128, 2, v128
    ds_read_b32 v148, v128 offset:256
    ds_read_b32 v150, v128 offset:320
    ds_read_b128 v[152:155], v55 offset:0
    s_mov_b32 s90, 0
    s_add_u32 m0, s93, 6144
    ds_read_b128 v[156:159], v55 offset:64
    buffer_load_dwordx4 v14, s[16:19], s90 offen lds
    ds_read_b128 v[160:163], v55 offset:128
    ds_read_b128 v[164:167], v55 offset:192
    ds_read_b128 v[168:171], v55 offset:256
    ds_read_b128 v[172:175], v55 offset:320
    v_mov_b32 v176, v212
    v_mov_b32 v177, v215
    v_mov_b32 v178, v213
    v_mov_b32 v179, v216
    v_mov_b32 v180, v214
    v_mov_b32 v181, v217
    v_mul_f32 v182, 0x3e8b97f6, v212
    v_mul_f32 v183, 0x3e8b97f6, v215
    v_mul_f32 v184, 0x3e8b97f6, v213
    v_mul_f32 v185, 0x3e8b97f6, v216
    v_pk_mul_f32 v[80:81], v[80:81], v[176:177] op_sel_hi:[1,0]
    v_pk_mul_f32 v[82:83], v[82:83], v[176:177] op_sel_hi:[1,0]
    s_waitcnt lgkmcnt(9)
    v_pk_fma_f32 v[80:81], v[140:141], v[176:177], v[80:81] op_sel:[0,1,0] op_sel_hi:[1,1,1] neg_lo:[0,1,0] neg_hi:[0,1,0]
    v_pk_fma_f32 v[82:83], v[142:143], v[176:177], v[82:83] op_sel:[0,1,0] op_sel_hi:[1,1,1] neg_lo:[0,1,0] neg_hi:[0,1,0]
    v_cvt_pk_bf16_f32 v196, v80, v81
    v_cvt_pk_bf16_f32 v197, v82, v83
    v_pk_mul_f32 v[84:85], v[84:85], v[176:177] op_sel_hi:[1,0]
    v_pk_mul_f32 v[86:87], v[86:87], v[176:177] op_sel_hi:[1,0]
    s_waitcnt lgkmcnt(8)
    v_pk_fma_f32 v[84:85], v[144:145], v[176:177], v[84:85] op_sel:[0,1,0] op_sel_hi:[1,1,1] neg_lo:[0,1,0] neg_hi:[0,1,0]
    v_pk_fma_f32 v[86:87], v[146:147], v[176:177], v[86:87] op_sel:[0,1,0] op_sel_hi:[1,1,1] neg_lo:[0,1,0] neg_hi:[0,1,0]
    v_cvt_pk_bf16_f32 v198, v84, v85
    v_cvt_pk_bf16_f32 v199, v86, v87
    v_pk_mul_f32 v[88:89], v[88:89], v[178:179] op_sel_hi:[1,0]
    v_pk_mul_f32 v[90:91], v[90:91], v[178:179] op_sel_hi:[1,0]
    v_pk_fma_f32 v[88:89], v[140:141], v[178:179], v[88:89] op_sel:[0,1,0] op_sel_hi:[1,1,1] neg_lo:[0,1,0] neg_hi:[0,1,0]
    v_pk_fma_f32 v[90:91], v[142:143], v[178:179], v[90:91] op_sel:[0,1,0] op_sel_hi:[1,1,1] neg_lo:[0,1,0] neg_hi:[0,1,0]
    v_cvt_pk_bf16_f32 v200, v88, v89
    v_cvt_pk_bf16_f32 v201, v90, v91
    s_add_u32 m0, s93, 10240
    v_pk_mul_f32 v[92:93], v[92:93], v[178:179] op_sel_hi:[1,0]
    buffer_load_dwordx4 v15, s[16:19], s90 offen lds
    v_pk_mul_f32 v[94:95], v[94:95], v[178:179] op_sel_hi:[1,0]
    v_pk_fma_f32 v[92:93], v[144:145], v[178:179], v[92:93] op_sel:[0,1,0] op_sel_hi:[1,1,1] neg_lo:[0,1,0] neg_hi:[0,1,0]
    v_pk_fma_f32 v[94:95], v[146:147], v[178:179], v[94:95] op_sel:[0,1,0] op_sel_hi:[1,1,1] neg_lo:[0,1,0] neg_hi:[0,1,0]
    v_cvt_pk_bf16_f32 v202, v92, v93
    v_cvt_pk_bf16_f32 v203, v94, v95
    s_waitcnt lgkmcnt(5)
    v_pk_mul_f32 v[96:97], v[96:97], v[152:153]
    v_pk_mul_f32 v[98:99], v[98:99], v[154:155]
    s_waitcnt lgkmcnt(4)
    v_pk_fma_f32 v[96:97], v[156:157], v[148:149], v[96:97] op_sel_hi:[1,0,1] neg_lo:[1,0,0] neg_hi:[1,0,0]
    v_pk_fma_f32 v[98:99], v[158:159], v[148:149], v[98:99] op_sel_hi:[1,0,1] neg_lo:[1,0,0] neg_hi:[1,0,0]
    v_pk_mul_f32 v[100:101], v[100:101], v[152:153]
    v_pk_mul_f32 v[102:103], v[102:103], v[154:155]
    v_pk_fma_f32 v[100:101], v[156:157], v[150:151], v[100:101] op_sel_hi:[1,0,1] neg_lo:[1,0,0] neg_hi:[1,0,0]
    v_pk_fma_f32 v[102:103], v[158:159], v[150:151], v[102:103] op_sel_hi:[1,0,1] neg_lo:[1,0,0] neg_hi:[1,0,0]
    s_waitcnt lgkmcnt(3)
    v_pk_mul_f32 v[104:105], v[104:105], v[160:161]
    v_pk_mul_f32 v[106:107], v[106:107], v[162:163]
    s_waitcnt lgkmcnt(2)
    v_pk_fma_f32 v[104:105], v[164:165], v[148:149], v[104:105] op_sel_hi:[1,0,1] neg_lo:[1,0,0] neg_hi:[1,0,0]
    v_pk_fma_f32 v[106:107], v[166:167], v[148:149], v[106:107] op_sel_hi:[1,0,1] neg_lo:[1,0,0] neg_hi:[1,0,0]
    v_pk_mul_f32 v[108:109], v[108:109], v[160:161]
    v_pk_mul_f32 v[110:111], v[110:111], v[162:163]
    v_pk_fma_f32 v[108:109], v[164:165], v[150:151], v[108:109] op_sel_hi:[1,0,1] neg_lo:[1,0,0] neg_hi:[1,0,0]
    v_pk_fma_f32 v[110:111], v[166:167], v[150:151], v[110:111] op_sel_hi:[1,0,1] neg_lo:[1,0,0] neg_hi:[1,0,0]
    v_cvt_pk_bf16_f32 v206, v96, v97
    v_cvt_pk_bf16_f32 v207, v98, v99
    v_cvt_pk_bf16_f32 v210, v100, v101
    v_cvt_pk_bf16_f32 v211, v102, v103
    v_cvt_pk_bf16_f32 v214, v104, v105
    v_cvt_pk_bf16_f32 v215, v106, v107
    v_cvt_pk_bf16_f32 v218, v108, v109
    v_cvt_pk_bf16_f32 v219, v110, v111
    s_cmp_ge_u32 s42, 2
    s_cbranch_scc1 L_haff_v_7
    s_lshl_b32 s72, s42, 6
    v_add_u32 v128, s72, v53
    ds_read_b128 v[232:235], v128 offset:128
    s_waitcnt lgkmcnt(0)
    v_pk_mul_f32 v[112:113], v[112:113], v[180:181] op_sel_hi:[1,0]
    v_pk_mul_f32 v[114:115], v[114:115], v[180:181] op_sel_hi:[1,0]
    v_pk_fma_f32 v[112:113], v[232:233], v[180:181], v[112:113] op_sel:[0,1,0] op_sel_hi:[1,1,1] neg_lo:[0,1,0] neg_hi:[0,1,0]
    v_pk_fma_f32 v[114:115], v[234:235], v[180:181], v[114:115] op_sel:[0,1,0] op_sel_hi:[1,1,1] neg_lo:[0,1,0] neg_hi:[0,1,0]
    s_branch L_haff_d_8
L_haff_v_7:
    s_and_b32 s72, s42, 1
    s_cmp_eq_u32 s72, 1
    s_cselect_b64 vcc, -1, 0
    s_waitcnt lgkmcnt(0)
    v_cndmask_b32 v232, v148, v150, vcc
    v_pk_mul_f32 v[112:113], v[112:113], v[168:169]
    v_pk_mul_f32 v[114:115], v[114:115], v[170:171]
    v_pk_fma_f32 v[112:113], v[172:173], v[232:233], v[112:113] op_sel_hi:[1,0,1] neg_lo:[1,0,0] neg_hi:[1,0,0]
    v_pk_fma_f32 v[114:115], v[174:175], v[232:233], v[114:115] op_sel_hi:[1,0,1] neg_lo:[1,0,0] neg_hi:[1,0,0]
L_haff_d_8:
    v_cvt_pk_bf16_f32 v186, v112, v113
    v_cvt_pk_bf16_f32 v187, v114, v115
    s_cmp_eq_u32 s42, 3
    s_cbranch_scc1 L_skip_9
    ds_write_b128 v44, v[196:199] offset:0
    ds_write_b64 v44, v[206:207] offset:2048
    ds_write_b64 v44, v[210:211] offset:2056
    ds_write_b128 v44, v[200:203] offset:1024
    ds_write_b64 v44, v[214:215] offset:3072
    ds_write_b64 v44, v[218:219] offset:3080
L_skip_9:
    s_lshr_b32 s72, s42, 1
    s_add_u32 m0, s93, 14336
    s_lshl_b32 s72, s72, 10
    buffer_load_dwordx4 v16, s[16:19], s90 offen lds
    s_and_b32 s73, s42, 1
    s_lshl_b32 s73, s73, 3
    s_add_u32 s72, s72, s73
    s_add_u32 s72, s72, 92160
    v_add_u32 v128, s72, v2
    ds_write_b64 v128, v[186:187]
    v_pk_mul_f32 v[64:65], v[64:65], v[182:183] op_sel_hi:[1,0]
    v_pk_mul_f32 v[66:67], v[66:67], v[182:183] op_sel_hi:[1,0]
    v_pk_fma_f32 v[64:65], v[132:133], v[182:183], v[64:65] op_sel:[0,1,0] op_sel_hi:[1,1,1] neg_lo:[0,1,0] neg_hi:[0,1,0]
    v_pk_fma_f32 v[66:67], v[134:135], v[182:183], v[66:67] op_sel:[0,1,0] op_sel_hi:[1,1,1] neg_lo:[0,1,0] neg_hi:[0,1,0]
    v_cvt_pk_bf16_f32 v188, v64, v65
    v_cvt_pk_bf16_f32 v189, v66, v67
    v_pk_mul_f32 v[68:69], v[68:69], v[182:183] op_sel_hi:[1,0]
    v_pk_mul_f32 v[70:71], v[70:71], v[182:183] op_sel_hi:[1,0]
    v_pk_fma_f32 v[68:69], v[136:137], v[182:183], v[68:69] op_sel:[0,1,0] op_sel_hi:[1,1,1] neg_lo:[0,1,0] neg_hi:[0,1,0]
    v_pk_fma_f32 v[70:71], v[138:139], v[182:183], v[70:71] op_sel:[0,1,0] op_sel_hi:[1,1,1] neg_lo:[0,1,0] neg_hi:[0,1,0]
    v_cvt_pk_bf16_f32 v190, v68, v69
    v_cvt_pk_bf16_f32 v191, v70, v71
    v_pk_mul_f32 v[72:73], v[72:73], v[184:185] op_sel_hi:[1,0]
    v_pk_mul_f32 v[74:75], v[74:75], v[184:185] op_sel_hi:[1,0]
    v_pk_fma_f32 v[72:73], v[132:133], v[184:185], v[72:73] op_sel:[0,1,0] op_sel_hi:[1,1,1] neg_lo:[0,1,0] neg_hi:[0,1,0]
    v_pk_fma_f32 v[74:75], v[134:135], v[184:185], v[74:75] op_sel:[0,1,0] op_sel_hi:[1,1,1] neg_lo:[0,1,0] neg_hi:[0,1,0]
    v_cvt_pk_bf16_f32 v192, v72, v73
    v_cvt_pk_bf16_f32 v193, v74, v75
    v_pk_mul_f32 v[76:77], v[76:77], v[184:185] op_sel_hi:[1,0]
    v_pk_mul_f32 v[78:79], v[78:79], v[184:185] op_sel_hi:[1,0]
    v_pk_fma_f32 v[76:77], v[136:137], v[184:185], v[76:77] op_sel:[0,1,0] op_sel_hi:[1,1,1] neg_lo:[0,1,0] neg_hi:[0,1,0]
    v_pk_fma_f32 v[78:79], v[138:139], v[184:185], v[78:79] op_sel:[0,1,0] op_sel_hi:[1,1,1] neg_lo:[0,1,0] neg_hi:[0,1,0]
    v_cvt_pk_bf16_f32 v194, v76, v77
    v_cvt_pk_bf16_f32 v195, v78, v79
    s_mov_b32 exec_lo, 0
    s_mov_b32 exec_hi, 0xffff0000
    v_mov_b32 v190, 0
    v_mov_b32 v191, 0
    v_mov_b32 v194, 0
    v_mov_b32 v195, 0
    s_mov_b64 exec, -1
    s_waitcnt lgkmcnt(0)
    s_barrier
    s_add_u32 m0, s93, 18432
    ds_read_b128 v[224:227], v45
    buffer_load_dwordx4 v17, s[16:19], s90 offen lds
    ds_read_b64 v[204:205], v47 offset:0
    ds_read_b64 v[208:209], v47 offset:8
    ds_read_b128 v[228:231], v46
    ds_read_b64 v[212:213], v48 offset:0
    ds_read_b64 v[216:217], v48 offset:8
    v_mfma_f32_16x16x32_bf16 v[140:143], v[196:199], v[188:191], 0
    v_mfma_f32_16x16x32_bf16 v[144:147], v[200:203], v[192:195], 0
    s_waitcnt lgkmcnt(5)
    v_mfma_f32_16x16x32_bf16 v[132:135], v[224:227], v[188:191], 0
    s_waitcnt lgkmcnt(2)
    v_mfma_f32_16x16x32_bf16 v[136:139], v[228:231], v[192:195], 0
    v_mov_b32 v148, 0xff7fffff
    s_nop 4
    v_cndmask_b32 v152, v140, v132, s[50:51]
    s_nop 0
    v_cndmask_b32 v156, v144, v136, s[50:51]
    v_cndmask_b32 v153, v141, v133, s[52:53]
    v_cndmask_b32 v157, v145, v137, s[52:53]
    v_cndmask_b32 v154, v142, v134, s[54:55]
    v_cndmask_b32 v158, v146, v138, s[54:55]
    v_cndmask_b32 v155, v143, v135, s[56:57]
    v_cndmask_b32 v159, v147, v139, s[56:57]
    v_cndmask_b32 v152, v148, v152, s[58:59]
    v_cndmask_b32 v156, v148, v156, s[58:59]
    v_cndmask_b32 v153, v148, v153, s[60:61]
    v_cndmask_b32 v157, v148, v157, s[60:61]
    v_cndmask_b32 v154, v148, v154, s[62:63]
    v_cndmask_b32 v158, v148, v158, s[62:63]
    v_cndmask_b32 v155, v148, v155, s[64:65]
    v_cndmask_b32 v159, v148, v159, s[64:65]
    v_max3_f32 v160, v152, v153, v154
    v_max3_f32 v161, v156, v157, v158
    s_add_u32 m0, s93, 22528
    v_max_f32 v160, v160, v155
    buffer_load_dwordx4 v18, s[16:19], s90 offen lds
    v_max_f32 v161, v161, v159
    v_mov_b32 v128, v160
    v_mov_b32 v129, v161
    s_nop 0
    v_permlane32_swap_b32 v128, v160
    v_permlane32_swap_b32 v129, v161
    v_max_f32 v160, v128, v160
    v_max_f32 v161, v129, v161
    v_mov_b32 v128, v160
    v_mov_b32 v129, v161
    s_nop 0
    v_permlane16_swap_b32 v128, v160
    v_permlane16_swap_b32 v129, v161
    v_max_f32 v160, v128, v160
    v_max_f32 v161, v129, v161
    v_pk_add_f32 v[152:153], v[152:153], v[160:161] op_sel:[0,0] op_sel_hi:[1,0] neg_lo:[0,1] neg_hi:[0,1]
    v_pk_add_f32 v[154:155], v[154:155], v[160:161] op_sel:[0,0] op_sel_hi:[1,0] neg_lo:[0,1] neg_hi:[0,1]
    v_pk_add_f32 v[156:157], v[156:157], v[160:161] op_sel:[0,1] op_sel_hi:[1,1] neg_lo:[0,1] neg_hi:[0,1]
    v_pk_add_f32 v[158:159], v[158:159], v[160:161] op_sel:[0,1] op_sel_hi:[1,1] neg_lo:[0,1] neg_hi:[0,1]
    v_exp_f32 v152, v152
    v_exp_f32 v153, v153
    v_exp_f32 v154, v154
    v_exp_f32 v155, v155
    v_exp_f32 v156, v156
    v_exp_f32 v157, v157
    v_exp_f32 v158, v158
    v_exp_f32 v159, v159
    s_add_u32 m0, s93, 26624
    v_cvt_pk_bf16_f32 v128, v152, v153
    buffer_load_dwordx4 v19, s[16:19], s90 offen lds
    v_cvt_pk_bf16_f32 v129, v154, v155
    v_cvt_pk_bf16_f32 v130, v156, v157
    v_cvt_pk_bf16_f32 v131, v158, v159
    v_and_b32 v164, v40, v128
    v_and_b32 v165, v41, v129
    v_and_b32 v166, v42, v128
    v_and_b32 v167, v43, v129
    v_and_b32 v168, v40, v130
    v_and_b32 v169, v41, v131
    v_and_b32 v170, v42, v130
    v_and_b32 v171, v43, v131
    v_mfma_f32_16x16x32_bf16 v[172:175], v[204:207], v[164:167], 0
    v_mfma_f32_16x16x32_bf16 v[176:179], v[208:211], v[164:167], 0
    s_waitcnt lgkmcnt(1)
    v_mfma_f32_16x16x32_bf16 v[180:183], v[212:215], v[168:171], 0
    s_waitcnt lgkmcnt(0)
    v_mfma_f32_16x16x32_bf16 v[184:187], v[216:219], v[168:171], 0
    v_add_f32 v162, v152, v153
    v_add_f32 v154, v154, v155
    v_add_f32 v163, v156, v157
    v_add_f32 v158, v158, v159
    v_add_f32 v162, v162, v154
    v_add_f32 v163, v163, v158
    v_mov_b32 v128, v162
    v_mov_b32 v129, v163
    s_nop 0
    v_permlane32_swap_b32 v128, v162
    v_permlane32_swap_b32 v129, v163
    v_add_f32 v162, v128, v162
    v_add_f32 v163, v129, v163
    v_mov_b32 v128, v162
    s_add_u32 m0, s93, 30720
    v_mov_b32 v129, v163
    buffer_load_dwordx4 v20, s[16:19], s90 offen lds
    v_permlane16_swap_b32 v128, v162
    v_permlane16_swap_b32 v129, v163
    v_add_f32 v162, v128, v162
    v_add_f32 v163, v129, v163
    v_rcp_f32 v162, v162
    v_rcp_f32 v163, v163
    s_nop 0
    v_pk_mul_f32 v[172:173], v[172:173], v[162:163] op_sel:[0,0] op_sel_hi:[1,0]
    v_pk_mul_f32 v[174:175], v[174:175], v[162:163] op_sel:[0,0] op_sel_hi:[1,0]
    v_pk_mul_f32 v[176:177], v[176:177], v[162:163] op_sel:[0,0] op_sel_hi:[1,0]
    v_pk_mul_f32 v[178:179], v[178:179], v[162:163] op_sel:[0,0] op_sel_hi:[1,0]
    v_cvt_pk_bf16_f32 v232, v172, v173
    v_cvt_pk_bf16_f32 v233, v174, v175
    v_cvt_pk_bf16_f32 v234, v176, v177
    v_cvt_pk_bf16_f32 v235, v178, v179
    v_pk_mul_f32 v[180:181], v[180:181], v[162:163] op_sel:[0,1] op_sel_hi:[1,1]
    v_pk_mul_f32 v[182:183], v[182:183], v[162:163] op_sel:[0,1] op_sel_hi:[1,1]
    v_pk_mul_f32 v[184:185], v[184:185], v[162:163] op_sel:[0,1] op_sel_hi:[1,1]
    v_pk_mul_f32 v[186:187], v[186:187], v[162:163] op_sel:[0,1] op_sel_hi:[1,1]
    v_cvt_pk_bf16_f32 v236, v180, v181
    v_cvt_pk_bf16_f32 v237, v182, v183
    v_cvt_pk_bf16_f32 v238, v184, v185
    v_cvt_pk_bf16_f32 v239, v186, v187
    s_mov_b32 exec_lo, 0
    s_mov_b32 exec_hi, 0xffff0000
    v_mov_b32 v234, 0
    v_mov_b32 v235, 0
    v_mov_b32 v238, 0
    v_mov_b32 v239, 0
    s_mov_b64 exec, -1
    s_mov_b32 s96, 0
    s_lshl_b32 s72, s40, 3
    s_sub_u32 s73, s72, 8
    s_cmp_eq_u32 s40, 0
    s_cselect_b32 s73, s72, s73
    v_mov_b32 v252, s72
    v_mov_b32 v253, s73
L_reg_10:
    buffer_load_dwordx2 v[248:249], v252, s[32:35], 0 offen sc1
    buffer_load_dwordx2 v[250:251], v253, s[32:35], 0 offen sc1
    s_add_u32 s96, s96, 1
    s_cmp_gt_u32 s96, 200000
    s_cbranch_scc1 L_end
    s_waitcnt vmcnt(0)
    v_readfirstlane_b32 s74, v248
    v_readfirstlane_b32 s75, v249
    v_readfirstlane_b32 s76, v250
    v_readfirstlane_b32 s77, v251
    s_nop 1
    s_add_u32 s78, s74, s75
    s_mul_i32 s78, s78, 0x01010101
    s_lshr_b32 s78, s78, 24
    s_cmp_lt_u32 s78, 16
    s_cbranch_scc1 L_reg_10
    s_add_u32 s78, s76, s77
    s_mul_i32 s78, s78, 0x01010101
    s_lshr_b32 s78, s78, 24
    s_cmp_lt_u32 s78, 16
    s_cbranch_scc1 L_reg_10
    s_or_b32 s78, s74, s75
    s_and_b32 s78, s78, 0x10101010
    s_cmp_lg_u32 s78, 0
    s_cselect_b32 s44, 1, 0
    s_mov_b32 s90, 458752
    s_add_u32 m0, s93, 34816
    s_nop 0
    buffer_load_dwordx4 v14, s[16:19], s90 offen lds
    s_add_u32 m0, s93, 38912
    s_nop 0
    buffer_load_dwordx4 v15, s[16:19], s90 offen lds
    s_add_u32 m0, s93, 43008
    s_nop 0
    buffer_load_dwordx4 v16, s[16:19], s90 offen lds
    s_add_u32 m0, s93, 47104
    s_nop 0
    buffer_load_dwordx4 v17, s[16:19], s90 offen lds
    s_add_u32 m0, s93, 51200
    s_nop 0
    buffer_load_dwordx4 v18, s[16:19], s90 offen lds
    s_cmp_eq_u32 s44, 0
    s_cbranch_scc1 L_st_slow_11
    buffer_store_dwordx4 v[232:235], v2, s[24:27], s84 offen
    buffer_store_dwordx4 v[236:239], v2, s[24:27], s85 offen
    s_branch L_st_done_12
L_st_slow_11:
    buffer_store_dwordx4 v[232:235], v2, s[24:27], s84 offen sc1
    buffer_store_dwordx4 v[236:239], v2, s[24:27], s85 offen sc1
L_st_done_12:
    s_barrier
    s_add_u32 s45, s45, 1
    v_mov_b32 v254, s45
    v_mov_b32 v255, 0
    s_waitcnt vmcnt(0)
    s_mov_b64 exec, 1
    s_cmp_eq_u32 s44, 0
    s_cbranch_scc1 L_sig_slow_13
    buffer_store_dword v254, v255, s[24:27], s94 offen
    s_branch L_sig_done_14
L_sig_slow_13:
    buffer_store_dword v254, v255, s[24:27], s94 offen sc1
L_sig_done_14:
    s_mov_b64 exec, -1
    s_mov_b32 s90, 175616
    s_add_u32 m0, s93, 92160
    s_nop 0
    buffer_load_dwordx4 v7, s[12:15], s90 offen lds
    s_mov_b32 s90, 376320
    s_add_u32 m0, s93, 96256
    s_nop 0
    buffer_load_dwordx4 v7, s[12:15], s90 offen lds
    s_mov_b32 s90, 458752
    s_add_u32 m0, s93, 55296
    s_nop 0
    buffer_load_dwordx4 v19, s[16:19], s90 offen lds
    s_add_u32 m0, s93, 59392
    s_nop 0
    buffer_load_dwordx4 v20, s[16:19], s90 offen lds
    s_mov_b32 s90, 917504
    s_add_u32 m0, s93, 63488
    s_nop 0
    buffer_load_dwordx4 v14, s[16:19], s90 offen lds
    s_add_u32 m0, s93, 67584
    s_nop 0
    buffer_load_dwordx4 v15, s[16:19], s90 offen lds
    s_add_u32 m0, s93, 71680
    s_nop 0
    buffer_load_dwordx4 v16, s[16:19], s90 offen lds
    s_add_u32 m0, s93, 75776
    s_nop 0
    buffer_load_dwordx4 v17, s[16:19], s90 offen lds
    s_add_u32 m0, s93, 79872
    s_nop 0
    buffer_load_dwordx4 v18, s[16:19], s90 offen lds
    s_add_u32 m0, s93, 83968
    s_nop 0
    buffer_load_dwordx4 v19, s[16:19], s90 offen lds
    s_add_u32 m0, s93, 88064
    s_nop 0
    buffer_load_dwordx4 v20, s[16:19], s90 offen lds
    s_xor_b32 s79, s0, 1
    s_mul_i32 s78, s0, 16384
    s_mul_i32 s79, s79, 16384
    s_mul_i32 s81, s49, 8192
    s_add_u32 s81, s81, 0
    s_add_u32 s78, s78, s81
    s_add_u32 s79, s79, s81
    s_mul_i32 s82, s0, 14
    s_add_u32 s82, s82, s71
    s_lshl_b32 s82, s82, 10
    s_lshl_b32 s83, s0, 10
    s_lshl_b32 s84, s47, 3
    s_add_u32 s83, s83, s84
    s_lshl_b32 s72, s47, 7
    s_mov_b32 s96, 0
L_poll_17:
    buffer_load_dword v254, v3, s[24:27], s70 offen sc1
    s_add_u32 s96, s96, 1
    s_cmp_gt_u32 s96, 200000
    s_cbranch_scc1 L_end
    s_waitcnt vmcnt(0)
    v_cmp_gt_u32 vcc, s45, v254
    s_nop 3
    s_and_b64 vcc, vcc, s[68:69]
    s_cbranch_vccnz L_poll_17
    s_cmp_eq_u32 s66, 0
    s_cbranch_scc1 L_wo_idle_15
    buffer_load_dwordx4 a[188:191], v2, s[24:27], s79 offen offset:0 sc1
    buffer_load_dwordx4 a[156:159], v2, s[24:27], s78 offen offset:0 sc1
    buffer_load_dwordx4 a[192:195], v2, s[24:27], s79 offen offset:1024 sc1
    buffer_load_dwordx4 a[160:163], v2, s[24:27], s78 offen offset:1024 sc1
    buffer_load_dwordx4 a[196:199], v2, s[24:27], s79 offen offset:2048 sc1
    buffer_load_dwordx4 a[164:167], v2, s[24:27], s78 offen offset:2048 sc1
    buffer_load_dwordx4 a[200:203], v2, s[24:27], s79 offen offset:3072 sc1
    buffer_load_dwordx4 a[168:171], v2, s[24:27], s78 offen offset:3072 sc1
    s_barrier
    s_mul_i32 s73, s49, 24576
    s_add_u32 s73, s73, 14336
    v_subrev_u32 v208, s73, v8
    v_subrev_u32 v209, s73, v9
    v_subrev_u32 v210, s73, v10
    v_subrev_u32 v211, s73, v11
    ds_read_b64_tr_b16 v[212:213], v8 offset:0
    ds_read_b64_tr_b16 v[214:215], v8 offset:2048
    ds_read_b64_tr_b16 v[216:217], v9 offset:0
    ds_read_b64_tr_b16 v[218:219], v9 offset:2048
    ds_read_b64_tr_b16 v[220:221], v10 offset:0
    ds_read_b64_tr_b16 v[222:223], v10 offset:2048
    ds_read_b64_tr_b16 v[224:225], v11 offset:0
    ds_read_b64_tr_b16 v[226:227], v11 offset:2048
    ds_read_b64_tr_b16 v[228:229], v8 offset:4096
    ds_read_b64_tr_b16 v[230:231], v8 offset:6144
    ds_read_b64_tr_b16 v[232:233], v9 offset:4096
    ds_read_b64_tr_b16 v[234:235], v9 offset:6144
    s_waitcnt lgkmcnt(8)
    s_waitcnt vmcnt(6)
    v_mfma_f32_16x16x32_bf16 v[64:67], v[212:215], a[156:159], 0
    ds_read_b64_tr_b16 v[236:237], v10 offset:4096
    v_mfma_f32_16x16x32_bf16 v[80:83], v[212:215], a[188:191], 0
    ds_read_b64_tr_b16 v[238:239], v10 offset:6144
    s_add_u32 s78, s78, 4096
    s_add_u32 s79, s79, 4096
    buffer_load_dwordx4 a[204:207], v2, s[24:27], s79 offen offset:0 sc1
    v_mfma_f32_16x16x32_bf16 v[68:71], v[216:219], a[156:159], 0
    ds_read_b64_tr_b16 v[240:241], v11 offset:4096
    v_mfma_f32_16x16x32_bf16 v[84:87], v[216:219], a[188:191], 0
    ds_read_b64_tr_b16 v[242:243], v11 offset:6144
    buffer_load_dwordx4 a[172:175], v2, s[24:27], s78 offen offset:0 sc1
    s_waitcnt lgkmcnt(8)
    v_mfma_f32_16x16x32_bf16 v[72:75], v[220:223], a[156:159], 0
    ds_read_b64_tr_b16 v[212:213], v8 offset:8192
    v_mfma_f32_16x16x32_bf16 v[88:91], v[220:223], a[188:191], 0
    ds_read_b64_tr_b16 v[214:215], v8 offset:10240
    buffer_load_dwordx4 a[208:211], v2, s[24:27], s79 offen offset:1024 sc1
    v_mfma_f32_16x16x32_bf16 v[76:79], v[224:227], a[156:159], 0
    ds_read_b64_tr_b16 v[216:217], v9 offset:8192
    v_mfma_f32_16x16x32_bf16 v[92:95], v[224:227], a[188:191], 0
    ds_read_b64_tr_b16 v[218:219], v9 offset:10240
    buffer_load_dwordx4 a[176:179], v2, s[24:27], s78 offen offset:1024 sc1
    s_waitcnt lgkmcnt(8)
    s_waitcnt vmcnt(8)
    v_mfma_f32_16x16x32_bf16 v[64:67], v[228:231], a[160:163], v[64:67]
    ds_read_b64_tr_b16 v[220:221], v10 offset:8192
    v_mfma_f32_16x16x32_bf16 v[80:83], v[228:231], a[192:195], v[80:83]
    ds_read_b64_tr_b16 v[222:223], v10 offset:10240
    buffer_load_dwordx4 a[212:215], v2, s[24:27], s79 offen offset:2048 sc1
    v_mfma_f32_16x16x32_bf16 v[68:71], v[232:235], a[160:163], v[68:71]
    ds_read_b64_tr_b16 v[224:225], v11 offset:8192
    v_mfma_f32_16x16x32_bf16 v[84:87], v[232:235], a[192:195], v[84:87]
    ds_read_b64_tr_b16 v[226:227], v11 offset:10240
    buffer_load_dwordx4 a[180:183], v2, s[24:27], s78 offen offset:2048 sc1
    s_waitcnt lgkmcnt(8)
    v_mfma_f32_16x16x32_bf16 v[72:75], v[236:239], a[160:163], v[72:75]
    ds_read_b64_tr_b16 v[228:229], v8 offset:12288
    v_mfma_f32_16x16x32_bf16 v[88:91], v[236:239], a[192:195], v[88:91]
    ds_read_b64_tr_b16 v[230:231], v8 offset:14336
    buffer_load_dwordx4 a[216:219], v2, s[24:27], s79 offen offset:3072 sc1
    v_mfma_f32_16x16x32_bf16 v[76:79], v[240:243], a[160:163], v[76:79]
    ds_read_b64_tr_b16 v[232:233], v9 offset:12288
    v_mfma_f32_16x16x32_bf16 v[92:95], v[240:243], a[192:195], v[92:95]
    ds_read_b64_tr_b16 v[234:235], v9 offset:14336
    buffer_load_dwordx4 a[184:187], v2, s[24:27], s78 offen offset:3072 sc1
    s_waitcnt lgkmcnt(8)
    s_waitcnt vmcnt(10)
    v_mfma_f32_16x16x32_bf16 v[64:67], v[212:215], a[164:167], v[64:67]
    ds_read_b64_tr_b16 v[236:237], v10 offset:12288
    v_mfma_f32_16x16x32_bf16 v[80:83], v[212:215], a[196:199], v[80:83]
    ds_read_b64_tr_b16 v[238:239], v10 offset:14336
    buffer_load_dwordx2 v[200:201], v51, s[4:7], s72 offen offset:0
    v_mfma_f32_16x16x32_bf16 v[68:71], v[216:219], a[164:167], v[68:71]
    ds_read_b64_tr_b16 v[240:241], v11 offset:12288
    v_mfma_f32_16x16x32_bf16 v[84:87], v[216:219], a[196:199], v[84:87]
    ds_read_b64_tr_b16 v[242:243], v11 offset:14336
    buffer_load_dwordx2 v[202:203], v51, s[4:7], s72 offen offset:32
    s_waitcnt lgkmcnt(8)
    v_mfma_f32_16x16x32_bf16 v[72:75], v[220:223], a[164:167], v[72:75]
    ds_read_b64_tr_b16 v[212:213], v8 offset:16384
    v_mfma_f32_16x16x32_bf16 v[88:91], v[220:223], a[196:199], v[88:91]
    ds_read_b64_tr_b16 v[214:215], v8 offset:18432
    buffer_load_dwordx2 v[204:205], v51, s[4:7], s72 offen offset:64
    v_mfma_f32_16x16x32_bf16 v[76:79], v[224:227], a[164:167], v[76:79]
    ds_read_b64_tr_b16 v[216:217], v9 offset:16384
    v_mfma_f32_16x16x32_bf16 v[92:95], v[224:227], a[196:199], v[92:95]
    ds_read_b64_tr_b16 v[218:219], v9 offset:18432
    buffer_load_dwordx2 v[206:207], v51, s[4:7], s72 offen offset:96
    s_waitcnt lgkmcnt(8)
    s_waitcnt vmcnt(12)
    v_mfma_f32_16x16x32_bf16 v[64:67], v[228:231], a[168:171], v[64:67]
    ds_read_b64_tr_b16 v[220:221], v10 offset:16384
    v_mfma_f32_16x16x32_bf16 v[80:83], v[228:231], a[200:203], v[80:83]
    ds_read_b64_tr_b16 v[222:223], v10 offset:18432
    v_mfma_f32_16x16x32_bf16 v[68:71], v[232:235], a[168:171], v[68:71]
    ds_read_b64_tr_b16 v[224:225], v11 offset:16384
    v_mfma_f32_16x16x32_bf16 v[84:87], v[232:235], a[200:203], v[84:87]
    ds_read_b64_tr_b16 v[226:227], v11 offset:18432
    s_waitcnt lgkmcnt(8)
    v_mfma_f32_16x16x32_bf16 v[72:75], v[236:239], a[168:171], v[72:75]
    ds_read_b64_tr_b16 v[228:229], v8 offset:20480
    v_mfma_f32_16x16x32_bf16 v[88:91], v[236:239], a[200:203], v[88:91]
    ds_read_b64_tr_b16 v[230:231], v8 offset:22528
    v_mfma_f32_16x16x32_bf16 v[76:79], v[240:243], a[168:171], v[76:79]
    ds_read_b64_tr_b16 v[232:233], v9 offset:20480
    v_mfma_f32_16x16x32_bf16 v[92:95], v[240:243], a[200:203], v[92:95]
    ds_read_b64_tr_b16 v[234:235], v9 offset:22528
    s_waitcnt lgkmcnt(8)
    s_waitcnt vmcnt(10)
    v_mfma_f32_16x16x32_bf16 v[64:67], v[212:215], a[172:175], v[64:67]
    ds_read_b64_tr_b16 v[236:237], v10 offset:20480
    v_mfma_f32_16x16x32_bf16 v[80:83], v[212:215], a[204:207], v[80:83]
    ds_read_b64_tr_b16 v[238:239], v10 offset:22528
    v_mfma_f32_16x16x32_bf16 v[68:71], v[216:219], a[172:175], v[68:71]
    ds_read_b64_tr_b16 v[240:241], v11 offset:20480
    v_mfma_f32_16x16x32_bf16 v[84:87], v[216:219], a[204:207], v[84:87]
    ds_read_b64_tr_b16 v[242:243], v11 offset:22528
    s_waitcnt lgkmcnt(8)
    v_mfma_f32_16x16x32_bf16 v[72:75], v[220:223], a[172:175], v[72:75]
    ds_read_b64_tr_b16 v[212:213], v8 offset:24576
    v_mfma_f32_16x16x32_bf16 v[88:91], v[220:223], a[204:207], v[88:91]
    ds_read_b64_tr_b16 v[214:215], v8 offset:26624
    v_mfma_f32_16x16x32_bf16 v[76:79], v[224:227], a[172:175], v[76:79]
    ds_read_b64_tr_b16 v[216:217], v9 offset:24576
    v_mfma_f32_16x16x32_bf16 v[92:95], v[224:227], a[204:207], v[92:95]
    ds_read_b64_tr_b16 v[218:219], v9 offset:26624
    s_waitcnt lgkmcnt(8)
    s_waitcnt vmcnt(8)
    v_mfma_f32_16x16x32_bf16 v[64:67], v[228:231], a[176:179], v[64:67]
    ds_read_b64_tr_b16 v[220:221], v10 offset:24576
    v_mfma_f32_16x16x32_bf16 v[80:83], v[228:231], a[208:211], v[80:83]
    ds_read_b64_tr_b16 v[222:223], v10 offset:26624
    v_mfma_f32_16x16x32_bf16 v[68:71], v[232:235], a[176:179], v[68:71]
    ds_read_b64_tr_b16 v[224:225], v11 offset:24576
    v_mfma_f32_16x16x32_bf16 v[84:87], v[232:235], a[208:211], v[84:87]
    ds_read_b64_tr_b16 v[226:227], v11 offset:26624
    s_waitcnt lgkmcnt(8)
    v_mfma_f32_16x16x32_bf16 v[72:75], v[236:239], a[176:179], v[72:75]
    ds_read_b64_tr_b16 v[228:229], v208 offset:0
    v_mfma_f32_16x16x32_bf16 v[88:91], v[236:239], a[208:211], v[88:91]
    ds_read_b64_tr_b16 v[230:231], v208 offset:2048
    v_mfma_f32_16x16x32_bf16 v[76:79], v[240:243], a[176:179], v[76:79]
    ds_read_b64_tr_b16 v[232:233], v209 offset:0
    v_mfma_f32_16x16x32_bf16 v[92:95], v[240:243], a[208:211], v[92:95]
    ds_read_b64_tr_b16 v[234:235], v209 offset:2048
    s_waitcnt lgkmcnt(8)
    s_waitcnt vmcnt(6)
    v_mfma_f32_16x16x32_bf16 v[64:67], v[212:215], a[180:183], v[64:67]
    ds_read_b64_tr_b16 v[236:237], v210 offset:0
    v_mfma_f32_16x16x32_bf16 v[80:83], v[212:215], a[212:215], v[80:83]
    ds_read_b64_tr_b16 v[238:239], v210 offset:2048
    v_mfma_f32_16x16x32_bf16 v[68:71], v[216:219], a[180:183], v[68:71]
    ds_read_b64_tr_b16 v[240:241], v211 offset:0
    v_mfma_f32_16x16x32_bf16 v[84:87], v[216:219], a[212:215], v[84:87]
    ds_read_b64_tr_b16 v[242:243], v211 offset:2048
    s_waitcnt lgkmcnt(8)
    v_mfma_f32_16x16x32_bf16 v[72:75], v[220:223], a[180:183], v[72:75]
    v_mfma_f32_16x16x32_bf16 v[88:91], v[220:223], a[212:215], v[88:91]
    v_mfma_f32_16x16x32_bf16 v[76:79], v[224:227], a[180:183], v[76:79]
    v_mfma_f32_16x16x32_bf16 v[92:95], v[224:227], a[212:215], v[92:95]
    s_waitcnt lgkmcnt(4)
    s_waitcnt vmcnt(4)
    v_mfma_f32_16x16x32_bf16 v[64:67], v[228:231], a[184:187], v[64:67]
    v_mfma_f32_16x16x32_bf16 v[80:83], v[228:231], a[216:219], v[80:83]
    v_mfma_f32_16x16x32_bf16 v[68:71], v[232:235], a[184:187], v[68:71]
    v_mfma_f32_16x16x32_bf16 v[84:87], v[232:235], a[216:219], v[84:87]
    s_waitcnt lgkmcnt(0)
    v_mfma_f32_16x16x32_bf16 v[72:75], v[236:239], a[184:187], v[72:75]
    v_mfma_f32_16x16x32_bf16 v[88:91], v[236:239], a[216:219], v[88:91]
    v_mfma_f32_16x16x32_bf16 v[76:79], v[240:243], a[184:187], v[76:79]
    v_mfma_f32_16x16x32_bf16 v[92:95], v[240:243], a[216:219], v[92:95]
    s_barrier
    ds_write_b128 v49, v[80:83] offset:0
    s_nop 0
    ds_write_b128 v49, v[84:87] offset:1024
    s_nop 1
    ds_write_b128 v49, v[88:91] offset:2048
    s_nop 0
    ds_write_b128 v49, v[92:95] offset:3072
    s_waitcnt vmcnt(3)
    v_lshlrev_b32 v160, 16, v200
    v_and_b32 v161, 0xffff0000, v200
    v_lshlrev_b32 v162, 16, v201
    v_and_b32 v163, 0xffff0000, v201
    s_waitcnt vmcnt(2)
    v_lshlrev_b32 v164, 16, v202
    v_and_b32 v165, 0xffff0000, v202
    v_lshlrev_b32 v166, 16, v203
    v_and_b32 v167, 0xffff0000, v203
    s_waitcnt vmcnt(1)
    v_lshlrev_b32 v168, 16, v204
    v_and_b32 v169, 0xffff0000, v204
    v_lshlrev_b32 v170, 16, v205
    v_and_b32 v171, 0xffff0000, v205
    s_waitcnt vmcnt(0)
    v_lshlrev_b32 v172, 16, v206
    v_and_b32 v173, 0xffff0000, v206
    v_lshlrev_b32 v174, 16, v207
    s_mov_b32 s90, 1376256
    s_add_u32 m0, s93, 92160
    v_and_b32 v175, 0xffff0000, v207
    buffer_load_dwordx4 v14, s[16:19], s90 offen lds
    v_pk_add_f32 v[64:65], v[64:65], v[160:161]
    v_pk_add_f32 v[66:67], v[66:67], v[162:163]
    v_pk_add_f32 v[68:69], v[68:69], v[164:165]
    v_pk_add_f32 v[70:71], v[70:71], v[166:167]
    v_pk_add_f32 v[72:73], v[72:73], v[168:169]
    v_pk_add_f32 v[74:75], v[74:75], v[170:171]
    v_pk_add_f32 v[76:77], v[76:77], v[172:173]
    v_pk_add_f32 v[78:79], v[78:79], v[174:175]
    s_add_u32 s82, s82, 2097152
    s_add_u32 s83, s83, 13631488
    s_waitcnt lgkmcnt(0)
    s_barrier
    ds_read_b128 v[128:131], v50 offset:0
    ds_read_b128 v[132:135], v50 offset:1024
    ds_read_b128 v[136:139], v50 offset:2048
    ds_read_b128 v[140:143], v50 offset:3072
    v_and_b32 v190, 15, v57
    v_lshlrev_b32 v190, 6, v190
    s_add_u32 m0, s93, 96256
    s_waitcnt lgkmcnt(3)
    v_pk_add_f32 v[64:65], v[64:65], v[128:129]
    buffer_load_dwordx4 v15, s[16:19], s90 offen lds
    v_pk_add_f32 v[66:67], v[66:67], v[130:131]
    s_waitcnt lgkmcnt(2)
    v_pk_add_f32 v[68:69], v[68:69], v[132:133]
    v_pk_add_f32 v[70:71], v[70:71], v[134:135]
    s_waitcnt lgkmcnt(1)
    v_pk_add_f32 v[72:73], v[72:73], v[136:137]
    v_pk_add_f32 v[74:75], v[74:75], v[138:139]
    s_waitcnt lgkmcnt(0)
    v_pk_add_f32 v[76:77], v[76:77], v[140:141]
    v_pk_add_f32 v[78:79], v[78:79], v[142:143]
    v_cvt_pk_bf16_f32 v176, v64, v65
    v_cvt_pk_bf16_f32 v177, v66, v67
    v_cvt_pk_bf16_f32 v178, v68, v69
    v_cvt_pk_bf16_f32 v179, v70, v71
    v_cvt_pk_bf16_f32 v180, v72, v73
    v_cvt_pk_bf16_f32 v181, v74, v75
    v_cvt_pk_bf16_f32 v182, v76, v77
    v_cvt_pk_bf16_f32 v183, v78, v79
    s_add_u32 m0, s93, 100352
    s_nop 0
    buffer_load_dwordx4 v16, s[16:19], s90 offen lds
    s_cmp_eq_u32 s44, 0
    s_cbranch_scc1 L_st_slow_18
    buffer_store_dwordx4 v[176:179], v2, s[24:27], s82 offen offset:0
    buffer_store_dwordx4 v[180:183], v2, s[24:27], s82 offen offset:1024
    s_branch L_st_done_19
L_st_slow_18:
    buffer_store_dwordx4 v[176:179], v2, s[24:27], s82 offen offset:0 sc1
    buffer_store_dwordx4 v[180:183], v2, s[24:27], s82 offen offset:1024 sc1
L_st_done_19:
    v_pk_mul_f32 v[192:193], v[64:65], v[64:65]
    v_pk_fma_f32 v[192:193], v[66:67], v[66:67], v[192:193]
    v_pk_add_f32 v[184:185], v[64:65], v[66:67]
    v_pk_fma_f32 v[192:193], v[68:69], v[68:69], v[192:193]
    v_pk_add_f32 v[184:185], v[184:185], v[68:69]
    v_pk_fma_f32 v[192:193], v[70:71], v[70:71], v[192:193]
    v_pk_add_f32 v[184:185], v[184:185], v[70:71]
    v_pk_fma_f32 v[192:193], v[72:73], v[72:73], v[192:193]
    v_pk_add_f32 v[184:185], v[184:185], v[72:73]
    v_pk_fma_f32 v[192:193], v[74:75], v[74:75], v[192:193]
    v_pk_add_f32 v[184:185], v[184:185], v[74:75]
    v_pk_fma_f32 v[192:193], v[76:77], v[76:77], v[192:193]
    v_pk_add_f32 v[184:185], v[184:185], v[76:77]
    v_pk_fma_f32 v[192:193], v[78:79], v[78:79], v[192:193]
    v_pk_add_f32 v[184:185], v[184:185], v[78:79]
    v_add_f32 v188, v184, v185
    v_add_f32 v189, v192, v193
    v_mov_b32 v190, 0
    v_mov_b32 v191, 0
    v_and_b32 v185, 15, v57
    v_lshlrev_b32 v185, 6, v185
    v_mov_b32 v186, v188
    v_mov_b32 v187, v189
    s_nop 0
    v_permlane32_swap_b32 v186, v188
    v_permlane32_swap_b32 v187, v189
    v_add_f32 v188, v186, v188
    v_add_f32 v189, v187, v189
    v_mov_b32 v186, v188
    v_mov_b32 v187, v189
    s_nop 0
    v_permlane16_swap_b32 v186, v188
    v_permlane16_swap_b32 v187, v189
    v_add_f32 v188, v186, v188
    v_add_f32 v189, v187, v189
    s_cmp_eq_u32 s47, 6
    s_cbranch_scc1 L_st_last_20
    s_cmp_eq_u32 s44, 0
    s_cbranch_scc1 L_st_slow_22
    s_mov_b64 exec, s[98:99]
    buffer_store_dwordx2 v[188:189], v185, s[24:27], s83 offen
    s_mov_b64 exec, -1
    s_branch L_st_done_23
L_st_slow_22:
    s_mov_b64 exec, s[98:99]
    buffer_store_dwordx2 v[188:189], v185, s[24:27], s83 offen sc1
    s_mov_b64 exec, -1
L_st_done_23:
    s_branch L_st_join_21
L_st_last_20:
    s_cmp_eq_u32 s44, 0
    s_cbranch_scc1 L_st_slow_24
    s_mov_b64 exec, s[98:99]
    buffer_store_dwordx4 v[188:191], v185, s[24:27], s83 offen
    s_mov_b64 exec, -1
    s_branch L_st_done_25
L_st_slow_24:
    s_mov_b64 exec, s[98:99]
    buffer_store_dwordx4 v[188:191], v185, s[24:27], s83 offen sc1
    s_mov_b64 exec, -1
L_st_done_25:
L_st_join_21:
    s_add_u32 s45, s45, 1
    v_mov_b32 v254, s45
    v_mov_b32 v255, 0
    s_waitcnt vmcnt(0)
    s_mov_b64 exec, 1
    s_cmp_eq_u32 s44, 0
    s_cbranch_scc1 L_sig_slow_26
    buffer_store_dword v254, v255, s[24:27], s94 offen
    s_branch L_sig_done_27
L_sig_slow_26:
    buffer_store_dword v254, v255, s[24:27], s94 offen sc1
L_sig_done_27:
    s_mov_b64 exec, -1
    s_mov_b32 s90, 802816
    s_add_u32 m0, s93, 135168
    s_nop 0
    buffer_load_dwordx4 v7, s[20:23], s90 offen lds
    s_mov_b32 s90, 831488
    s_add_u32 m0, s93, 139264
    s_nop 0
    buffer_load_dwordx4 v7, s[20:23], s90 offen lds
    s_mov_b32 s90, 860160
    s_add_u32 m0, s93, 143360
    s_nop 0
    buffer_load_dwordx4 v7, s[20:23], s90 offen lds
    s_mov_b32 s90, 888832
    s_add_u32 m0, s93, 147456
    s_nop 0
    buffer_load_dwordx4 v7, s[20:23], s90 offen lds
    s_mov_b32 s90, 114688
    s_add_u32 m0, s93, 122880
    s_nop 0
    buffer_load_dwordx4 v7, s[20:23], s90 offen lds
    s_mov_b32 s90, 917504
    s_add_u32 m0, s93, 151552
    s_nop 0
    buffer_load_dwordx4 v7, s[20:23], s90 offen lds
    s_mov_b32 s90, 143360
    s_add_u32 m0, s93, 126976
    s_nop 0
    buffer_load_dwordx4 v7, s[20:23], s90 offen lds
    s_mov_b32 s90, 946176
    s_add_u32 m0, s93, 155648
    s_nop 0
    buffer_load_dwordx4 v7, s[20:23], s90 offen lds
    s_mov_b32 s90, 172032
    s_add_u32 m0, s93, 131072
    s_nop 0
    buffer_load_dwordx4 v7, s[20:23], s90 offen lds
    s_mov_b32 s90, 974848
    s_add_u32 m0, s93, 159744
    s_nop 0
    buffer_load_dwordx4 v7, s[20:23], s90 offen lds
    s_branch L_wo_join_16
L_wo_idle_15:
    s_barrier
    s_mov_b32 s90, 1376256
    s_add_u32 m0, s93, 92160
    s_nop 0
    buffer_load_dwordx4 v14, s[16:19], s90 offen lds
    s_add_u32 m0, s93, 96256
    s_nop 0
    buffer_load_dwordx4 v15, s[16:19], s90 offen lds
    s_add_u32 m0, s93, 100352
    s_nop 0
    buffer_load_dwordx4 v16, s[16:19], s90 offen lds
    s_add_u32 s45, s45, 1
    v_mov_b32 v254, s45
    v_mov_b32 v255, 0
    s_waitcnt vmcnt(0)
    s_mov_b64 exec, 1
    s_cmp_eq_u32 s44, 0
    s_cbranch_scc1 L_sig_slow_28
    buffer_store_dword v254, v255, s[24:27], s94 offen
    s_branch L_sig_done_29
L_sig_slow_28:
    buffer_store_dword v254, v255, s[24:27], s94 offen sc1
L_sig_done_29:
    s_mov_b64 exec, -1
L_wo_join_16:
    s_cmp_ge_u32 s42, 2
    s_cbranch_scc1 L_skip_30
    s_mov_b32 s90, 1376256
    s_add_u32 m0, s93, 104448
    s_nop 0
    buffer_load_dwordx4 v17, s[16:19], s90 offen lds
L_skip_30:
    s_mul_i32 s78, s3, 14336
    s_add_u32 s78, s78, 2097152
    s_add_u32 s79, s78, 14336
    s_lshl_b32 s80, s3, 10
    s_add_u32 s80, s80, 13631488
    s_mul_i32 s82, s41, 7
    s_lshr_b32 s82, s82, 1
    s_mul_i32 s83, s3, 56
    s_add_u32 s82, s82, s83
    s_lshl_b32 s82, s82, 10
    s_add_u32 s82, s82, 4194304
    s_add_u32 s83, s82, 57344
    s_mov_b32 s96, 0
L_poll_31:
    buffer_load_dword v254, v3, s[24:27], s70 offen sc1
    s_add_u32 s96, s96, 1
    s_cmp_gt_u32 s96, 200000
    s_cbranch_scc1 L_end
    s_waitcnt vmcnt(0)
    v_cmp_gt_u32 vcc, s45, v254
    s_nop 3
    s_and_b64 vcc, vcc, s[36:37]
    s_cbranch_vccnz L_poll_31
    buffer_load_dwordx4 a[4:7], v2, s[24:27], s79 offen offset:0 sc1
    buffer_load_dwordx4 a[0:3], v2, s[24:27], s78 offen offset:0 sc1
    buffer_load_dwordx4 a[12:15], v2, s[24:27], s79 offen offset:1024 sc1
    buffer_load_dwordx4 a[8:11], v2, s[24:27], s78 offen offset:1024 sc1
    buffer_load_dwordx4 a[20:23], v2, s[24:27], s79 offen offset:2048 sc1
    buffer_load_dwordx4 a[16:19], v2, s[24:27], s78 offen offset:2048 sc1
    buffer_load_dwordx4 a[28:31], v2, s[24:27], s79 offen offset:3072 sc1
    buffer_load_dwordx4 a[24:27], v2, s[24:27], s78 offen offset:3072 sc1
    s_waitcnt lgkmcnt(0)
    s_barrier
    buffer_load_dwordx4 v[200:203], v52, s[24:27], s80 offen sc1
    s_add_u32 s80, s80, 1024
    buffer_load_dwordx4 v[204:207], v52, s[24:27], s80 offen sc1
    v_mov_b32 v192, 0x3f803f80
    v_mov_b32 v193, 0x3f803f80
    v_mov_b32 v194, 0x3f803f80
    v_mov_b32 v195, 0x3f803f80
    s_mul_i32 s89, s42, 7168
    v_add_u32 v196, s89, v38
    s_lshr_b32 s89, s42, 1
    s_add_u32 s89, s89, 12
    s_mul_i32 s89, s89, 7168
    s_and_b32 s88, s42, 1
    s_lshl_b32 s88, s88, 7
    s_add_u32 s89, s89, s88
    v_add_u32 v197, s89, v38
    ds_read_b64_tr_b16 v[208:209], v38 offset:0
    ds_read_b64_tr_b16 v[210:211], v38 offset:3584
    ds_read_b64_tr_b16 v[212:213], v38 offset:32
    ds_read_b64_tr_b16 v[214:215], v38 offset:3616
    ds_read_b64_tr_b16 v[216:217], v38 offset:64
    ds_read_b64_tr_b16 v[218:219], v38 offset:3648
    ds_read_b64_tr_b16 v[220:221], v38 offset:96
    ds_read_b64_tr_b16 v[222:223], v38 offset:3680
    ds_read_b64_tr_b16 v[224:225], v38 offset:128
    ds_read_b64_tr_b16 v[226:227], v38 offset:3712
    ds_read_b64_tr_b16 v[228:229], v38 offset:160
    ds_read_b64_tr_b16 v[230:231], v38 offset:3744
    s_waitcnt lgkmcnt(8)
    s_waitcnt vmcnt(8)
    v_mfma_f32_16x16x32_bf16 v[64:67], v[208:211], a[0:3], 0
    ds_read_b64_tr_b16 v[232:233], v38 offset:192
    v_mfma_f32_16x16x32_bf16 v[92:95], v[208:211], a[4:7], 0
    ds_read_b64_tr_b16 v[234:235], v38 offset:3776
    ds_read_b64_tr_b16 v[176:177], v58 offset:0
    ds_read_b64_tr_b16 v[178:179], v58 offset:3584
    s_add_u32 s78, s78, 4096
    s_add_u32 s79, s79, 4096
    buffer_load_dwordx4 a[36:39], v2, s[24:27], s79 offen offset:0 sc1
    v_mfma_f32_16x16x32_bf16 v[68:71], v[212:215], a[0:3], 0
    ds_read_b64_tr_b16 v[236:237], v38 offset:7168
    v_mfma_f32_16x16x32_bf16 v[96:99], v[212:215], a[4:7], 0
    ds_read_b64_tr_b16 v[238:239], v38 offset:10752
    ds_read_b64_tr_b16 v[180:181], v58 offset:32
    s_waitcnt lgkmcnt(8)
    v_mfma_f32_16x16x32_bf16 v[72:75], v[216:219], a[0:3], 0
    ds_read_b64_tr_b16 v[208:209], v38 offset:7200
    v_mfma_f32_16x16x32_bf16 v[100:103], v[216:219], a[4:7], 0
    ds_read_b64_tr_b16 v[210:211], v38 offset:10784
    ds_read_b64_tr_b16 v[182:183], v58 offset:3616
    buffer_load_dwordx4 a[32:35], v2, s[24:27], s78 offen offset:0 sc1
    v_mfma_f32_16x16x32_bf16 v[76:79], v[220:223], a[0:3], 0
    ds_read_b64_tr_b16 v[212:213], v38 offset:7232
    v_mfma_f32_16x16x32_bf16 v[104:107], v[220:223], a[4:7], 0
    ds_read_b64_tr_b16 v[214:215], v38 offset:10816
    ds_read_b64_tr_b16 a[156:157], v196 offset:0
    ds_read_b64_tr_b16 a[158:159], v196 offset:3584
    s_waitcnt lgkmcnt(8)
    v_mfma_f32_16x16x32_bf16 v[80:83], v[224:227], a[0:3], 0
    ds_read_b64_tr_b16 v[216:217], v38 offset:7264
    v_mfma_f32_16x16x32_bf16 v[108:111], v[224:227], a[4:7], 0
    ds_read_b64_tr_b16 v[218:219], v38 offset:10848
    ds_read_b64_tr_b16 a[160:161], v196 offset:32
    ds_read_b64_tr_b16 a[162:163], v196 offset:3616
    buffer_load_dwordx4 a[44:47], v2, s[24:27], s79 offen offset:1024 sc1
    v_mfma_f32_16x16x32_bf16 v[84:87], v[228:231], a[0:3], 0
    ds_read_b64_tr_b16 v[220:221], v38 offset:7296
    v_mfma_f32_16x16x32_bf16 v[112:115], v[228:231], a[4:7], 0
    ds_read_b64_tr_b16 v[222:223], v38 offset:10880
    s_waitcnt lgkmcnt(8)
    v_mfma_f32_16x16x32_bf16 v[88:91], v[232:235], a[0:3], 0
    ds_read_b64_tr_b16 v[224:225], v38 offset:7328
    v_mfma_f32_16x16x32_bf16 v[116:119], v[232:235], a[4:7], 0
    ds_read_b64_tr_b16 v[226:227], v38 offset:10912
    buffer_load_dwordx4 a[40:43], v2, s[24:27], s78 offen offset:1024 sc1
    s_waitcnt vmcnt(10)
    v_mfma_f32_16x16x32_bf16 v[64:67], v[236:239], a[8:11], v[64:67]
    ds_read_b64_tr_b16 v[228:229], v38 offset:7360
    v_mfma_f32_16x16x32_bf16 v[92:95], v[236:239], a[12:15], v[92:95]
    ds_read_b64_tr_b16 v[230:231], v38 offset:10944
    ds_read_b64_tr_b16 v[184:185], v58 offset:7168
    ds_read_b64_tr_b16 v[186:187], v58 offset:10752
    s_waitcnt lgkmcnt(8)
    v_mfma_f32_16x16x32_bf16 v[68:71], v[208:211], a[8:11], v[68:71]
    ds_read_b64_tr_b16 v[232:233], v38 offset:14336
    v_mfma_f32_16x16x32_bf16 v[96:99], v[208:211], a[12:15], v[96:99]
    ds_read_b64_tr_b16 v[234:235], v38 offset:17920
    v_mfma_f32_16x16x32_bf16 v[240:243], v[176:179], v[192:195], 0
    ds_read_b64_tr_b16 v[188:189], v58 offset:7200
    buffer_load_dwordx4 a[52:55], v2, s[24:27], s79 offen offset:2048 sc1
    v_mfma_f32_16x16x32_bf16 v[72:75], v[212:215], a[8:11], v[72:75]
    ds_read_b64_tr_b16 v[236:237], v38 offset:14368
    v_mfma_f32_16x16x32_bf16 v[100:103], v[212:215], a[12:15], v[100:103]
    ds_read_b64_tr_b16 v[238:239], v38 offset:17952
    ds_read_b64_tr_b16 v[190:191], v58 offset:10784
    v_mfma_f32_16x16x32_bf16 v[244:247], v[180:183], v[192:195], 0
    s_waitcnt lgkmcnt(8)
    v_mfma_f32_16x16x32_bf16 v[76:79], v[216:219], a[8:11], v[76:79]
    ds_read_b64_tr_b16 v[208:209], v38 offset:14400
    v_mfma_f32_16x16x32_bf16 v[104:107], v[216:219], a[12:15], v[104:107]
    ds_read_b64_tr_b16 v[210:211], v38 offset:17984
    ds_read_b64_tr_b16 a[164:165], v196 offset:64
    ds_read_b64_tr_b16 a[166:167], v196 offset:3648
    v_mfma_f32_16x16x32_bf16 v[80:83], v[220:223], a[8:11], v[80:83]
    ds_read_b64_tr_b16 v[212:213], v38 offset:14432
    v_mfma_f32_16x16x32_bf16 v[108:111], v[220:223], a[12:15], v[108:111]
    ds_read_b64_tr_b16 v[214:215], v38 offset:18016
    ds_read_b64_tr_b16 a[168:169], v196 offset:96
    ds_read_b64_tr_b16 a[170:171], v196 offset:3680
    buffer_load_dwordx4 a[48:51], v2, s[24:27], s78 offen offset:2048 sc1
    s_waitcnt lgkmcnt(8)
    v_mfma_f32_16x16x32_bf16 v[84:87], v[224:227], a[8:11], v[84:87]
    ds_read_b64_tr_b16 v[216:217], v38 offset:14464
    v_mfma_f32_16x16x32_bf16 v[112:115], v[224:227], a[12:15], v[112:115]
    ds_read_b64_tr_b16 v[218:219], v38 offset:18048
    v_mfma_f32_16x16x32_bf16 v[88:91], v[228:231], a[8:11], v[88:91]
    ds_read_b64_tr_b16 v[220:221], v38 offset:14496
    v_mfma_f32_16x16x32_bf16 v[116:119], v[228:231], a[12:15], v[116:119]
    ds_read_b64_tr_b16 v[222:223], v38 offset:18080
    buffer_load_dwordx4 a[60:63], v2, s[24:27], s79 offen offset:3072 sc1
    s_waitcnt lgkmcnt(8)
    s_waitcnt vmcnt(11)
    v_mfma_f32_16x16x32_bf16 v[64:67], v[232:235], a[16:19], v[64:67]
    ds_read_b64_tr_b16 v[224:225], v38 offset:14528
    v_mfma_f32_16x16x32_bf16 v[92:95], v[232:235], a[20:23], v[92:95]
    ds_read_b64_tr_b16 v[226:227], v38 offset:18112
    ds_read_b64_tr_b16 v[176:177], v58 offset:14336
    ds_read_b64_tr_b16 v[178:179], v58 offset:17920
    v_mfma_f32_16x16x32_bf16 v[68:71], v[236:239], a[16:19], v[68:71]
    ds_read_b64_tr_b16 v[228:229], v38 offset:21504
    v_mfma_f32_16x16x32_bf16 v[96:99], v[236:239], a[20:23], v[96:99]
    ds_read_b64_tr_b16 v[230:231], v38 offset:25088
    v_mfma_f32_16x16x32_bf16 v[240:243], v[184:187], v[192:195], v[240:243]
    ds_read_b64_tr_b16 v[180:181], v58 offset:14368
    buffer_load_dwordx4 a[56:59], v2, s[24:27], s78 offen offset:3072 sc1
    s_waitcnt lgkmcnt(8)
    v_mfma_f32_16x16x32_bf16 v[72:75], v[208:211], a[16:19], v[72:75]
    ds_read_b64_tr_b16 v[232:233], v38 offset:21536
    v_mfma_f32_16x16x32_bf16 v[100:103], v[208:211], a[20:23], v[100:103]
    ds_read_b64_tr_b16 v[234:235], v38 offset:25120
    ds_read_b64_tr_b16 v[182:183], v58 offset:17952
    v_mfma_f32_16x16x32_bf16 v[244:247], v[188:191], v[192:195], v[244:247]
    v_mfma_f32_16x16x32_bf16 v[76:79], v[212:215], a[16:19], v[76:79]
    ds_read_b64_tr_b16 v[236:237], v38 offset:21568
    v_mfma_f32_16x16x32_bf16 v[104:107], v[212:215], a[20:23], v[104:107]
    ds_read_b64_tr_b16 v[238:239], v38 offset:25152
    ds_read_b64_tr_b16 a[172:173], v196 offset:128
    ds_read_b64_tr_b16 a[174:175], v196 offset:3712
    s_add_u32 s78, s78, 4096
    s_add_u32 s79, s79, 4096
    buffer_load_dwordx4 a[68:71], v2, s[24:27], s79 offen offset:0 sc1
    s_waitcnt lgkmcnt(8)
    v_mfma_f32_16x16x32_bf16 v[80:83], v[216:219], a[16:19], v[80:83]
    ds_read_b64_tr_b16 v[208:209], v38 offset:21600
    v_mfma_f32_16x16x32_bf16 v[108:111], v[216:219], a[20:23], v[108:111]
    ds_read_b64_tr_b16 v[210:211], v38 offset:25184
    ds_read_b64_tr_b16 a[176:177], v196 offset:160
    ds_read_b64_tr_b16 a[178:179], v196 offset:3744
    v_mfma_f32_16x16x32_bf16 v[84:87], v[220:223], a[16:19], v[84:87]
    ds_read_b64_tr_b16 v[212:213], v38 offset:21632
    v_mfma_f32_16x16x32_bf16 v[112:115], v[220:223], a[20:23], v[112:115]
    ds_read_b64_tr_b16 v[214:215], v38 offset:25216
    s_waitcnt vmcnt(10)
    v_add_f32 v200, v200, v202
    v_add_f32 v201, v201, v203
    buffer_load_dwordx4 a[64:67], v2, s[24:27], s78 offen offset:0 sc1
    s_waitcnt lgkmcnt(8)
    v_mfma_f32_16x16x32_bf16 v[88:91], v[224:227], a[16:19], v[88:91]
    ds_read_b64_tr_b16 v[216:217], v38 offset:21664
    v_mfma_f32_16x16x32_bf16 v[116:119], v[224:227], a[20:23], v[116:119]
    ds_read_b64_tr_b16 v[218:219], v38 offset:25248
    s_waitcnt vmcnt(10)
    v_add_f32 v204, v204, v206
    v_add_f32 v205, v205, v207
    v_mfma_f32_16x16x32_bf16 v[64:67], v[228:231], a[24:27], v[64:67]
    ds_read_b64_tr_b16 v[220:221], v38 offset:21696
    v_mfma_f32_16x16x32_bf16 v[92:95], v[228:231], a[28:31], v[92:95]
    ds_read_b64_tr_b16 v[222:223], v38 offset:25280
    ds_read_b64_tr_b16 v[184:185], v58 offset:21504
    ds_read_b64_tr_b16 v[186:187], v58 offset:25088
    s_waitcnt lgkmcnt(8)
    v_mfma_f32_16x16x32_bf16 v[68:71], v[232:235], a[24:27], v[68:71]
    ds_read_b64_tr_b16 v[224:225], v38 offset:28672
    v_mfma_f32_16x16x32_bf16 v[96:99], v[232:235], a[28:31], v[96:99]
    ds_read_b64_tr_b16 v[226:227], v38 offset:32256
    v_mfma_f32_16x16x32_bf16 v[240:243], v[176:179], v[192:195], v[240:243]
    ds_read_b64_tr_b16 v[188:189], v58 offset:21536
    buffer_load_dwordx4 v[132:135], v2, s[24:27], s79 offen offset:1024 sc1
    v_mfma_f32_16x16x32_bf16 v[72:75], v[236:239], a[24:27], v[72:75]
    ds_read_b64_tr_b16 v[228:229], v38 offset:28704
    v_mfma_f32_16x16x32_bf16 v[100:103], v[236:239], a[28:31], v[100:103]
    ds_read_b64_tr_b16 v[230:231], v38 offset:32288
    ds_read_b64_tr_b16 v[190:191], v58 offset:25120
    v_mfma_f32_16x16x32_bf16 v[244:247], v[180:183], v[192:195], v[244:247]
    s_waitcnt lgkmcnt(8)
    v_mfma_f32_16x16x32_bf16 v[76:79], v[208:211], a[24:27], v[76:79]
    ds_read_b64_tr_b16 v[232:233], v38 offset:28736
    v_mfma_f32_16x16x32_bf16 v[104:107], v[208:211], a[28:31], v[104:107]
    ds_read_b64_tr_b16 v[234:235], v38 offset:32320
    ds_read_b64_tr_b16 a[180:181], v196 offset:192
    ds_read_b64_tr_b16 a[182:183], v196 offset:3776
    buffer_load_dwordx4 v[128:131], v2, s[24:27], s78 offen offset:1024 sc1
    v_mfma_f32_16x16x32_bf16 v[80:83], v[212:215], a[24:27], v[80:83]
    ds_read_b64_tr_b16 v[236:237], v38 offset:28768
    v_mfma_f32_16x16x32_bf16 v[108:111], v[212:215], a[28:31], v[108:111]
    ds_read_b64_tr_b16 v[238:239], v38 offset:32352
    ds_read_b64_tr_b16 a[184:185], v196 offset:28672
    ds_read_b64_tr_b16 a[186:187], v196 offset:32256
    s_waitcnt lgkmcnt(8)
    v_mfma_f32_16x16x32_bf16 v[84:87], v[216:219], a[24:27], v[84:87]
    ds_read_b64_tr_b16 v[208:209], v38 offset:28800
    v_mfma_f32_16x16x32_bf16 v[112:115], v[216:219], a[28:31], v[112:115]
    ds_read_b64_tr_b16 v[210:211], v38 offset:32384
    v_mov_b32 v172, v200
    v_mov_b32 v173, v201
    buffer_load_dwordx4 v[140:143], v2, s[24:27], s79 offen offset:2048 sc1
    v_mfma_f32_16x16x32_bf16 v[88:91], v[220:223], a[24:27], v[88:91]
    ds_read_b64_tr_b16 v[212:213], v38 offset:28832
    v_mfma_f32_16x16x32_bf16 v[116:119], v[220:223], a[28:31], v[116:119]
    ds_read_b64_tr_b16 v[214:215], v38 offset:32416
    v_mov_b32 v174, v204
    v_mov_b32 v175, v205
    s_waitcnt lgkmcnt(8)
    s_waitcnt vmcnt(11)
    v_mfma_f32_16x16x32_bf16 v[64:67], v[224:227], a[32:35], v[64:67]
    ds_read_b64_tr_b16 v[216:217], v38 offset:28864
    v_mfma_f32_16x16x32_bf16 v[92:95], v[224:227], a[36:39], v[92:95]
    ds_read_b64_tr_b16 v[218:219], v38 offset:32448
    ds_read_b64_tr_b16 v[176:177], v58 offset:28672
    ds_read_b64_tr_b16 v[178:179], v58 offset:32256
    buffer_load_dwordx4 v[136:139], v2, s[24:27], s78 offen offset:2048 sc1
    v_mfma_f32_16x16x32_bf16 v[68:71], v[228:231], a[32:35], v[68:71]
    ds_read_b64_tr_b16 v[220:221], v38 offset:35840
    v_mfma_f32_16x16x32_bf16 v[96:99], v[228:231], a[36:39], v[96:99]
    ds_read_b64_tr_b16 v[222:223], v38 offset:39424
    v_mfma_f32_16x16x32_bf16 v[240:243], v[184:187], v[192:195], v[240:243]
    ds_read_b64_tr_b16 v[180:181], v58 offset:28704
    s_waitcnt lgkmcnt(8)
    v_mfma_f32_16x16x32_bf16 v[72:75], v[232:235], a[32:35], v[72:75]
    ds_read_b64_tr_b16 v[224:225], v38 offset:35872
    v_mfma_f32_16x16x32_bf16 v[100:103], v[232:235], a[36:39], v[100:103]
    ds_read_b64_tr_b16 v[226:227], v38 offset:39456
    ds_read_b64_tr_b16 v[182:183], v58 offset:32288
    v_mfma_f32_16x16x32_bf16 v[244:247], v[188:191], v[192:195], v[244:247]
    buffer_load_dwordx4 v[148:151], v2, s[24:27], s79 offen offset:3072 sc1
    v_mfma_f32_16x16x32_bf16 v[76:79], v[236:239], a[32:35], v[76:79]
    ds_read_b64_tr_b16 v[228:229], v38 offset:35904
    v_mfma_f32_16x16x32_bf16 v[104:107], v[236:239], a[36:39], v[104:107]
    ds_read_b64_tr_b16 v[230:231], v38 offset:39488
    ds_read_b64_tr_b16 a[188:189], v196 offset:28704
    ds_read_b64_tr_b16 a[190:191], v196 offset:32288
    s_waitcnt lgkmcnt(8)
    v_mfma_f32_16x16x32_bf16 v[80:83], v[208:211], a[32:35], v[80:83]
    ds_read_b64_tr_b16 v[232:233], v38 offset:35936
    v_mfma_f32_16x16x32_bf16 v[108:111], v[208:211], a[36:39], v[108:111]
    ds_read_b64_tr_b16 v[234:235], v38 offset:39520
    ds_read_b64_tr_b16 a[192:193], v196 offset:28736
    ds_read_b64_tr_b16 a[194:195], v196 offset:32320
    v_mfma_f32_16x16x32_bf16 v[84:87], v[212:215], a[32:35], v[84:87]
    ds_read_b64_tr_b16 v[236:237], v38 offset:35968
    v_mfma_f32_16x16x32_bf16 v[112:115], v[212:215], a[36:39], v[112:115]
    ds_read_b64_tr_b16 v[238:239], v38 offset:39552
    v_permlane32_swap_b32 v172, v200
    v_permlane32_swap_b32 v173, v201
    buffer_load_dwordx4 v[144:147], v2, s[24:27], s78 offen offset:3072 sc1
    s_waitcnt lgkmcnt(8)
    v_mfma_f32_16x16x32_bf16 v[88:91], v[216:219], a[32:35], v[88:91]
    ds_read_b64_tr_b16 v[208:209], v38 offset:36000
    v_mfma_f32_16x16x32_bf16 v[116:119], v[216:219], a[36:39], v[116:119]
    ds_read_b64_tr_b16 v[210:211], v38 offset:39584
    v_permlane32_swap_b32 v174, v204
    v_permlane32_swap_b32 v175, v205
    s_waitcnt vmcnt(12)
    v_mfma_f32_16x16x32_bf16 v[64:67], v[220:223], a[40:43], v[64:67]
    ds_read_b64_tr_b16 v[212:213], v38 offset:36032
    v_mfma_f32_16x16x32_bf16 v[92:95], v[220:223], a[44:47], v[92:95]
    ds_read_b64_tr_b16 v[214:215], v38 offset:39616
    ds_read_b64_tr_b16 v[184:185], v58 offset:35840
    ds_read_b64_tr_b16 v[186:187], v58 offset:39424
    s_add_u32 s78, s78, 4096
    s_add_u32 s79, s79, 4096
    buffer_load_dwordx4 v[156:159], v2, s[24:27], s79 offen offset:0 sc1
    s_waitcnt lgkmcnt(8)
    v_mfma_f32_16x16x32_bf16 v[68:71], v[224:227], a[40:43], v[68:71]
    ds_read_b64_tr_b16 v[216:217], v38 offset:43008
    v_mfma_f32_16x16x32_bf16 v[96:99], v[224:227], a[44:47], v[96:99]
    ds_read_b64_tr_b16 v[218:219], v38 offset:46592
    v_mfma_f32_16x16x32_bf16 v[240:243], v[176:179], v[192:195], v[240:243]
    ds_read_b64_tr_b16 v[188:189], v58 offset:35872
    v_mfma_f32_16x16x32_bf16 v[72:75], v[228:231], a[40:43], v[72:75]
    ds_read_b64_tr_b16 v[220:221], v38 offset:43040
    v_mfma_f32_16x16x32_bf16 v[100:103], v[228:231], a[44:47], v[100:103]
    ds_read_b64_tr_b16 v[222:223], v38 offset:46624
    ds_read_b64_tr_b16 v[190:191], v58 offset:39456
    v_mfma_f32_16x16x32_bf16 v[244:247], v[180:183], v[192:195], v[244:247]
    buffer_load_dwordx4 v[152:155], v2, s[24:27], s78 offen offset:0 sc1
    s_waitcnt lgkmcnt(8)
    v_mfma_f32_16x16x32_bf16 v[76:79], v[232:235], a[40:43], v[76:79]
    ds_read_b64_tr_b16 v[224:225], v38 offset:43072
    v_mfma_f32_16x16x32_bf16 v[104:107], v[232:235], a[44:47], v[104:107]
    ds_read_b64_tr_b16 v[226:227], v38 offset:46656
    ds_read_b64_tr_b16 a[196:197], v196 offset:28768
    ds_read_b64_tr_b16 a[198:199], v196 offset:32352
    v_mfma_f32_16x16x32_bf16 v[80:83], v[236:239], a[40:43], v[80:83]
    ds_read_b64_tr_b16 v[228:229], v38 offset:43104
    v_mfma_f32_16x16x32_bf16 v[108:111], v[236:239], a[44:47], v[108:111]
    ds_read_b64_tr_b16 v[230:231], v38 offset:46688
    ds_read_b64_tr_b16 a[200:201], v196 offset:28800
    ds_read_b64_tr_b16 a[202:203], v196 offset:32384
    buffer_load_dwordx4 v[164:167], v2, s[24:27], s79 offen offset:1024 sc1
    s_waitcnt lgkmcnt(8)
    v_mfma_f32_16x16x32_bf16 v[84:87], v[208:211], a[40:43], v[84:87]
    ds_read_b64_tr_b16 v[232:233], v38 offset:43136
    v_mfma_f32_16x16x32_bf16 v[112:115], v[208:211], a[44:47], v[112:115]
    ds_read_b64_tr_b16 v[234:235], v38 offset:46720
    v_add_f32 v200, v172, v200
    v_add_f32 v201, v173, v201
    v_mfma_f32_16x16x32_bf16 v[88:91], v[212:215], a[40:43], v[88:91]
    ds_read_b64_tr_b16 v[236:237], v38 offset:43168
    v_mfma_f32_16x16x32_bf16 v[116:119], v[212:215], a[44:47], v[116:119]
    ds_read_b64_tr_b16 v[238:239], v38 offset:46752
    v_add_f32 v204, v174, v204
    v_add_f32 v205, v175, v205
    buffer_load_dwordx4 v[160:163], v2, s[24:27], s78 offen offset:1024 sc1
    s_waitcnt lgkmcnt(8)
    s_waitcnt vmcnt(14)
    v_mfma_f32_16x16x32_bf16 v[64:67], v[216:219], a[48:51], v[64:67]
    ds_read_b64_tr_b16 v[208:209], v38 offset:43200
    v_mfma_f32_16x16x32_bf16 v[92:95], v[216:219], a[52:55], v[92:95]
    ds_read_b64_tr_b16 v[210:211], v38 offset:46784
    ds_read_b64_tr_b16 v[176:177], v58 offset:43008
    ds_read_b64_tr_b16 v[178:179], v58 offset:46592
    v_mfma_f32_16x16x32_bf16 v[68:71], v[220:223], a[48:51], v[68:71]
    ds_read_b64_tr_b16 v[212:213], v38 offset:50176
    v_mfma_f32_16x16x32_bf16 v[96:99], v[220:223], a[52:55], v[96:99]
    ds_read_b64_tr_b16 v[214:215], v38 offset:53760
    v_mfma_f32_16x16x32_bf16 v[240:243], v[184:187], v[192:195], v[240:243]
    ds_read_b64_tr_b16 v[180:181], v58 offset:43040
    s_waitcnt lgkmcnt(8)
    v_mfma_f32_16x16x32_bf16 v[72:75], v[224:227], a[48:51], v[72:75]
    ds_read_b64_tr_b16 v[216:217], v38 offset:50208
    v_mfma_f32_16x16x32_bf16 v[100:103], v[224:227], a[52:55], v[100:103]
    ds_read_b64_tr_b16 v[218:219], v38 offset:53792
    ds_read_b64_tr_b16 v[182:183], v58 offset:46624
    v_mfma_f32_16x16x32_bf16 v[244:247], v[188:191], v[192:195], v[244:247]
    buffer_load_dword v250, v12, s[24:27], 0 offen
    v_mfma_f32_16x16x32_bf16 v[76:79], v[228:231], a[48:51], v[76:79]
    ds_read_b64_tr_b16 v[220:221], v38 offset:50240
    v_mfma_f32_16x16x32_bf16 v[104:107], v[228:231], a[52:55], v[104:107]
    ds_read_b64_tr_b16 v[222:223], v38 offset:53824
    ds_read_b64_tr_b16 a[204:205], v196 offset:28832
    ds_read_b64_tr_b16 a[206:207], v196 offset:32416
    s_waitcnt lgkmcnt(8)
    v_mfma_f32_16x16x32_bf16 v[80:83], v[232:235], a[48:51], v[80:83]
    ds_read_b64_tr_b16 v[224:225], v38 offset:50272
    v_mfma_f32_16x16x32_bf16 v[108:111], v[232:235], a[52:55], v[108:111]
    ds_read_b64_tr_b16 v[226:227], v38 offset:53856
    ds_read_b64_tr_b16 a[208:209], v196 offset:28864
    ds_read_b64_tr_b16 a[210:211], v196 offset:32448
    s_mov_b32 s90, 0
    s_add_u32 m0, s93, 106496
    v_mfma_f32_16x16x32_bf16 v[84:87], v[236:239], a[48:51], v[84:87]
    buffer_load_dwordx4 v7, s[20:23], s90 offen lds
    ds_read_b64_tr_b16 v[228:229], v38 offset:50304
    v_mfma_f32_16x16x32_bf16 v[112:115], v[236:239], a[52:55], v[112:115]
    ds_read_b64_tr_b16 v[230:231], v38 offset:53888
    v_mov_b32 v172, v200
    v_mov_b32 v173, v201
    s_waitcnt lgkmcnt(8)
    v_mfma_f32_16x16x32_bf16 v[88:91], v[208:211], a[48:51], v[88:91]
    ds_read_b64_tr_b16 v[232:233], v38 offset:50336
    v_mfma_f32_16x16x32_bf16 v[116:119], v[208:211], a[52:55], v[116:119]
    ds_read_b64_tr_b16 v[234:235], v38 offset:53920
    v_mov_b32 v174, v204
    v_mov_b32 v175, v205
    s_mov_b32 s90, 28672
    s_add_u32 m0, s93, 110592
    s_waitcnt vmcnt(14)
    v_mfma_f32_16x16x32_bf16 v[64:67], v[212:215], a[56:59], v[64:67]
    buffer_load_dwordx4 v7, s[20:23], s90 offen lds
    ds_read_b64_tr_b16 v[236:237], v38 offset:50368
    v_mfma_f32_16x16x32_bf16 v[92:95], v[212:215], a[60:63], v[92:95]
    ds_read_b64_tr_b16 v[238:239], v38 offset:53952
    ds_read_b64_tr_b16 v[184:185], v58 offset:50176
    ds_read_b64_tr_b16 v[186:187], v58 offset:53760
    s_waitcnt lgkmcnt(8)
    v_mfma_f32_16x16x32_bf16 v[68:71], v[216:219], a[56:59], v[68:71]
    ds_read_b64_tr_b16 v[208:209], v38 offset:57344
    v_mfma_f32_16x16x32_bf16 v[96:99], v[216:219], a[60:63], v[96:99]
    ds_read_b64_tr_b16 v[210:211], v38 offset:60928
    v_mfma_f32_16x16x32_bf16 v[240:243], v[176:179], v[192:195], v[240:243]
    ds_read_b64_tr_b16 v[188:189], v58 offset:50208
    s_mov_b32 s90, 57344
    s_add_u32 m0, s93, 114688
    v_mfma_f32_16x16x32_bf16 v[72:75], v[220:223], a[56:59], v[72:75]
    buffer_load_dwordx4 v7, s[20:23], s90 offen lds
    ds_read_b64_tr_b16 v[212:213], v38 offset:57376
    v_mfma_f32_16x16x32_bf16 v[100:103], v[220:223], a[60:63], v[100:103]
    ds_read_b64_tr_b16 v[214:215], v38 offset:60960
    ds_read_b64_tr_b16 v[190:191], v58 offset:53792
    v_mfma_f32_16x16x32_bf16 v[244:247], v[180:183], v[192:195], v[244:247]
    s_waitcnt lgkmcnt(8)
    v_mfma_f32_16x16x32_bf16 v[76:79], v[224:227], a[56:59], v[76:79]
    ds_read_b64_tr_b16 v[216:217], v38 offset:57408
    v_mfma_f32_16x16x32_bf16 v[104:107], v[224:227], a[60:63], v[104:107]
    ds_read_b64_tr_b16 v[218:219], v38 offset:60992
    ds_read_b64_tr_b16 a[212:213], v196 offset:57344
    ds_read_b64_tr_b16 a[214:215], v196 offset:60928
    s_mov_b32 s90, 86016
    s_add_u32 m0, s93, 118784
    v_mfma_f32_16x16x32_bf16 v[80:83], v[228:231], a[56:59], v[80:83]
    buffer_load_dwordx4 v7, s[20:23], s90 offen lds
    ds_read_b64_tr_b16 v[220:221], v38 offset:57440
    v_mfma_f32_16x16x32_bf16 v[108:111], v[228:231], a[60:63], v[108:111]
    ds_read_b64_tr_b16 v[222:223], v38 offset:61024
    ds_read_b64_tr_b16 a[216:217], v196 offset:57376
    ds_read_b64_tr_b16 a[218:219], v196 offset:60960
    s_waitcnt lgkmcnt(8)
    v_mfma_f32_16x16x32_bf16 v[84:87], v[232:235], a[56:59], v[84:87]
    ds_read_b64_tr_b16 v[224:225], v38 offset:57472
    v_mfma_f32_16x16x32_bf16 v[112:115], v[232:235], a[60:63], v[112:115]
    ds_read_b64_tr_b16 v[226:227], v38 offset:61056
    v_permlane16_swap_b32 v172, v200
    v_permlane16_swap_b32 v173, v201
    v_mfma_f32_16x16x32_bf16 v[88:91], v[236:239], a[56:59], v[88:91]
    ds_read_b64_tr_b16 v[228:229], v38 offset:57504
    v_mfma_f32_16x16x32_bf16 v[116:119], v[236:239], a[60:63], v[116:119]
    ds_read_b64_tr_b16 v[230:231], v38 offset:61088
    v_permlane16_swap_b32 v174, v204
    v_permlane16_swap_b32 v175, v205
    s_waitcnt lgkmcnt(8)
    s_waitcnt vmcnt(15)
    v_mfma_f32_16x16x32_bf16 v[64:67], v[208:211], a[64:67], v[64:67]
    ds_read_b64_tr_b16 v[232:233], v38 offset:57536
    v_mfma_f32_16x16x32_bf16 v[92:95], v[208:211], a[68:71], v[92:95]
    ds_read_b64_tr_b16 v[234:235], v38 offset:61120
    ds_read_b64_tr_b16 v[176:177], v58 offset:57344
    ds_read_b64_tr_b16 v[178:179], v58 offset:60928
    v_mfma_f32_16x16x32_bf16 v[68:71], v[212:215], a[64:67], v[68:71]
    ds_read_b64_tr_b16 v[236:237], v39 offset:0
    v_mfma_f32_16x16x32_bf16 v[96:99], v[212:215], a[68:71], v[96:99]
    ds_read_b64_tr_b16 v[238:239], v39 offset:3584
    v_mfma_f32_16x16x32_bf16 v[240:243], v[184:187], v[192:195], v[240:243]
    ds_read_b64_tr_b16 v[180:181], v58 offset:57376
    s_waitcnt lgkmcnt(8)
    v_mfma_f32_16x16x32_bf16 v[72:75], v[216:219], a[64:67], v[72:75]
    ds_read_b64_tr_b16 v[208:209], v39 offset:32
    v_mfma_f32_16x16x32_bf16 v[100:103], v[216:219], a[68:71], v[100:103]
    ds_read_b64_tr_b16 v[210:211], v39 offset:3616
    ds_read_b64_tr_b16 v[182:183], v58 offset:60960
    v_mfma_f32_16x16x32_bf16 v[244:247], v[188:191], v[192:195], v[244:247]
    v_mfma_f32_16x16x32_bf16 v[76:79], v[220:223], a[64:67], v[76:79]
    ds_read_b64_tr_b16 v[212:213], v39 offset:64
    v_mfma_f32_16x16x32_bf16 v[104:107], v[220:223], a[68:71], v[104:107]
    ds_read_b64_tr_b16 v[214:215], v39 offset:3648
    ds_read_b64_tr_b16 a[220:221], v196 offset:57408
    ds_read_b64_tr_b16 a[222:223], v196 offset:60992
    s_waitcnt lgkmcnt(8)
    v_mfma_f32_16x16x32_bf16 v[80:83], v[224:227], a[64:67], v[80:83]
    ds_read_b64_tr_b16 v[216:217], v39 offset:96
    v_mfma_f32_16x16x32_bf16 v[108:111], v[224:227], a[68:71], v[108:111]
    ds_read_b64_tr_b16 v[218:219], v39 offset:3680
    ds_read_b64_tr_b16 a[224:225], v196 offset:57440
    ds_read_b64_tr_b16 a[226:227], v196 offset:61024
    v_mfma_f32_16x16x32_bf16 v[84:87], v[228:231], a[64:67], v[84:87]
    ds_read_b64_tr_b16 v[220:221], v39 offset:128
    v_mfma_f32_16x16x32_bf16 v[112:115], v[228:231], a[68:71], v[112:115]
    ds_read_b64_tr_b16 v[222:223], v39 offset:3712
    v_add_f32 v200, v172, v200
    v_add_f32 v201, v173, v201
    s_waitcnt lgkmcnt(8)
    v_mfma_f32_16x16x32_bf16 v[88:91], v[232:235], a[64:67], v[88:91]
    ds_read_b64_tr_b16 v[224:225], v39 offset:160
    v_mfma_f32_16x16x32_bf16 v[116:119], v[232:235], a[68:71], v[116:119]
    ds_read_b64_tr_b16 v[226:227], v39 offset:3744
    v_add_f32 v204, v174, v204
    v_add_f32 v205, v175, v205
    s_waitcnt vmcnt(13)
    v_mfma_f32_16x16x32_bf16 v[64:67], v[236:239], v[128:131], v[64:67]
    ds_read_b64_tr_b16 v[228:229], v39 offset:192
    v_mfma_f32_16x16x32_bf16 v[92:95], v[236:239], v[132:135], v[92:95]
    ds_read_b64_tr_b16 v[230:231], v39 offset:3776
    ds_read_b64_tr_b16 v[184:185], v59 offset:0
    ds_read_b64_tr_b16 v[186:187], v59 offset:3584
    s_waitcnt lgkmcnt(8)
    v_mfma_f32_16x16x32_bf16 v[68:71], v[208:211], v[128:131], v[68:71]
    ds_read_b64_tr_b16 v[232:233], v39 offset:7168
    v_mfma_f32_16x16x32_bf16 v[96:99], v[208:211], v[132:135], v[96:99]
    ds_read_b64_tr_b16 v[234:235], v39 offset:10752
    v_mfma_f32_16x16x32_bf16 v[240:243], v[176:179], v[192:195], v[240:243]
    ds_read_b64_tr_b16 v[188:189], v59 offset:32
    v_mfma_f32_16x16x32_bf16 v[72:75], v[212:215], v[128:131], v[72:75]
    ds_read_b64_tr_b16 v[236:237], v39 offset:7200
    v_mfma_f32_16x16x32_bf16 v[100:103], v[212:215], v[132:135], v[100:103]
    ds_read_b64_tr_b16 v[238:239], v39 offset:10784
    ds_read_b64_tr_b16 v[190:191], v59 offset:3616
    v_mfma_f32_16x16x32_bf16 v[244:247], v[180:183], v[192:195], v[244:247]
    s_waitcnt lgkmcnt(8)
    v_mfma_f32_16x16x32_bf16 v[76:79], v[216:219], v[128:131], v[76:79]
    ds_read_b64_tr_b16 v[208:209], v39 offset:7232
    v_mfma_f32_16x16x32_bf16 v[104:107], v[216:219], v[132:135], v[104:107]
    ds_read_b64_tr_b16 v[210:211], v39 offset:10816
    ds_read_b64_tr_b16 a[228:229], v196 offset:57472
    ds_read_b64_tr_b16 a[230:231], v196 offset:61056
    v_mfma_f32_16x16x32_bf16 v[80:83], v[220:223], v[128:131], v[80:83]
    ds_read_b64_tr_b16 v[212:213], v39 offset:7264
    v_mfma_f32_16x16x32_bf16 v[108:111], v[220:223], v[132:135], v[108:111]
    ds_read_b64_tr_b16 v[214:215], v39 offset:10848
    ds_read_b64_tr_b16 a[232:233], v196 offset:57504
    ds_read_b64_tr_b16 a[234:235], v196 offset:61088
    s_waitcnt lgkmcnt(8)
    v_mfma_f32_16x16x32_bf16 v[84:87], v[224:227], v[128:131], v[84:87]
    ds_read_b64_tr_b16 v[216:217], v39 offset:7296
    v_mfma_f32_16x16x32_bf16 v[112:115], v[224:227], v[132:135], v[112:115]
    ds_read_b64_tr_b16 v[218:219], v39 offset:10880
    v_mul_f32 v200, 0x3b124925, v200
    v_mul_f32 v201, 0x3b124925, v201
    v_mfma_f32_16x16x32_bf16 v[88:91], v[228:231], v[128:131], v[88:91]
    ds_read_b64_tr_b16 v[220:221], v39 offset:7328
    v_mfma_f32_16x16x32_bf16 v[116:119], v[228:231], v[132:135], v[116:119]
    ds_read_b64_tr_b16 v[222:223], v39 offset:10912
    v_fma_f32 v201, -v200, v200, v201
    v_max_f32 v201, 0, v201
    s_waitcnt lgkmcnt(8)
    s_waitcnt vmcnt(11)
    v_mfma_f32_16x16x32_bf16 v[64:67], v[232:235], v[136:139], v[64:67]
    ds_read_b64_tr_b16 v[224:225], v39 offset:7360
    v_mfma_f32_16x16x32_bf16 v[92:95], v[232:235], v[140:143], v[92:95]
    ds_read_b64_tr_b16 v[226:227], v39 offset:10944
    ds_read_b64_tr_b16 v[176:177], v59 offset:7168
    ds_read_b64_tr_b16 v[178:179], v59 offset:10752
    v_mfma_f32_16x16x32_bf16 v[68:71], v[236:239], v[136:139], v[68:71]
    ds_read_b64_tr_b16 v[228:229], v39 offset:14336
    v_mfma_f32_16x16x32_bf16 v[96:99], v[236:239], v[140:143], v[96:99]
    ds_read_b64_tr_b16 v[230:231], v39 offset:17920
    v_mfma_f32_16x16x32_bf16 v[240:243], v[184:187], v[192:195], v[240:243]
    ds_read_b64_tr_b16 v[180:181], v59 offset:7200
    s_waitcnt lgkmcnt(8)
    v_mfma_f32_16x16x32_bf16 v[72:75], v[208:211], v[136:139], v[72:75]
    ds_read_b64_tr_b16 v[232:233], v39 offset:14368
    v_mfma_f32_16x16x32_bf16 v[100:103], v[208:211], v[140:143], v[100:103]
    ds_read_b64_tr_b16 v[234:235], v39 offset:17952
    ds_read_b64_tr_b16 v[182:183], v59 offset:10784
    v_mfma_f32_16x16x32_bf16 v[244:247], v[188:191], v[192:195], v[244:247]
    v_mfma_f32_16x16x32_bf16 v[76:79], v[212:215], v[136:139], v[76:79]
    ds_read_b64_tr_b16 v[236:237], v39 offset:14400
    v_mfma_f32_16x16x32_bf16 v[104:107], v[212:215], v[140:143], v[104:107]
    ds_read_b64_tr_b16 v[238:239], v39 offset:17984
    ds_read_b64_tr_b16 a[236:237], v196 offset:57536
    ds_read_b64_tr_b16 a[238:239], v196 offset:61120
    s_waitcnt lgkmcnt(8)
    v_mfma_f32_16x16x32_bf16 v[80:83], v[216:219], v[136:139], v[80:83]
    ds_read_b64_tr_b16 v[208:209], v39 offset:14432
    v_mfma_f32_16x16x32_bf16 v[108:111], v[216:219], v[140:143], v[108:111]
    ds_read_b64_tr_b16 v[210:211], v39 offset:18016
    ds_read_b64_tr_b16 a[240:241], v197 offset:0
    ds_read_b64_tr_b16 a[242:243], v197 offset:3584
    v_mfma_f32_16x16x32_bf16 v[84:87], v[220:223], v[136:139], v[84:87]
    ds_read_b64_tr_b16 v[212:213], v39 offset:14464
    v_mfma_f32_16x16x32_bf16 v[112:115], v[220:223], v[140:143], v[112:115]
    ds_read_b64_tr_b16 v[214:215], v39 offset:18048
    v_add_f32 v172, 0x3727c5ac, v201
    v_rsq_f32 v168, v172
    s_waitcnt lgkmcnt(8)
    v_mfma_f32_16x16x32_bf16 v[88:91], v[224:227], v[136:139], v[88:91]
    ds_read_b64_tr_b16 v[216:217], v39 offset:14496
    v_mfma_f32_16x16x32_bf16 v[116:119], v[224:227], v[140:143], v[116:119]
    ds_read_b64_tr_b16 v[218:219], v39 offset:18080
    v_mul_f32 v172, v168, v168
    v_mul_f32 v172, v172, v201
    s_waitcnt vmcnt(9)
    v_mfma_f32_16x16x32_bf16 v[64:67], v[228:231], v[144:147], v[64:67]
    ds_read_b64_tr_b16 v[220:221], v39 offset:14528
    v_mfma_f32_16x16x32_bf16 v[92:95], v[228:231], v[148:151], v[92:95]
    ds_read_b64_tr_b16 v[222:223], v39 offset:18112
    ds_read_b64_tr_b16 v[184:185], v59 offset:14336
    ds_read_b64_tr_b16 v[186:187], v59 offset:17920
    s_waitcnt lgkmcnt(8)
    v_mfma_f32_16x16x32_bf16 v[68:71], v[232:235], v[144:147], v[68:71]
    ds_read_b64_tr_b16 v[224:225], v39 offset:21504
    v_mfma_f32_16x16x32_bf16 v[96:99], v[232:235], v[148:151], v[96:99]
    ds_read_b64_tr_b16 v[226:227], v39 offset:25088
    v_mfma_f32_16x16x32_bf16 v[240:243], v[176:179], v[192:195], v[240:243]
    ds_read_b64_tr_b16 v[188:189], v59 offset:14368
    v_mfma_f32_16x16x32_bf16 v[72:75], v[236:239], v[144:147], v[72:75]
    ds_read_b64_tr_b16 v[228:229], v39 offset:21536
    v_mfma_f32_16x16x32_bf16 v[100:103], v[236:239], v[148:151], v[100:103]
    ds_read_b64_tr_b16 v[230:231], v39 offset:25120
    ds_read_b64_tr_b16 v[190:191], v59 offset:17952
    v_mfma_f32_16x16x32_bf16 v[244:247], v[180:183], v[192:195], v[244:247]
    s_waitcnt lgkmcnt(8)
    v_mfma_f32_16x16x32_bf16 v[76:79], v[208:211], v[144:147], v[76:79]
    ds_read_b64_tr_b16 v[232:233], v39 offset:21568
    v_mfma_f32_16x16x32_bf16 v[104:107], v[208:211], v[148:151], v[104:107]
    ds_read_b64_tr_b16 v[234:235], v39 offset:25152
    ds_read_b64_tr_b16 a[244:245], v197 offset:32
    ds_read_b64_tr_b16 a[246:247], v197 offset:3616
    v_mfma_f32_16x16x32_bf16 v[80:83], v[212:215], v[144:147], v[80:83]
    ds_read_b64_tr_b16 v[236:237], v39 offset:21600
    v_mfma_f32_16x16x32_bf16 v[108:111], v[212:215], v[148:151], v[108:111]
    ds_read_b64_tr_b16 v[238:239], v39 offset:25184
    ds_read_b64_tr_b16 a[248:249], v197 offset:64
    ds_read_b64_tr_b16 a[250:251], v197 offset:3648
    s_waitcnt lgkmcnt(8)
    v_mfma_f32_16x16x32_bf16 v[84:87], v[216:219], v[144:147], v[84:87]
    ds_read_b64_tr_b16 v[208:209], v39 offset:21632
    v_mfma_f32_16x16x32_bf16 v[112:115], v[216:219], v[148:151], v[112:115]
    ds_read_b64_tr_b16 v[210:211], v39 offset:25216
    v_add_f32 v172, 0x3727c5ac, v172
    v_rsq_f32 v172, v172
    v_mfma_f32_16x16x32_bf16 v[88:91], v[220:223], v[144:147], v[88:91]
    ds_read_b64_tr_b16 v[212:213], v39 offset:21664
    v_mfma_f32_16x16x32_bf16 v[116:119], v[220:223], v[148:151], v[116:119]
    ds_read_b64_tr_b16 v[214:215], v39 offset:25248
    v_mul_f32 v168, v168, v172
    v_mul_f32 v169, v200, v168
    s_waitcnt lgkmcnt(8)
    s_waitcnt vmcnt(7)
    v_mfma_f32_16x16x32_bf16 v[64:67], v[224:227], v[152:155], v[64:67]
    ds_read_b64_tr_b16 v[216:217], v39 offset:21696
    v_mfma_f32_16x16x32_bf16 v[92:95], v[224:227], v[156:159], v[92:95]
    ds_read_b64_tr_b16 v[218:219], v39 offset:25280
    ds_read_b64_tr_b16 v[176:177], v59 offset:21504
    ds_read_b64_tr_b16 v[178:179], v59 offset:25088
    v_mfma_f32_16x16x32_bf16 v[68:71], v[228:231], v[152:155], v[68:71]
    ds_read_b64_tr_b16 v[220:221], v39 offset:28672
    v_mfma_f32_16x16x32_bf16 v[96:99], v[228:231], v[156:159], v[96:99]
    ds_read_b64_tr_b16 v[222:223], v39 offset:32256
    v_mfma_f32_16x16x32_bf16 v[240:243], v[184:187], v[192:195], v[240:243]
    ds_read_b64_tr_b16 v[180:181], v59 offset:21536
    s_waitcnt lgkmcnt(8)
    v_mfma_f32_16x16x32_bf16 v[72:75], v[232:235], v[152:155], v[72:75]
    ds_read_b64_tr_b16 v[224:225], v39 offset:28704
    v_mfma_f32_16x16x32_bf16 v[100:103], v[232:235], v[156:159], v[100:103]
    ds_read_b64_tr_b16 v[226:227], v39 offset:32288
    ds_read_b64_tr_b16 v[182:183], v59 offset:25120
    v_mfma_f32_16x16x32_bf16 v[244:247], v[188:191], v[192:195], v[244:247]
    v_mfma_f32_16x16x32_bf16 v[76:79], v[236:239], v[152:155], v[76:79]
    ds_read_b64_tr_b16 v[228:229], v39 offset:28736
    v_mfma_f32_16x16x32_bf16 v[104:107], v[236:239], v[156:159], v[104:107]
    ds_read_b64_tr_b16 v[230:231], v39 offset:32320
    ds_read_b64_tr_b16 a[252:253], v197 offset:96
    ds_read_b64_tr_b16 a[254:255], v197 offset:3680
    s_waitcnt lgkmcnt(8)
    v_mfma_f32_16x16x32_bf16 v[80:83], v[208:211], v[152:155], v[80:83]
    ds_read_b64_tr_b16 v[232:233], v39 offset:28768
    v_mfma_f32_16x16x32_bf16 v[108:111], v[208:211], v[156:159], v[108:111]
    ds_read_b64_tr_b16 v[234:235], v39 offset:32352
    v_mul_f32 v204, 0x3b124925, v204
    v_mul_f32 v205, 0x3b124925, v205
    v_mfma_f32_16x16x32_bf16 v[84:87], v[212:215], v[152:155], v[84:87]
    ds_read_b64_tr_b16 v[236:237], v39 offset:28800
    v_mfma_f32_16x16x32_bf16 v[112:115], v[212:215], v[156:159], v[112:115]
    ds_read_b64_tr_b16 v[238:239], v39 offset:32384
    v_fma_f32 v205, -v204, v204, v205
    v_max_f32 v205, 0, v205
    s_waitcnt lgkmcnt(8)
    v_mfma_f32_16x16x32_bf16 v[88:91], v[216:219], v[152:155], v[88:91]
    ds_read_b64_tr_b16 v[208:209], v39 offset:28832
    v_mfma_f32_16x16x32_bf16 v[116:119], v[216:219], v[156:159], v[116:119]
    ds_read_b64_tr_b16 v[210:211], v39 offset:32416
    v_add_f32 v173, 0x3727c5ac, v205
    v_rsq_f32 v170, v173
    s_waitcnt vmcnt(5)
    v_mfma_f32_16x16x32_bf16 v[64:67], v[220:223], v[160:163], v[64:67]
    ds_read_b64_tr_b16 v[212:213], v39 offset:28864
    v_mfma_f32_16x16x32_bf16 v[92:95], v[220:223], v[164:167], v[92:95]
    ds_read_b64_tr_b16 v[214:215], v39 offset:32448
    ds_read_b64_tr_b16 v[184:185], v59 offset:28672
    ds_read_b64_tr_b16 v[186:187], v59 offset:32256
    s_waitcnt lgkmcnt(8)
    v_mfma_f32_16x16x32_bf16 v[68:71], v[224:227], v[160:163], v[68:71]
    v_mfma_f32_16x16x32_bf16 v[96:99], v[224:227], v[164:167], v[96:99]
    v_mfma_f32_16x16x32_bf16 v[240:243], v[176:179], v[192:195], v[240:243]
    ds_read_b64_tr_b16 v[188:189], v59 offset:28704
    v_mfma_f32_16x16x32_bf16 v[72:75], v[228:231], v[160:163], v[72:75]
    v_mfma_f32_16x16x32_bf16 v[100:103], v[228:231], v[164:167], v[100:103]
    ds_read_b64_tr_b16 v[190:191], v59 offset:32288
    v_mfma_f32_16x16x32_bf16 v[244:247], v[180:183], v[192:195], v[244:247]
    s_waitcnt lgkmcnt(4)
    v_mfma_f32_16x16x32_bf16 v[76:79], v[232:235], v[160:163], v[76:79]
    v_mfma_f32_16x16x32_bf16 v[104:107], v[232:235], v[164:167], v[104:107]
    v_mul_f32 v173, v170, v170
    v_mul_f32 v173, v173, v205
    v_mfma_f32_16x16x32_bf16 v[80:83], v[236:239], v[160:163], v[80:83]
    v_mfma_f32_16x16x32_bf16 v[108:111], v[236:239], v[164:167], v[108:111]
    v_add_f32 v173, 0x3727c5ac, v173
    v_rsq_f32 v173, v173
    s_waitcnt lgkmcnt(0)
    v_mfma_f32_16x16x32_bf16 v[84:87], v[208:211], v[160:163], v[84:87]
    v_mfma_f32_16x16x32_bf16 v[112:115], v[208:211], v[164:167], v[112:115]
    v_mul_f32 v170, v170, v173
    v_mul_f32 v171, v204, v170
    v_mfma_f32_16x16x32_bf16 v[88:91], v[212:215], v[160:163], v[88:91]
    v_mfma_f32_16x16x32_bf16 v[116:119], v[212:215], v[164:167], v[116:119]
    v_mfma_f32_16x16x32_bf16 v[240:243], v[184:187], v[192:195], v[240:243]
    v_mfma_f32_16x16x32_bf16 v[244:247], v[188:191], v[192:195], v[244:247]
    s_lshl_b32 s72, s42, 7
    v_add_u32 v228, s72, v53
    s_mov_b32 exec_lo, 0x00010001
    s_mov_b32 exec_hi, 0x00010001
    s_nop 2
    ds_write_b128 v228, v[240:243] offset:384
    s_cmp_eq_u32 s42, 3
    s_cbranch_scc1 L_cs1w3_32
    s_nop 7
    ds_write_b128 v228, v[244:247] offset:448
L_cs1w3_32:
    s_mov_b64 exec, -1
    s_waitcnt lgkmcnt(0)
    s_barrier
    v_mov_b32 v212, v168
    v_mov_b32 v213, v169
    v_mov_b32 v214, v170
    v_mov_b32 v215, v171
    ds_read_b128 v[160:163], v53 offset:384
    ds_read_b128 v[164:167], v53 offset:832
    ds_read_b128 v[168:171], v53 offset:448
    ds_read_b128 v[172:175], v53 offset:896
    s_waitcnt lgkmcnt(2)
    v_pk_fma_f32 v[176:177], v[160:161], v[212:213], v[164:165] op_sel:[0,1,0] op_sel_hi:[1,1,1] neg_lo:[0,1,0] neg_hi:[0,1,0]
    v_pk_fma_f32 v[178:179], v[162:163], v[212:213], v[166:167] op_sel:[0,1,0] op_sel_hi:[1,1,1] neg_lo:[0,1,0] neg_hi:[0,1,0]
    v_pk_fma_f32 v[180:181], v[160:161], v[214:215], v[164:165] op_sel:[0,1,0] op_sel_hi:[1,1,1] neg_lo:[0,1,0] neg_hi:[0,1,0]
    v_pk_fma_f32 v[182:183], v[162:163], v[214:215], v[166:167] op_sel:[0,1,0] op_sel_hi:[1,1,1] neg_lo:[0,1,0] neg_hi:[0,1,0]
    v_pk_fma_f32 v[176:177], v[64:65], v[212:213], v[176:177] op_sel_hi:[1,0,1]
    v_pk_fma_f32 v[178:179], v[66:67], v[212:213], v[178:179] op_sel_hi:[1,0,1]
    v_pk_fma_f32 v[180:181], v[92:93], v[214:215], v[180:181] op_sel_hi:[1,0,1]
    v_pk_fma_f32 v[182:183], v[94:95], v[214:215], v[182:183] op_sel_hi:[1,0,1]
    v_pk_mul_f32 v[184:185], v[176:177], v[176:177]
    v_pk_mul_f32 v[186:187], v[178:179], v[178:179]
    v_pk_mul_f32 v[188:189], v[180:181], v[180:181]
    v_pk_mul_f32 v[190:191], v[182:183], v[182:183]
    v_pk_fma_f32 v[184:185], v[184:185], v[62:63], v[62:63] op_sel:[0,1,0] op_sel_hi:[1,1,0]
    v_pk_fma_f32 v[186:187], v[186:187], v[62:63], v[62:63] op_sel:[0,1,0] op_sel_hi:[1,1,0]
    v_pk_fma_f32 v[188:189], v[188:189], v[62:63], v[62:63] op_sel:[0,1,0] op_sel_hi:[1,1,0]
    v_pk_fma_f32 v[190:191], v[190:191], v[62:63], v[62:63] op_sel:[0,1,0] op_sel_hi:[1,1,0]
    v_pk_mul_f32 v[184:185], v[184:185], v[176:177]
    s_mov_b32 s90, 200704
    s_add_u32 m0, s93, 6144
    v_pk_mul_f32 v[186:187], v[186:187], v[178:179]
    buffer_load_dwordx4 v7, s[20:23], s90 offen lds
    v_pk_mul_f32 v[188:189], v[188:189], v[180:181]
    v_pk_mul_f32 v[190:191], v[190:191], v[182:183]
    v_exp_f32 v184, v184
    v_exp_f32 v185, v185
    v_exp_f32 v186, v186
    v_exp_f32 v187, v187
    v_exp_f32 v188, v188
    v_exp_f32 v189, v189
    v_exp_f32 v190, v190
    v_exp_f32 v191, v191
    v_pk_add_f32 v[184:185], v[184:185], 1.0 op_sel_hi:[1,0]
    v_pk_add_f32 v[186:187], v[186:187], 1.0 op_sel_hi:[1,0]
    s_mov_b32 s90, 1003520
    s_add_u32 m0, s93, 55296
    v_pk_add_f32 v[188:189], v[188:189], 1.0 op_sel_hi:[1,0]
    buffer_load_dwordx4 v7, s[20:23], s90 offen lds
    v_pk_add_f32 v[190:191], v[190:191], 1.0 op_sel_hi:[1,0]
    v_rcp_f32 v184, v184
    v_rcp_f32 v185, v185
    v_rcp_f32 v186, v186
    v_rcp_f32 v187, v187
    v_rcp_f32 v188, v188
    v_rcp_f32 v189, v189
    v_rcp_f32 v190, v190
    v_rcp_f32 v191, v191
    v_pk_mul_f32 v[184:185], v[184:185], v[176:177]
    v_pk_mul_f32 v[186:187], v[186:187], v[178:179]
    v_pk_mul_f32 v[188:189], v[188:189], v[180:181]
    s_mov_b32 s90, 229376
    s_add_u32 m0, s93, 10240
    v_pk_mul_f32 v[190:191], v[190:191], v[182:183]
    buffer_load_dwordx4 v7, s[20:23], s90 offen lds
    v_cvt_pk_bf16_f32 v128, v184, v185
    v_cvt_pk_bf16_f32 v129, v186, v187
    v_cvt_pk_bf16_f32 v142, v188, v189
    v_cvt_pk_bf16_f32 v143, v190, v191
    ds_read_b128 v[160:163], v53 offset:512
    ds_read_b128 v[164:167], v53 offset:960
    s_waitcnt lgkmcnt(2)
    v_pk_fma_f32 v[176:177], v[168:169], v[212:213], v[172:173] op_sel:[0,1,0] op_sel_hi:[1,1,1] neg_lo:[0,1,0] neg_hi:[0,1,0]
    v_pk_fma_f32 v[178:179], v[170:171], v[212:213], v[174:175] op_sel:[0,1,0] op_sel_hi:[1,1,1] neg_lo:[0,1,0] neg_hi:[0,1,0]
    v_pk_fma_f32 v[180:181], v[168:169], v[214:215], v[172:173] op_sel:[0,1,0] op_sel_hi:[1,1,1] neg_lo:[0,1,0] neg_hi:[0,1,0]
    v_pk_fma_f32 v[182:183], v[170:171], v[214:215], v[174:175] op_sel:[0,1,0] op_sel_hi:[1,1,1] neg_lo:[0,1,0] neg_hi:[0,1,0]
    v_pk_fma_f32 v[176:177], v[68:69], v[212:213], v[176:177] op_sel_hi:[1,0,1]
    v_pk_fma_f32 v[178:179], v[70:71], v[212:213], v[178:179] op_sel_hi:[1,0,1]
    v_pk_fma_f32 v[180:181], v[96:97], v[214:215], v[180:181] op_sel_hi:[1,0,1]
    v_pk_fma_f32 v[182:183], v[98:99], v[214:215], v[182:183] op_sel_hi:[1,0,1]
    v_pk_mul_f32 v[184:185], v[176:177], v[176:177]
    v_pk_mul_f32 v[186:187], v[178:179], v[178:179]
    v_pk_mul_f32 v[188:189], v[180:181], v[180:181]
    v_pk_mul_f32 v[190:191], v[182:183], v[182:183]
    v_pk_fma_f32 v[184:185], v[184:185], v[62:63], v[62:63] op_sel:[0,1,0] op_sel_hi:[1,1,0]
    v_pk_fma_f32 v[186:187], v[186:187], v[62:63], v[62:63] op_sel:[0,1,0] op_sel_hi:[1,1,0]
    s_mov_b32 s90, 1032192
    s_add_u32 m0, s93, 59392
    v_pk_fma_f32 v[188:189], v[188:189], v[62:63], v[62:63] op_sel:[0,1,0] op_sel_hi:[1,1,0]
    buffer_load_dwordx4 v7, s[20:23], s90 offen lds
    v_pk_fma_f32 v[190:191], v[190:191], v[62:63], v[62:63] op_sel:[0,1,0] op_sel_hi:[1,1,0]
    v_pk_mul_f32 v[184:185], v[184:185], v[176:177]
    v_pk_mul_f32 v[186:187], v[186:187], v[178:179]
    v_pk_mul_f32 v[188:189], v[188:189], v[180:181]
    v_pk_mul_f32 v[190:191], v[190:191], v[182:183]
    v_exp_f32 v184, v184
    v_exp_f32 v185, v185
    v_exp_f32 v186, v186
    v_exp_f32 v187, v187
    v_exp_f32 v188, v188
    v_exp_f32 v189, v189
    v_exp_f32 v190, v190
    v_exp_f32 v191, v191
    s_mov_b32 s90, 258048
    s_add_u32 m0, s93, 14336
    v_pk_add_f32 v[184:185], v[184:185], 1.0 op_sel_hi:[1,0]
    buffer_load_dwordx4 v7, s[20:23], s90 offen lds
    v_pk_add_f32 v[186:187], v[186:187], 1.0 op_sel_hi:[1,0]
    v_pk_add_f32 v[188:189], v[188:189], 1.0 op_sel_hi:[1,0]
    v_pk_add_f32 v[190:191], v[190:191], 1.0 op_sel_hi:[1,0]
    v_rcp_f32 v184, v184
    v_rcp_f32 v185, v185
    v_rcp_f32 v186, v186
    v_rcp_f32 v187, v187
    v_rcp_f32 v188, v188
    v_rcp_f32 v189, v189
    v_rcp_f32 v190, v190
    v_rcp_f32 v191, v191
    v_pk_mul_f32 v[184:185], v[184:185], v[176:177]
    s_mov_b32 s90, 1060864
    s_add_u32 m0, s93, 63488
    v_pk_mul_f32 v[186:187], v[186:187], v[178:179]
    buffer_load_dwordx4 v7, s[20:23], s90 offen lds
    v_pk_mul_f32 v[188:189], v[188:189], v[180:181]
    v_pk_mul_f32 v[190:191], v[190:191], v[182:183]
    v_cvt_pk_bf16_f32 v130, v184, v185
    v_cvt_pk_bf16_f32 v131, v186, v187
    v_cvt_pk_bf16_f32 v144, v188, v189
    v_cvt_pk_bf16_f32 v145, v190, v191
    ds_read_b128 v[168:171], v53 offset:576
    ds_read_b128 v[172:175], v53 offset:1024
    s_waitcnt lgkmcnt(2)
    v_pk_fma_f32 v[176:177], v[160:161], v[212:213], v[164:165] op_sel:[0,1,0] op_sel_hi:[1,1,1] neg_lo:[0,1,0] neg_hi:[0,1,0]
    v_pk_fma_f32 v[178:179], v[162:163], v[212:213], v[166:167] op_sel:[0,1,0] op_sel_hi:[1,1,1] neg_lo:[0,1,0] neg_hi:[0,1,0]
    v_pk_fma_f32 v[180:181], v[160:161], v[214:215], v[164:165] op_sel:[0,1,0] op_sel_hi:[1,1,1] neg_lo:[0,1,0] neg_hi:[0,1,0]
    v_pk_fma_f32 v[182:183], v[162:163], v[214:215], v[166:167] op_sel:[0,1,0] op_sel_hi:[1,1,1] neg_lo:[0,1,0] neg_hi:[0,1,0]
    v_pk_fma_f32 v[176:177], v[72:73], v[212:213], v[176:177] op_sel_hi:[1,0,1]
    v_pk_fma_f32 v[178:179], v[74:75], v[212:213], v[178:179] op_sel_hi:[1,0,1]
    v_pk_fma_f32 v[180:181], v[100:101], v[214:215], v[180:181] op_sel_hi:[1,0,1]
    v_pk_fma_f32 v[182:183], v[102:103], v[214:215], v[182:183] op_sel_hi:[1,0,1]
    v_pk_mul_f32 v[184:185], v[176:177], v[176:177]
    v_pk_mul_f32 v[186:187], v[178:179], v[178:179]
    v_pk_mul_f32 v[188:189], v[180:181], v[180:181]
    v_pk_mul_f32 v[190:191], v[182:183], v[182:183]
    s_mov_b32 s90, 286720
    s_add_u32 m0, s93, 18432
    v_pk_fma_f32 v[184:185], v[184:185], v[62:63], v[62:63] op_sel:[0,1,0] op_sel_hi:[1,1,0]
    buffer_load_dwordx4 v7, s[20:23], s90 offen lds
    v_pk_fma_f32 v[186:187], v[186:187], v[62:63], v[62:63] op_sel:[0,1,0] op_sel_hi:[1,1,0]
    v_pk_fma_f32 v[188:189], v[188:189], v[62:63], v[62:63] op_sel:[0,1,0] op_sel_hi:[1,1,0]
    v_pk_fma_f32 v[190:191], v[190:191], v[62:63], v[62:63] op_sel:[0,1,0] op_sel_hi:[1,1,0]
    v_pk_mul_f32 v[184:185], v[184:185], v[176:177]
    v_pk_mul_f32 v[186:187], v[186:187], v[178:179]
    v_pk_mul_f32 v[188:189], v[188:189], v[180:181]
    v_pk_mul_f32 v[190:191], v[190:191], v[182:183]
    v_exp_f32 v184, v184
    v_exp_f32 v185, v185
    v_exp_f32 v186, v186
    v_exp_f32 v187, v187
    v_exp_f32 v188, v188
    v_exp_f32 v189, v189
    v_exp_f32 v190, v190
    s_mov_b32 s90, 1089536
    s_add_u32 m0, s93, 67584
    v_exp_f32 v191, v191
    buffer_load_dwordx4 v7, s[20:23], s90 offen lds
    v_pk_add_f32 v[184:185], v[184:185], 1.0 op_sel_hi:[1,0]
    v_pk_add_f32 v[186:187], v[186:187], 1.0 op_sel_hi:[1,0]
    v_pk_add_f32 v[188:189], v[188:189], 1.0 op_sel_hi:[1,0]
    v_pk_add_f32 v[190:191], v[190:191], 1.0 op_sel_hi:[1,0]
    v_rcp_f32 v184, v184
    v_rcp_f32 v185, v185
    v_rcp_f32 v186, v186
    v_rcp_f32 v187, v187
    v_rcp_f32 v188, v188
    v_rcp_f32 v189, v189
    v_rcp_f32 v190, v190
    v_rcp_f32 v191, v191
    s_mov_b32 s90, 315392
    s_add_u32 m0, s93, 22528
    v_pk_mul_f32 v[184:185], v[184:185], v[176:177]
    buffer_load_dwordx4 v7, s[20:23], s90 offen lds
    v_pk_mul_f32 v[186:187], v[186:187], v[178:179]
    v_pk_mul_f32 v[188:189], v[188:189], v[180:181]
    v_pk_mul_f32 v[190:191], v[190:191], v[182:183]
    v_cvt_pk_bf16_f32 v132, v184, v185
    v_cvt_pk_bf16_f32 v133, v186, v187
    v_cvt_pk_bf16_f32 v146, v188, v189
    v_cvt_pk_bf16_f32 v147, v190, v191
    ds_read_b128 v[160:163], v53 offset:640
    ds_read_b128 v[164:167], v53 offset:1088
    s_waitcnt lgkmcnt(2)
    v_pk_fma_f32 v[176:177], v[168:169], v[212:213], v[172:173] op_sel:[0,1,0] op_sel_hi:[1,1,1] neg_lo:[0,1,0] neg_hi:[0,1,0]
    v_pk_fma_f32 v[178:179], v[170:171], v[212:213], v[174:175] op_sel:[0,1,0] op_sel_hi:[1,1,1] neg_lo:[0,1,0] neg_hi:[0,1,0]
    v_pk_fma_f32 v[180:181], v[168:169], v[214:215], v[172:173] op_sel:[0,1,0] op_sel_hi:[1,1,1] neg_lo:[0,1,0] neg_hi:[0,1,0]
    v_pk_fma_f32 v[182:183], v[170:171], v[214:215], v[174:175] op_sel:[0,1,0] op_sel_hi:[1,1,1] neg_lo:[0,1,0] neg_hi:[0,1,0]
    v_pk_fma_f32 v[176:177], v[76:77], v[212:213], v[176:177] op_sel_hi:[1,0,1]
    v_pk_fma_f32 v[178:179], v[78:79], v[212:213], v[178:179] op_sel_hi:[1,0,1]
    v_pk_fma_f32 v[180:181], v[104:105], v[214:215], v[180:181] op_sel_hi:[1,0,1]
    v_pk_fma_f32 v[182:183], v[106:107], v[214:215], v[182:183] op_sel_hi:[1,0,1]
    v_pk_mul_f32 v[184:185], v[176:177], v[176:177]
    v_pk_mul_f32 v[186:187], v[178:179], v[178:179]
    v_pk_mul_f32 v[188:189], v[180:181], v[180:181]
    s_mov_b32 s90, 1118208
    s_add_u32 m0, s93, 71680
    v_pk_mul_f32 v[190:191], v[182:183], v[182:183]
    buffer_load_dwordx4 v7, s[20:23], s90 offen lds
    v_pk_fma_f32 v[184:185], v[184:185], v[62:63], v[62:63] op_sel:[0,1,0] op_sel_hi:[1,1,0]
    v_pk_fma_f32 v[186:187], v[186:187], v[62:63], v[62:63] op_sel:[0,1,0] op_sel_hi:[1,1,0]
    v_pk_fma_f32 v[188:189], v[188:189], v[62:63], v[62:63] op_sel:[0,1,0] op_sel_hi:[1,1,0]
    v_pk_fma_f32 v[190:191], v[190:191], v[62:63], v[62:63] op_sel:[0,1,0] op_sel_hi:[1,1,0]
    v_pk_mul_f32 v[184:185], v[184:185], v[176:177]
    v_pk_mul_f32 v[186:187], v[186:187], v[178:179]
    v_pk_mul_f32 v[188:189], v[188:189], v[180:181]
    v_pk_mul_f32 v[190:191], v[190:191], v[182:183]
    v_exp_f32 v184, v184
    v_exp_f32 v185, v185
    v_exp_f32 v186, v186
    v_exp_f32 v187, v187
    v_exp_f32 v188, v188
    v_exp_f32 v189, v189
    s_mov_b32 s90, 344064
    s_add_u32 m0, s93, 26624
    v_exp_f32 v190, v190
    buffer_load_dwordx4 v7, s[20:23], s90 offen lds
    v_exp_f32 v191, v191
    v_pk_add_f32 v[184:185], v[184:185], 1.0 op_sel_hi:[1,0]
    v_pk_add_f32 v[186:187], v[186:187], 1.0 op_sel_hi:[1,0]
    v_pk_add_f32 v[188:189], v[188:189], 1.0 op_sel_hi:[1,0]
    v_pk_add_f32 v[190:191], v[190:191], 1.0 op_sel_hi:[1,0]
    v_rcp_f32 v184, v184
    v_rcp_f32 v185, v185
    v_rcp_f32 v186, v186
    v_rcp_f32 v187, v187
    v_rcp_f32 v188, v188
    v_rcp_f32 v189, v189
    v_rcp_f32 v190, v190
    s_mov_b32 s90, 1146880
    s_add_u32 m0, s93, 75776
    v_rcp_f32 v191, v191
    buffer_load_dwordx4 v7, s[20:23], s90 offen lds
    v_pk_mul_f32 v[184:185], v[184:185], v[176:177]
    v_pk_mul_f32 v[186:187], v[186:187], v[178:179]
    v_pk_mul_f32 v[188:189], v[188:189], v[180:181]
    v_pk_mul_f32 v[190:191], v[190:191], v[182:183]
    v_cvt_pk_bf16_f32 v134, v184, v185
    v_cvt_pk_bf16_f32 v135, v186, v187
    v_cvt_pk_bf16_f32 v148, v188, v189
    v_cvt_pk_bf16_f32 v149, v190, v191
    ds_read_b128 v[168:171], v53 offset:704
    ds_read_b128 v[172:175], v53 offset:1152
    s_waitcnt lgkmcnt(2)
    v_pk_fma_f32 v[176:177], v[160:161], v[212:213], v[164:165] op_sel:[0,1,0] op_sel_hi:[1,1,1] neg_lo:[0,1,0] neg_hi:[0,1,0]
    v_pk_fma_f32 v[178:179], v[162:163], v[212:213], v[166:167] op_sel:[0,1,0] op_sel_hi:[1,1,1] neg_lo:[0,1,0] neg_hi:[0,1,0]
    v_pk_fma_f32 v[180:181], v[160:161], v[214:215], v[164:165] op_sel:[0,1,0] op_sel_hi:[1,1,1] neg_lo:[0,1,0] neg_hi:[0,1,0]
    v_pk_fma_f32 v[182:183], v[162:163], v[214:215], v[166:167] op_sel:[0,1,0] op_sel_hi:[1,1,1] neg_lo:[0,1,0] neg_hi:[0,1,0]
    v_pk_fma_f32 v[176:177], v[80:81], v[212:213], v[176:177] op_sel_hi:[1,0,1]
    v_pk_fma_f32 v[178:179], v[82:83], v[212:213], v[178:179] op_sel_hi:[1,0,1]
    v_pk_fma_f32 v[180:181], v[108:109], v[214:215], v[180:181] op_sel_hi:[1,0,1]
    v_pk_fma_f32 v[182:183], v[110:111], v[214:215], v[182:183] op_sel_hi:[1,0,1]
    v_pk_mul_f32 v[184:185], v[176:177], v[176:177]
    s_mov_b32 s90, 372736
    s_add_u32 m0, s93, 30720
    v_pk_mul_f32 v[186:187], v[178:179], v[178:179]
    buffer_load_dwordx4 v7, s[20:23], s90 offen lds
    v_pk_mul_f32 v[188:189], v[180:181], v[180:181]
    v_pk_mul_f32 v[190:191], v[182:183], v[182:183]
    v_pk_fma_f32 v[184:185], v[184:185], v[62:63], v[62:63] op_sel:[0,1,0] op_sel_hi:[1,1,0]
    v_pk_fma_f32 v[186:187], v[186:187], v[62:63], v[62:63] op_sel:[0,1,0] op_sel_hi:[1,1,0]
    v_pk_fma_f32 v[188:189], v[188:189], v[62:63], v[62:63] op_sel:[0,1,0] op_sel_hi:[1,1,0]
    v_pk_fma_f32 v[190:191], v[190:191], v[62:63], v[62:63] op_sel:[0,1,0] op_sel_hi:[1,1,0]
    v_pk_mul_f32 v[184:185], v[184:185], v[176:177]
    v_pk_mul_f32 v[186:187], v[186:187], v[178:179]
    v_pk_mul_f32 v[188:189], v[188:189], v[180:181]
    v_pk_mul_f32 v[190:191], v[190:191], v[182:183]
    v_exp_f32 v184, v184
    v_exp_f32 v185, v185
    v_exp_f32 v186, v186
    v_exp_f32 v187, v187
    v_exp_f32 v188, v188
    s_mov_b32 s90, 1175552
    s_add_u32 m0, s93, 79872
    v_exp_f32 v189, v189
    buffer_load_dwordx4 v7, s[20:23], s90 offen lds
    v_exp_f32 v190, v190
    v_exp_f32 v191, v191
    v_pk_add_f32 v[184:185], v[184:185], 1.0 op_sel_hi:[1,0]
    v_pk_add_f32 v[186:187], v[186:187], 1.0 op_sel_hi:[1,0]
    v_pk_add_f32 v[188:189], v[188:189], 1.0 op_sel_hi:[1,0]
    v_pk_add_f32 v[190:191], v[190:191], 1.0 op_sel_hi:[1,0]
    v_rcp_f32 v184, v184
    v_rcp_f32 v185, v185
    v_rcp_f32 v186, v186
    v_rcp_f32 v187, v187
    v_rcp_f32 v188, v188
    v_rcp_f32 v189, v189
    v_rcp_f32 v190, v190
    v_rcp_f32 v191, v191
    v_pk_mul_f32 v[184:185], v[184:185], v[176:177]
    v_pk_mul_f32 v[186:187], v[186:187], v[178:179]
    v_pk_mul_f32 v[188:189], v[188:189], v[180:181]
    v_pk_mul_f32 v[190:191], v[190:191], v[182:183]
    v_cvt_pk_bf16_f32 v136, v184, v185
    v_cvt_pk_bf16_f32 v137, v186, v187
    v_cvt_pk_bf16_f32 v150, v188, v189
    v_cvt_pk_bf16_f32 v151, v190, v191
    ds_read_b128 v[160:163], v53 offset:768
    ds_read_b128 v[164:167], v53 offset:1216
    s_waitcnt lgkmcnt(2)
    v_pk_fma_f32 v[176:177], v[168:169], v[212:213], v[172:173] op_sel:[0,1,0] op_sel_hi:[1,1,1] neg_lo:[0,1,0] neg_hi:[0,1,0]
    v_pk_fma_f32 v[178:179], v[170:171], v[212:213], v[174:175] op_sel:[0,1,0] op_sel_hi:[1,1,1] neg_lo:[0,1,0] neg_hi:[0,1,0]
    v_pk_fma_f32 v[180:181], v[168:169], v[214:215], v[172:173] op_sel:[0,1,0] op_sel_hi:[1,1,1] neg_lo:[0,1,0] neg_hi:[0,1,0]
    v_pk_fma_f32 v[182:183], v[170:171], v[214:215], v[174:175] op_sel:[0,1,0] op_sel_hi:[1,1,1] neg_lo:[0,1,0] neg_hi:[0,1,0]
    v_pk_fma_f32 v[176:177], v[84:85], v[212:213], v[176:177] op_sel_hi:[1,0,1]
    v_pk_fma_f32 v[178:179], v[86:87], v[212:213], v[178:179] op_sel_hi:[1,0,1]
    v_pk_fma_f32 v[180:181], v[112:113], v[214:215], v[180:181] op_sel_hi:[1,0,1]
    v_pk_fma_f32 v[182:183], v[114:115], v[214:215], v[182:183] op_sel_hi:[1,0,1]
    v_pk_mul_f32 v[184:185], v[176:177], v[176:177]
    v_pk_mul_f32 v[186:187], v[178:179], v[178:179]
    v_pk_mul_f32 v[188:189], v[180:181], v[180:181]
    v_pk_mul_f32 v[190:191], v[182:183], v[182:183]
    v_pk_fma_f32 v[184:185], v[184:185], v[62:63], v[62:63] op_sel:[0,1,0] op_sel_hi:[1,1,0]
    v_pk_fma_f32 v[186:187], v[186:187], v[62:63], v[62:63] op_sel:[0,1,0] op_sel_hi:[1,1,0]
    v_pk_fma_f32 v[188:189], v[188:189], v[62:63], v[62:63] op_sel:[0,1,0] op_sel_hi:[1,1,0]
    v_pk_fma_f32 v[190:191], v[190:191], v[62:63], v[62:63] op_sel:[0,1,0] op_sel_hi:[1,1,0]
    v_pk_mul_f32 v[184:185], v[184:185], v[176:177]
    v_pk_mul_f32 v[186:187], v[186:187], v[178:179]
    v_pk_mul_f32 v[188:189], v[188:189], v[180:181]
    v_pk_mul_f32 v[190:191], v[190:191], v[182:183]
    v_exp_f32 v184, v184
    v_exp_f32 v185, v185
    v_exp_f32 v186, v186
    v_exp_f32 v187, v187
    v_exp_f32 v188, v188
    v_exp_f32 v189, v189
    v_exp_f32 v190, v190
    v_exp_f32 v191, v191
    v_pk_add_f32 v[184:185], v[184:185], 1.0 op_sel_hi:[1,0]
    v_pk_add_f32 v[186:187], v[186:187], 1.0 op_sel_hi:[1,0]
    v_pk_add_f32 v[188:189], v[188:189], 1.0 op_sel_hi:[1,0]
    v_pk_add_f32 v[190:191], v[190:191], 1.0 op_sel_hi:[1,0]
    v_rcp_f32 v184, v184
    v_rcp_f32 v185, v185
    v_rcp_f32 v186, v186
    v_rcp_f32 v187, v187
    v_rcp_f32 v188, v188
    v_rcp_f32 v189, v189
    v_rcp_f32 v190, v190
    v_rcp_f32 v191, v191
    v_pk_mul_f32 v[184:185], v[184:185], v[176:177]
    v_pk_mul_f32 v[186:187], v[186:187], v[178:179]
    v_pk_mul_f32 v[188:189], v[188:189], v[180:181]
    v_pk_mul_f32 v[190:191], v[190:191], v[182:183]
    v_cvt_pk_bf16_f32 v138, v184, v185
    v_cvt_pk_bf16_f32 v139, v186, v187
    v_cvt_pk_bf16_f32 v152, v188, v189
    v_cvt_pk_bf16_f32 v153, v190, v191
    s_waitcnt lgkmcnt(0)
    v_pk_fma_f32 v[176:177], v[160:161], v[212:213], v[164:165] op_sel:[0,1,0] op_sel_hi:[1,1,1] neg_lo:[0,1,0] neg_hi:[0,1,0]
    v_pk_fma_f32 v[178:179], v[162:163], v[212:213], v[166:167] op_sel:[0,1,0] op_sel_hi:[1,1,1] neg_lo:[0,1,0] neg_hi:[0,1,0]
    v_pk_fma_f32 v[180:181], v[160:161], v[214:215], v[164:165] op_sel:[0,1,0] op_sel_hi:[1,1,1] neg_lo:[0,1,0] neg_hi:[0,1,0]
    v_pk_fma_f32 v[182:183], v[162:163], v[214:215], v[166:167] op_sel:[0,1,0] op_sel_hi:[1,1,1] neg_lo:[0,1,0] neg_hi:[0,1,0]
    v_pk_fma_f32 v[176:177], v[88:89], v[212:213], v[176:177] op_sel_hi:[1,0,1]
    v_pk_fma_f32 v[178:179], v[90:91], v[212:213], v[178:179] op_sel_hi:[1,0,1]
    v_pk_fma_f32 v[180:181], v[116:117], v[214:215], v[180:181] op_sel_hi:[1,0,1]
    v_pk_fma_f32 v[182:183], v[118:119], v[214:215], v[182:183] op_sel_hi:[1,0,1]
    v_pk_mul_f32 v[184:185], v[176:177], v[176:177]
    v_pk_mul_f32 v[186:187], v[178:179], v[178:179]
    v_pk_mul_f32 v[188:189], v[180:181], v[180:181]
    v_pk_mul_f32 v[190:191], v[182:183], v[182:183]
    v_pk_fma_f32 v[184:185], v[184:185], v[62:63], v[62:63] op_sel:[0,1,0] op_sel_hi:[1,1,0]
    v_pk_fma_f32 v[186:187], v[186:187], v[62:63], v[62:63] op_sel:[0,1,0] op_sel_hi:[1,1,0]
    v_pk_fma_f32 v[188:189], v[188:189], v[62:63], v[62:63] op_sel:[0,1,0] op_sel_hi:[1,1,0]
    v_pk_fma_f32 v[190:191], v[190:191], v[62:63], v[62:63] op_sel:[0,1,0] op_sel_hi:[1,1,0]
    v_pk_mul_f32 v[184:185], v[184:185], v[176:177]
    v_pk_mul_f32 v[186:187], v[186:187], v[178:179]
    v_pk_mul_f32 v[188:189], v[188:189], v[180:181]
    v_pk_mul_f32 v[190:191], v[190:191], v[182:183]
    v_exp_f32 v184, v184
    v_exp_f32 v185, v185
    v_exp_f32 v186, v186
    v_exp_f32 v187, v187
    v_exp_f32 v188, v188
    v_exp_f32 v189, v189
    v_exp_f32 v190, v190
    v_exp_f32 v191, v191
    v_pk_add_f32 v[184:185], v[184:185], 1.0 op_sel_hi:[1,0]
    v_pk_add_f32 v[186:187], v[186:187], 1.0 op_sel_hi:[1,0]
    v_pk_add_f32 v[188:189], v[188:189], 1.0 op_sel_hi:[1,0]
    v_pk_add_f32 v[190:191], v[190:191], 1.0 op_sel_hi:[1,0]
    v_rcp_f32 v184, v184
    v_rcp_f32 v185, v185
    v_rcp_f32 v186, v186
    v_rcp_f32 v187, v187
    v_rcp_f32 v188, v188
    v_rcp_f32 v189, v189
    v_rcp_f32 v190, v190
    v_rcp_f32 v191, v191
    v_pk_mul_f32 v[184:185], v[184:185], v[176:177]
    v_pk_mul_f32 v[186:187], v[186:187], v[178:179]
    v_pk_mul_f32 v[188:189], v[188:189], v[180:181]
    v_pk_mul_f32 v[190:191], v[190:191], v[182:183]
    v_cvt_pk_bf16_f32 v140, v184, v185
    v_cvt_pk_bf16_f32 v141, v186, v187
    v_cvt_pk_bf16_f32 v154, v188, v189
    v_cvt_pk_bf16_f32 v155, v190, v191
    s_bitcmp1_b32 s41, 0
    s_cbranch_scc1 L_h_odd_33
    s_cmp_eq_u32 s44, 0
    s_cbranch_scc1 L_st_slow_35
    buffer_store_dwordx4 v[128:131], v2, s[24:27], s82 offen offset:0
    buffer_store_dwordx4 v[132:135], v2, s[24:27], s82 offen offset:1024
    buffer_store_dwordx4 v[136:139], v2, s[24:27], s82 offen offset:2048
    buffer_store_dwordx2 v[140:141], v2, s[24:27], s82 offen offset:3072
    buffer_store_dwordx4 v[142:145], v2, s[24:27], s83 offen offset:0
    buffer_store_dwordx4 v[146:149], v2, s[24:27], s83 offen offset:1024
    buffer_store_dwordx4 v[150:153], v2, s[24:27], s83 offen offset:2048
    buffer_store_dwordx2 v[154:155], v2, s[24:27], s83 offen offset:3072
    s_branch L_st_done_36
L_st_slow_35:
    buffer_store_dwordx4 v[128:131], v2, s[24:27], s82 offen offset:0 sc1
    buffer_store_dwordx4 v[132:135], v2, s[24:27], s82 offen offset:1024 sc1
    buffer_store_dwordx4 v[136:139], v2, s[24:27], s82 offen offset:2048 sc1
    buffer_store_dwordx2 v[140:141], v2, s[24:27], s82 offen offset:3072 sc1
    buffer_store_dwordx4 v[142:145], v2, s[24:27], s83 offen offset:0 sc1
    buffer_store_dwordx4 v[146:149], v2, s[24:27], s83 offen offset:1024 sc1
    buffer_store_dwordx4 v[150:153], v2, s[24:27], s83 offen offset:2048 sc1
    buffer_store_dwordx2 v[154:155], v2, s[24:27], s83 offen offset:3072 sc1
L_st_done_36:
    s_branch L_h_done_34
L_h_odd_33:
    s_cmp_eq_u32 s44, 0
    s_cbranch_scc1 L_st_slow_37
    buffer_store_dwordx2 v[128:129], v2, s[24:27], s82 offen offset:8
    buffer_store_dwordx4 v[130:133], v2, s[24:27], s82 offen offset:1024
    buffer_store_dwordx4 v[134:137], v2, s[24:27], s82 offen offset:2048
    buffer_store_dwordx4 v[138:141], v2, s[24:27], s82 offen offset:3072
    buffer_store_dwordx2 v[142:143], v2, s[24:27], s83 offen offset:8
    buffer_store_dwordx4 v[144:147], v2, s[24:27], s83 offen offset:1024
    buffer_store_dwordx4 v[148:151], v2, s[24:27], s83 offen offset:2048
    buffer_store_dwordx4 v[152:155], v2, s[24:27], s83 offen offset:3072
    s_branch L_st_done_38
L_st_slow_37:
    buffer_store_dwordx2 v[128:129], v2, s[24:27], s82 offen offset:8 sc1
    buffer_store_dwordx4 v[130:133], v2, s[24:27], s82 offen offset:1024 sc1
    buffer_store_dwordx4 v[134:137], v2, s[24:27], s82 offen offset:2048 sc1
    buffer_store_dwordx4 v[138:141], v2, s[24:27], s82 offen offset:3072 sc1
    buffer_store_dwordx2 v[142:143], v2, s[24:27], s83 offen offset:8 sc1
    buffer_store_dwordx4 v[144:147], v2, s[24:27], s83 offen offset:1024 sc1
    buffer_store_dwordx4 v[148:151], v2, s[24:27], s83 offen offset:2048 sc1
    buffer_store_dwordx4 v[152:155], v2, s[24:27], s83 offen offset:3072 sc1
L_st_done_38:
L_h_done_34:
    s_add_u32 s45, s45, 1
    v_mov_b32 v254, s45
    v_mov_b32 v255, 0
    s_waitcnt vmcnt(0)
    s_mov_b64 exec, 1
    s_cmp_eq_u32 s44, 0
    s_cbranch_scc1 L_sig_slow_39
    buffer_store_dword v254, v255, s[24:27], s94 offen
    s_branch L_sig_done_40
L_sig_slow_39:
    buffer_store_dword v254, v255, s[24:27], s94 offen sc1
L_sig_done_40:
    s_mov_b64 exec, -1
    s_mov_b32 s90, 401408
    s_add_u32 m0, s93, 34816
    s_nop 0
    buffer_load_dwordx4 v7, s[20:23], s90 offen lds
    s_mov_b32 s90, 1204224
    s_add_u32 m0, s93, 83968
    s_nop 0
    buffer_load_dwordx4 v7, s[20:23], s90 offen lds
    s_mov_b32 s90, 430080
    s_add_u32 m0, s93, 38912
    s_nop 0
    buffer_load_dwordx4 v7, s[20:23], s90 offen lds
    s_mov_b32 s90, 1232896
    s_add_u32 m0, s93, 88064
    s_nop 0
    buffer_load_dwordx4 v7, s[20:23], s90 offen lds
    s_mov_b32 s90, 458752
    s_add_u32 m0, s93, 43008
    s_nop 0
    buffer_load_dwordx4 v7, s[20:23], s90 offen lds
    s_mov_b32 s90, 1261568
    s_add_u32 m0, s93, 92160
    s_nop 0
    buffer_load_dwordx4 v7, s[20:23], s90 offen lds
    s_mov_b32 s90, 487424
    s_add_u32 m0, s93, 47104
    s_nop 0
    buffer_load_dwordx4 v7, s[20:23], s90 offen lds
    s_mov_b32 s90, 1290240
    s_add_u32 m0, s93, 96256
    s_nop 0
    buffer_load_dwordx4 v7, s[20:23], s90 offen lds
    s_mov_b32 s90, 516096
    s_add_u32 m0, s93, 51200
    s_nop 0
    buffer_load_dwordx4 v7, s[20:23], s90 offen lds
    s_mov_b32 s90, 1318912
    s_add_u32 m0, s93, 100352
    s_nop 0
    buffer_load_dwordx4 v7, s[20:23], s90 offen lds
    s_mov_b32 s90, 544768
    buffer_load_dwordx4 a[0:3], v7, s[20:23], s90 offen
    s_mov_b32 s90, 1347584
    buffer_load_dwordx4 a[36:39], v7, s[20:23], s90 offen
    s_mov_b32 s90, 573440
    buffer_load_dwordx4 a[4:7], v7, s[20:23], s90 offen
    s_mov_b32 s90, 1376256
    buffer_load_dwordx4 a[40:43], v7, s[20:23], s90 offen
    s_mov_b32 s90, 602112
    buffer_load_dwordx4 a[8:11], v7, s[20:23], s90 offen
    s_mov_b32 s90, 1404928
    buffer_load_dwordx4 a[44:47], v7, s[20:23], s90 offen
    s_mov_b32 s90, 630784
    buffer_load_dwordx4 a[12:15], v7, s[20:23], s90 offen
    s_mov_b32 s90, 1433600
    buffer_load_dwordx4 a[48:51], v7, s[20:23], s90 offen
    s_mov_b32 s90, 659456
    buffer_load_dwordx4 a[16:19], v7, s[20:23], s90 offen
    s_mov_b32 s90, 1462272
    buffer_load_dwordx4 a[52:55], v7, s[20:23], s90 offen
    s_mov_b32 s90, 688128
    buffer_load_dwordx4 a[20:23], v7, s[20:23], s90 offen
    s_mov_b32 s90, 1490944
    buffer_load_dwordx4 a[56:59], v7, s[20:23], s90 offen
    s_mov_b32 s90, 716800
    buffer_load_dwordx4 a[24:27], v7, s[20:23], s90 offen
    s_mov_b32 s90, 1519616
    buffer_load_dwordx4 a[60:63], v7, s[20:23], s90 offen
    s_mov_b32 s90, 745472
    buffer_load_dwordx4 a[28:31], v7, s[20:23], s90 offen
    s_mov_b32 s90, 1548288
    buffer_load_dwordx4 a[64:67], v7, s[20:23], s90 offen
    s_mov_b32 s90, 774144
    buffer_load_dwordx4 a[32:35], v7, s[20:23], s90 offen
    s_mov_b32 s90, 1576960
    buffer_load_dwordx4 a[68:71], v7, s[20:23], s90 offen
    s_xor_b32 s79, s0, 1
    s_mul_i32 s78, s0, 57344
    s_mul_i32 s79, s79, 57344
    s_mul_i32 s81, s49, 28672
    s_add_u32 s81, s81, 4194304
    s_add_u32 s78, s78, s81
    s_add_u32 s79, s79, s81
    s_mul_i32 s82, s0, 14
    s_add_u32 s82, s82, s71
    s_lshl_b32 s82, s82, 10
    s_lshl_b32 s83, s0, 10
    s_lshl_b32 s84, s47, 3
    s_add_u32 s83, s83, s84
    s_add_u32 s72, s82, 2097152
    s_mov_b32 s96, 0
L_poll_43:
    buffer_load_dword v254, v3, s[24:27], s70 offen sc1
    s_add_u32 s96, s96, 1
    s_cmp_gt_u32 s96, 200000
    s_cbranch_scc1 L_end
    s_waitcnt vmcnt(0)
    v_cmp_gt_u32 vcc, s45, v254
    s_nop 3
    s_and_b64 vcc, vcc, s[68:69]
    s_cbranch_vccnz L_poll_43
    s_cmp_eq_u32 s66, 0
    s_cbranch_scc1 L_w2_idle_41
    buffer_load_dwordx4 v[100:103], v2, s[24:27], s79 offen offset:0 sc1
    buffer_load_dwordx4 v[96:99], v2, s[24:27], s78 offen offset:0 sc1
    buffer_load_dwordx4 v[108:111], v2, s[24:27], s79 offen offset:1024 sc1
    buffer_load_dwordx4 v[104:107], v2, s[24:27], s78 offen offset:1024 sc1
    buffer_load_dwordx4 v[116:119], v2, s[24:27], s79 offen offset:2048 sc1
    buffer_load_dwordx4 v[112:115], v2, s[24:27], s78 offen offset:2048 sc1
    buffer_load_dwordx4 v[124:127], v2, s[24:27], s79 offen offset:3072 sc1
    buffer_load_dwordx4 v[120:123], v2, s[24:27], s78 offen offset:3072 sc1
    s_add_u32 s78, s78, 4096
    s_add_u32 s79, s79, 4096
    buffer_load_dwordx4 v[132:135], v2, s[24:27], s79 offen offset:0 sc1
    buffer_load_dwordx4 v[128:131], v2, s[24:27], s78 offen offset:0 sc1
    s_barrier
    s_add_u32 s73, s93, 106496
    v_add_u32 v192, s73, v2
    s_add_u32 s73, s93, 6144
    v_add_u32 v193, s73, v2
    ds_read_b64_tr_b16 v[208:209], v8 offset:0
    ds_read_b64_tr_b16 v[210:211], v8 offset:2048
    ds_read_b64_tr_b16 v[212:213], v9 offset:0
    ds_read_b64_tr_b16 v[214:215], v9 offset:2048
    ds_read_b64_tr_b16 v[216:217], v10 offset:0
    ds_read_b64_tr_b16 v[218:219], v10 offset:2048
    ds_read_b64_tr_b16 v[220:221], v11 offset:0
    ds_read_b64_tr_b16 v[222:223], v11 offset:2048
    ds_read_b64_tr_b16 v[224:225], v8 offset:4096
    ds_read_b64_tr_b16 v[226:227], v8 offset:6144
    ds_read_b64_tr_b16 v[228:229], v9 offset:4096
    ds_read_b64_tr_b16 v[230:231], v9 offset:6144
    s_waitcnt lgkmcnt(8)
    s_waitcnt vmcnt(8)
    v_mfma_f32_16x16x32_bf16 v[64:67], v[208:211], v[96:99], 0
    ds_read_b64_tr_b16 v[232:233], v10 offset:4096
    v_mfma_f32_16x16x32_bf16 v[80:83], v[208:211], v[100:103], 0
    ds_read_b64_tr_b16 v[234:235], v10 offset:6144
    buffer_load_dwordx4 v[140:143], v2, s[24:27], s79 offen offset:1024 sc1
    v_mfma_f32_16x16x32_bf16 v[68:71], v[212:215], v[96:99], 0
    ds_read_b64_tr_b16 v[236:237], v11 offset:4096
    v_mfma_f32_16x16x32_bf16 v[84:87], v[212:215], v[100:103], 0
    ds_read_b64_tr_b16 v[238:239], v11 offset:6144
    s_waitcnt lgkmcnt(8)
    v_mfma_f32_16x16x32_bf16 v[72:75], v[216:219], v[96:99], 0
    ds_read_b64_tr_b16 v[208:209], v8 offset:8192
    v_mfma_f32_16x16x32_bf16 v[88:91], v[216:219], v[100:103], 0
    ds_read_b64_tr_b16 v[210:211], v8 offset:10240
    buffer_load_dwordx4 v[136:139], v2, s[24:27], s78 offen offset:1024 sc1
    v_mfma_f32_16x16x32_bf16 v[76:79], v[220:223], v[96:99], 0
    ds_read_b64_tr_b16 v[212:213], v9 offset:8192
    v_mfma_f32_16x16x32_bf16 v[92:95], v[220:223], v[100:103], 0
    ds_read_b64_tr_b16 v[214:215], v9 offset:10240
    s_waitcnt lgkmcnt(8)
    s_waitcnt vmcnt(8)
    v_mfma_f32_16x16x32_bf16 v[64:67], v[224:227], v[104:107], v[64:67]
    ds_read_b64_tr_b16 v[216:217], v10 offset:8192
    v_mfma_f32_16x16x32_bf16 v[80:83], v[224:227], v[108:111], v[80:83]
    ds_read_b64_tr_b16 v[218:219], v10 offset:10240
    buffer_load_dwordx4 v[148:151], v2, s[24:27], s79 offen offset:2048 sc1
    v_mfma_f32_16x16x32_bf16 v[68:71], v[228:231], v[104:107], v[68:71]
    ds_read_b64_tr_b16 v[220:221], v11 offset:8192
    v_mfma_f32_16x16x32_bf16 v[84:87], v[228:231], v[108:111], v[84:87]
    ds_read_b64_tr_b16 v[222:223], v11 offset:10240
    s_waitcnt lgkmcnt(8)
    v_mfma_f32_16x16x32_bf16 v[72:75], v[232:235], v[104:107], v[72:75]
    ds_read_b64_tr_b16 v[224:225], v8 offset:12288
    v_mfma_f32_16x16x32_bf16 v[88:91], v[232:235], v[108:111], v[88:91]
    ds_read_b64_tr_b16 v[226:227], v8 offset:14336
    buffer_load_dwordx4 v[144:147], v2, s[24:27], s78 offen offset:2048 sc1
    v_mfma_f32_16x16x32_bf16 v[76:79], v[236:239], v[104:107], v[76:79]
    ds_read_b64_tr_b16 v[228:229], v9 offset:12288
    v_mfma_f32_16x16x32_bf16 v[92:95], v[236:239], v[108:111], v[92:95]
    ds_read_b64_tr_b16 v[230:231], v9 offset:14336
    s_waitcnt lgkmcnt(8)
    s_waitcnt vmcnt(8)
    v_mfma_f32_16x16x32_bf16 v[64:67], v[208:211], v[112:115], v[64:67]
    ds_read_b64_tr_b16 v[232:233], v10 offset:12288
    v_mfma_f32_16x16x32_bf16 v[80:83], v[208:211], v[116:119], v[80:83]
    ds_read_b64_tr_b16 v[234:235], v10 offset:14336
    buffer_load_dwordx4 v[156:159], v2, s[24:27], s79 offen offset:3072 sc1
    v_mfma_f32_16x16x32_bf16 v[68:71], v[212:215], v[112:115], v[68:71]
    ds_read_b64_tr_b16 v[236:237], v11 offset:12288
    v_mfma_f32_16x16x32_bf16 v[84:87], v[212:215], v[116:119], v[84:87]
    ds_read_b64_tr_b16 v[238:239], v11 offset:14336
    s_waitcnt lgkmcnt(8)
    v_mfma_f32_16x16x32_bf16 v[72:75], v[216:219], v[112:115], v[72:75]
    ds_read_b64_tr_b16 v[208:209], v8 offset:16384
    v_mfma_f32_16x16x32_bf16 v[88:91], v[216:219], v[116:119], v[88:91]
    ds_read_b64_tr_b16 v[210:211], v8 offset:18432
    buffer_load_dwordx4 v[152:155], v2, s[24:27], s78 offen offset:3072 sc1
    v_mfma_f32_16x16x32_bf16 v[76:79], v[220:223], v[112:115], v[76:79]
    ds_read_b64_tr_b16 v[212:213], v9 offset:16384
    v_mfma_f32_16x16x32_bf16 v[92:95], v[220:223], v[116:119], v[92:95]
    ds_read_b64_tr_b16 v[214:215], v9 offset:18432
    s_waitcnt lgkmcnt(8)
    s_waitcnt vmcnt(8)
    v_mfma_f32_16x16x32_bf16 v[64:67], v[224:227], v[120:123], v[64:67]
    ds_read_b64_tr_b16 v[216:217], v10 offset:16384
    v_mfma_f32_16x16x32_bf16 v[80:83], v[224:227], v[124:127], v[80:83]
    ds_read_b64_tr_b16 v[218:219], v10 offset:18432
    s_add_u32 s78, s78, 4096
    s_add_u32 s79, s79, 4096
    buffer_load_dwordx4 v[164:167], v2, s[24:27], s79 offen offset:0 sc1
    v_mfma_f32_16x16x32_bf16 v[68:71], v[228:231], v[120:123], v[68:71]
    ds_read_b64_tr_b16 v[220:221], v11 offset:16384
    v_mfma_f32_16x16x32_bf16 v[84:87], v[228:231], v[124:127], v[84:87]
    ds_read_b64_tr_b16 v[222:223], v11 offset:18432
    s_waitcnt lgkmcnt(8)
    v_mfma_f32_16x16x32_bf16 v[72:75], v[232:235], v[120:123], v[72:75]
    ds_read_b64_tr_b16 v[224:225], v8 offset:20480
    v_mfma_f32_16x16x32_bf16 v[88:91], v[232:235], v[124:127], v[88:91]
    ds_read_b64_tr_b16 v[226:227], v8 offset:22528
    buffer_load_dwordx4 v[160:163], v2, s[24:27], s78 offen offset:0 sc1
    v_mfma_f32_16x16x32_bf16 v[76:79], v[236:239], v[120:123], v[76:79]
    ds_read_b64_tr_b16 v[228:229], v9 offset:20480
    v_mfma_f32_16x16x32_bf16 v[92:95], v[236:239], v[124:127], v[92:95]
    ds_read_b64_tr_b16 v[230:231], v9 offset:22528
    s_waitcnt lgkmcnt(8)
    s_waitcnt vmcnt(8)
    v_mfma_f32_16x16x32_bf16 v[64:67], v[208:211], v[128:131], v[64:67]
    ds_read_b64_tr_b16 v[232:233], v10 offset:20480
    v_mfma_f32_16x16x32_bf16 v[80:83], v[208:211], v[132:135], v[80:83]
    ds_read_b64_tr_b16 v[234:235], v10 offset:22528
    buffer_load_dwordx4 v[172:175], v2, s[24:27], s79 offen offset:1024 sc1
    v_mfma_f32_16x16x32_bf16 v[68:71], v[212:215], v[128:131], v[68:71]
    ds_read_b64_tr_b16 v[236:237], v11 offset:20480
    v_mfma_f32_16x16x32_bf16 v[84:87], v[212:215], v[132:135], v[84:87]
    ds_read_b64_tr_b16 v[238:239], v11 offset:22528
    s_waitcnt lgkmcnt(8)
    v_mfma_f32_16x16x32_bf16 v[72:75], v[216:219], v[128:131], v[72:75]
    ds_read_b64_tr_b16 v[208:209], v8 offset:24576
    v_mfma_f32_16x16x32_bf16 v[88:91], v[216:219], v[132:135], v[88:91]
    ds_read_b64_tr_b16 v[210:211], v8 offset:26624
    buffer_load_dwordx4 v[168:171], v2, s[24:27], s78 offen offset:1024 sc1
    v_mfma_f32_16x16x32_bf16 v[76:79], v[220:223], v[128:131], v[76:79]
    ds_read_b64_tr_b16 v[212:213], v9 offset:24576
    v_mfma_f32_16x16x32_bf16 v[92:95], v[220:223], v[132:135], v[92:95]
    ds_read_b64_tr_b16 v[214:215], v9 offset:26624
    s_waitcnt lgkmcnt(8)
    s_waitcnt vmcnt(8)
    v_mfma_f32_16x16x32_bf16 v[64:67], v[224:227], v[136:139], v[64:67]
    ds_read_b64_tr_b16 v[216:217], v10 offset:24576
    v_mfma_f32_16x16x32_bf16 v[80:83], v[224:227], v[140:143], v[80:83]
    ds_read_b64_tr_b16 v[218:219], v10 offset:26624
    buffer_load_dwordx4 v[180:183], v2, s[24:27], s79 offen offset:2048 sc1
    v_mfma_f32_16x16x32_bf16 v[68:71], v[228:231], v[136:139], v[68:71]
    ds_read_b64_tr_b16 v[220:221], v11 offset:24576
    v_mfma_f32_16x16x32_bf16 v[84:87], v[228:231], v[140:143], v[84:87]
    ds_read_b64_tr_b16 v[222:223], v11 offset:26624
    s_waitcnt lgkmcnt(8)
    v_mfma_f32_16x16x32_bf16 v[72:75], v[232:235], v[136:139], v[72:75]
    ds_read_b64_tr_b16 v[224:225], v21 offset:0
    v_mfma_f32_16x16x32_bf16 v[88:91], v[232:235], v[140:143], v[88:91]
    ds_read_b64_tr_b16 v[226:227], v21 offset:2048
    buffer_load_dwordx4 v[176:179], v2, s[24:27], s78 offen offset:2048 sc1
    v_mfma_f32_16x16x32_bf16 v[76:79], v[236:239], v[136:139], v[76:79]
    ds_read_b64_tr_b16 v[228:229], v22 offset:0
    v_mfma_f32_16x16x32_bf16 v[92:95], v[236:239], v[140:143], v[92:95]
    ds_read_b64_tr_b16 v[230:231], v22 offset:2048
    s_waitcnt lgkmcnt(8)
    s_waitcnt vmcnt(8)
    v_mfma_f32_16x16x32_bf16 v[64:67], v[208:211], v[144:147], v[64:67]
    ds_read_b64_tr_b16 v[232:233], v23 offset:0
    v_mfma_f32_16x16x32_bf16 v[80:83], v[208:211], v[148:151], v[80:83]
    ds_read_b64_tr_b16 v[234:235], v23 offset:2048
    buffer_load_dwordx4 v[188:191], v2, s[24:27], s79 offen offset:3072 sc1
    v_mfma_f32_16x16x32_bf16 v[68:71], v[212:215], v[144:147], v[68:71]
    ds_read_b64_tr_b16 v[236:237], v24 offset:0
    v_mfma_f32_16x16x32_bf16 v[84:87], v[212:215], v[148:151], v[84:87]
    ds_read_b64_tr_b16 v[238:239], v24 offset:2048
    s_waitcnt lgkmcnt(8)
    v_mfma_f32_16x16x32_bf16 v[72:75], v[216:219], v[144:147], v[72:75]
    ds_read_b64_tr_b16 v[208:209], v21 offset:4096
    v_mfma_f32_16x16x32_bf16 v[88:91], v[216:219], v[148:151], v[88:91]
    ds_read_b64_tr_b16 v[210:211], v21 offset:6144
    buffer_load_dwordx4 v[184:187], v2, s[24:27], s78 offen offset:3072 sc1
    v_mfma_f32_16x16x32_bf16 v[76:79], v[220:223], v[144:147], v[76:79]
    ds_read_b64_tr_b16 v[212:213], v22 offset:4096
    v_mfma_f32_16x16x32_bf16 v[92:95], v[220:223], v[148:151], v[92:95]
    ds_read_b64_tr_b16 v[214:215], v22 offset:6144
    s_waitcnt lgkmcnt(8)
    s_waitcnt vmcnt(8)
    v_mfma_f32_16x16x32_bf16 v[64:67], v[224:227], v[152:155], v[64:67]
    ds_read_b64_tr_b16 v[216:217], v23 offset:4096
    v_mfma_f32_16x16x32_bf16 v[80:83], v[224:227], v[156:159], v[80:83]
    ds_read_b64_tr_b16 v[218:219], v23 offset:6144
    s_add_u32 s78, s78, 4096
    s_add_u32 s79, s79, 4096
    buffer_load_dwordx4 v[100:103], v2, s[24:27], s79 offen offset:0 sc1
    v_mfma_f32_16x16x32_bf16 v[68:71], v[228:231], v[152:155], v[68:71]
    ds_read_b64_tr_b16 v[220:221], v24 offset:4096
    v_mfma_f32_16x16x32_bf16 v[84:87], v[228:231], v[156:159], v[84:87]
    ds_read_b64_tr_b16 v[222:223], v24 offset:6144
    s_waitcnt lgkmcnt(8)
    v_mfma_f32_16x16x32_bf16 v[72:75], v[232:235], v[152:155], v[72:75]
    ds_read_b64_tr_b16 v[224:225], v21 offset:8192
    v_mfma_f32_16x16x32_bf16 v[88:91], v[232:235], v[156:159], v[88:91]
    ds_read_b64_tr_b16 v[226:227], v21 offset:10240
    buffer_load_dwordx4 v[96:99], v2, s[24:27], s78 offen offset:0 sc1
    v_mfma_f32_16x16x32_bf16 v[76:79], v[236:239], v[152:155], v[76:79]
    ds_read_b64_tr_b16 v[228:229], v22 offset:8192
    v_mfma_f32_16x16x32_bf16 v[92:95], v[236:239], v[156:159], v[92:95]
    ds_read_b64_tr_b16 v[230:231], v22 offset:10240
    s_waitcnt lgkmcnt(8)
    s_waitcnt vmcnt(8)
    v_mfma_f32_16x16x32_bf16 v[64:67], v[208:211], v[160:163], v[64:67]
    ds_read_b64_tr_b16 v[232:233], v23 offset:8192
    v_mfma_f32_16x16x32_bf16 v[80:83], v[208:211], v[164:167], v[80:83]
    ds_read_b64_tr_b16 v[234:235], v23 offset:10240
    buffer_load_dwordx4 v[108:111], v2, s[24:27], s79 offen offset:1024 sc1
    v_mfma_f32_16x16x32_bf16 v[68:71], v[212:215], v[160:163], v[68:71]
    ds_read_b64_tr_b16 v[236:237], v24 offset:8192
    v_mfma_f32_16x16x32_bf16 v[84:87], v[212:215], v[164:167], v[84:87]
    ds_read_b64_tr_b16 v[238:239], v24 offset:10240
    s_waitcnt lgkmcnt(8)
    v_mfma_f32_16x16x32_bf16 v[72:75], v[216:219], v[160:163], v[72:75]
    ds_read_b64_tr_b16 v[208:209], v21 offset:12288
    v_mfma_f32_16x16x32_bf16 v[88:91], v[216:219], v[164:167], v[88:91]
    ds_read_b64_tr_b16 v[210:211], v21 offset:14336
    buffer_load_dwordx4 v[104:107], v2, s[24:27], s78 offen offset:1024 sc1
    v_mfma_f32_16x16x32_bf16 v[76:79], v[220:223], v[160:163], v[76:79]
    ds_read_b64_tr_b16 v[212:213], v22 offset:12288
    v_mfma_f32_16x16x32_bf16 v[92:95], v[220:223], v[164:167], v[92:95]
    ds_read_b64_tr_b16 v[214:215], v22 offset:14336
    s_barrier
    s_waitcnt lgkmcnt(8)
    s_waitcnt vmcnt(8)
    v_mfma_f32_16x16x32_bf16 v[64:67], v[224:227], v[168:171], v[64:67]
    ds_read_b64_tr_b16 v[216:217], v23 offset:12288
    v_mfma_f32_16x16x32_bf16 v[80:83], v[224:227], v[172:175], v[80:83]
    ds_read_b64_tr_b16 v[218:219], v23 offset:14336
    ds_write_b128 v192, a[0:3] offset:0
    buffer_load_dwordx4 v[116:119], v2, s[24:27], s79 offen offset:2048 sc1
    v_mfma_f32_16x16x32_bf16 v[68:71], v[228:231], v[168:171], v[68:71]
    ds_read_b64_tr_b16 v[220:221], v24 offset:12288
    v_mfma_f32_16x16x32_bf16 v[84:87], v[228:231], v[172:175], v[84:87]
    ds_read_b64_tr_b16 v[222:223], v24 offset:14336
    ds_write_b128 v192, a[4:7] offset:4096
    s_waitcnt lgkmcnt(8)
    v_mfma_f32_16x16x32_bf16 v[72:75], v[232:235], v[168:171], v[72:75]
    ds_read_b64_tr_b16 v[224:225], v21 offset:16384
    v_mfma_f32_16x16x32_bf16 v[88:91], v[232:235], v[172:175], v[88:91]
    ds_read_b64_tr_b16 v[226:227], v21 offset:18432
    buffer_load_dwordx4 v[112:115], v2, s[24:27], s78 offen offset:2048 sc1
    v_mfma_f32_16x16x32_bf16 v[76:79], v[236:239], v[168:171], v[76:79]
    ds_read_b64_tr_b16 v[228:229], v22 offset:16384
    v_mfma_f32_16x16x32_bf16 v[92:95], v[236:239], v[172:175], v[92:95]
    ds_read_b64_tr_b16 v[230:231], v22 offset:18432
    ds_write_b128 v192, a[8:11] offset:8192
    s_waitcnt lgkmcnt(8)
    s_waitcnt vmcnt(8)
    v_mfma_f32_16x16x32_bf16 v[64:67], v[208:211], v[176:179], v[64:67]
    ds_read_b64_tr_b16 v[232:233], v23 offset:16384
    v_mfma_f32_16x16x32_bf16 v[80:83], v[208:211], v[180:183], v[80:83]
    ds_read_b64_tr_b16 v[234:235], v23 offset:18432
    ds_write_b128 v192, a[12:15] offset:12288
    buffer_load_dwordx4 v[124:127], v2, s[24:27], s79 offen offset:3072 sc1
    v_mfma_f32_16x16x32_bf16 v[68:71], v[212:215], v[176:179], v[68:71]
    ds_read_b64_tr_b16 v[236:237], v24 offset:16384
    v_mfma_f32_16x16x32_bf16 v[84:87], v[212:215], v[180:183], v[84:87]
    ds_read_b64_tr_b16 v[238:239], v24 offset:18432
    s_waitcnt lgkmcnt(8)
    v_mfma_f32_16x16x32_bf16 v[72:75], v[216:219], v[176:179], v[72:75]
    ds_read_b64_tr_b16 v[208:209], v21 offset:20480
    v_mfma_f32_16x16x32_bf16 v[88:91], v[216:219], v[180:183], v[88:91]
    ds_read_b64_tr_b16 v[210:211], v21 offset:22528
    ds_write_b128 v192, a[16:19] offset:16384
    buffer_load_dwordx4 v[120:123], v2, s[24:27], s78 offen offset:3072 sc1
    v_mfma_f32_16x16x32_bf16 v[76:79], v[220:223], v[176:179], v[76:79]
    ds_read_b64_tr_b16 v[212:213], v22 offset:20480
    v_mfma_f32_16x16x32_bf16 v[92:95], v[220:223], v[180:183], v[92:95]
    ds_read_b64_tr_b16 v[214:215], v22 offset:22528
    ds_write_b128 v192, a[20:23] offset:20480
    s_waitcnt lgkmcnt(8)
    s_waitcnt vmcnt(8)
    v_mfma_f32_16x16x32_bf16 v[64:67], v[224:227], v[184:187], v[64:67]
    ds_read_b64_tr_b16 v[216:217], v23 offset:20480
    v_mfma_f32_16x16x32_bf16 v[80:83], v[224:227], v[188:191], v[80:83]
    ds_read_b64_tr_b16 v[218:219], v23 offset:22528
    s_add_u32 s78, s78, 4096
    s_add_u32 s79, s79, 4096
    buffer_load_dwordx4 v[132:135], v2, s[24:27], s79 offen offset:0 sc1
    v_mfma_f32_16x16x32_bf16 v[68:71], v[228:231], v[184:187], v[68:71]
    ds_read_b64_tr_b16 v[220:221], v24 offset:20480
    v_mfma_f32_16x16x32_bf16 v[84:87], v[228:231], v[188:191], v[84:87]
    ds_read_b64_tr_b16 v[222:223], v24 offset:22528
    ds_write_b128 v192, a[24:27] offset:24576
    s_waitcnt lgkmcnt(8)
    v_mfma_f32_16x16x32_bf16 v[72:75], v[232:235], v[184:187], v[72:75]
    ds_read_b64_tr_b16 v[224:225], v21 offset:24576
    v_mfma_f32_16x16x32_bf16 v[88:91], v[232:235], v[188:191], v[88:91]
    ds_read_b64_tr_b16 v[226:227], v21 offset:26624
    ds_write_b128 v193, a[28:31] offset:0
    buffer_load_dwordx4 v[128:131], v2, s[24:27], s78 offen offset:0 sc1
    v_mfma_f32_16x16x32_bf16 v[76:79], v[236:239], v[184:187], v[76:79]
    ds_read_b64_tr_b16 v[228:229], v22 offset:24576
    v_mfma_f32_16x16x32_bf16 v[92:95], v[236:239], v[188:191], v[92:95]
    ds_read_b64_tr_b16 v[230:231], v22 offset:26624
    s_waitcnt lgkmcnt(8)
    s_waitcnt vmcnt(8)
    v_mfma_f32_16x16x32_bf16 v[64:67], v[208:211], v[96:99], v[64:67]
    ds_read_b64_tr_b16 v[232:233], v23 offset:24576
    v_mfma_f32_16x16x32_bf16 v[80:83], v[208:211], v[100:103], v[80:83]
    ds_read_b64_tr_b16 v[234:235], v23 offset:26624
    ds_write_b128 v193, a[32:35] offset:4096
    buffer_load_dwordx4 v[140:143], v2, s[24:27], s79 offen offset:1024 sc1
    v_mfma_f32_16x16x32_bf16 v[68:71], v[212:215], v[96:99], v[68:71]
    ds_read_b64_tr_b16 v[236:237], v24 offset:24576
    v_mfma_f32_16x16x32_bf16 v[84:87], v[212:215], v[100:103], v[84:87]
    ds_read_b64_tr_b16 v[238:239], v24 offset:26624
    ds_write_b128 v192, a[36:39] offset:28672
    s_waitcnt lgkmcnt(8)
    v_mfma_f32_16x16x32_bf16 v[72:75], v[216:219], v[96:99], v[72:75]
    ds_read_b64_tr_b16 v[208:209], v21 offset:28672
    v_mfma_f32_16x16x32_bf16 v[88:91], v[216:219], v[100:103], v[88:91]
    ds_read_b64_tr_b16 v[210:211], v21 offset:30720
    buffer_load_dwordx4 v[136:139], v2, s[24:27], s78 offen offset:1024 sc1
    v_mfma_f32_16x16x32_bf16 v[76:79], v[220:223], v[96:99], v[76:79]
    ds_read_b64_tr_b16 v[212:213], v22 offset:28672
    v_mfma_f32_16x16x32_bf16 v[92:95], v[220:223], v[100:103], v[92:95]
    ds_read_b64_tr_b16 v[214:215], v22 offset:30720
    ds_write_b128 v192, a[40:43] offset:32768
    s_waitcnt lgkmcnt(8)
    s_waitcnt vmcnt(8)
    v_mfma_f32_16x16x32_bf16 v[64:67], v[224:227], v[104:107], v[64:67]
    ds_read_b64_tr_b16 v[216:217], v23 offset:28672
    v_mfma_f32_16x16x32_bf16 v[80:83], v[224:227], v[108:111], v[80:83]
    ds_read_b64_tr_b16 v[218:219], v23 offset:30720
    ds_write_b128 v192, a[44:47] offset:36864
    buffer_load_dwordx4 v[148:151], v2, s[24:27], s79 offen offset:2048 sc1
    v_mfma_f32_16x16x32_bf16 v[68:71], v[228:231], v[104:107], v[68:71]
    ds_read_b64_tr_b16 v[220:221], v24 offset:28672
    v_mfma_f32_16x16x32_bf16 v[84:87], v[228:231], v[108:111], v[84:87]
    ds_read_b64_tr_b16 v[222:223], v24 offset:30720
    s_waitcnt lgkmcnt(8)
    v_mfma_f32_16x16x32_bf16 v[72:75], v[232:235], v[104:107], v[72:75]
    ds_read_b64_tr_b16 v[224:225], v21 offset:32768
    v_mfma_f32_16x16x32_bf16 v[88:91], v[232:235], v[108:111], v[88:91]
    ds_read_b64_tr_b16 v[226:227], v21 offset:34816
    ds_write_b128 v192, a[48:51] offset:40960
    buffer_load_dwordx4 v[144:147], v2, s[24:27], s78 offen offset:2048 sc1
    v_mfma_f32_16x16x32_bf16 v[76:79], v[236:239], v[104:107], v[76:79]
    ds_read_b64_tr_b16 v[228:229], v22 offset:32768
    v_mfma_f32_16x16x32_bf16 v[92:95], v[236:239], v[108:111], v[92:95]
    ds_read_b64_tr_b16 v[230:231], v22 offset:34816
    ds_write_b128 v192, a[52:55] offset:45056
    s_waitcnt lgkmcnt(8)
    s_waitcnt vmcnt(8)
    v_mfma_f32_16x16x32_bf16 v[64:67], v[208:211], v[112:115], v[64:67]
    ds_read_b64_tr_b16 v[232:233], v23 offset:32768
    v_mfma_f32_16x16x32_bf16 v[80:83], v[208:211], v[116:119], v[80:83]
    ds_read_b64_tr_b16 v[234:235], v23 offset:34816
    buffer_load_dwordx4 v[156:159], v2, s[24:27], s79 offen offset:3072 sc1
    v_mfma_f32_16x16x32_bf16 v[68:71], v[212:215], v[112:115], v[68:71]
    ds_read_b64_tr_b16 v[236:237], v24 offset:32768
    v_mfma_f32_16x16x32_bf16 v[84:87], v[212:215], v[116:119], v[84:87]
    ds_read_b64_tr_b16 v[238:239], v24 offset:34816
    ds_write_b128 v192, a[56:59] offset:49152
    s_waitcnt lgkmcnt(8)
    v_mfma_f32_16x16x32_bf16 v[72:75], v[216:219], v[112:115], v[72:75]
    ds_read_b64_tr_b16 v[208:209], v21 offset:36864
    v_mfma_f32_16x16x32_bf16 v[88:91], v[216:219], v[116:119], v[88:91]
    ds_read_b64_tr_b16 v[210:211], v21 offset:38912
    ds_write_b128 v192, a[60:63] offset:53248
    buffer_load_dwordx4 v[152:155], v2, s[24:27], s78 offen offset:3072 sc1
    v_mfma_f32_16x16x32_bf16 v[76:79], v[220:223], v[112:115], v[76:79]
    ds_read_b64_tr_b16 v[212:213], v22 offset:36864
    v_mfma_f32_16x16x32_bf16 v[92:95], v[220:223], v[116:119], v[92:95]
    ds_read_b64_tr_b16 v[214:215], v22 offset:38912
    s_waitcnt lgkmcnt(8)
    s_waitcnt vmcnt(8)
    v_mfma_f32_16x16x32_bf16 v[64:67], v[224:227], v[120:123], v[64:67]
    ds_read_b64_tr_b16 v[216:217], v23 offset:36864
    v_mfma_f32_16x16x32_bf16 v[80:83], v[224:227], v[124:127], v[80:83]
    ds_read_b64_tr_b16 v[218:219], v23 offset:38912
    ds_write_b128 v193, a[64:67] offset:49152
    s_add_u32 s78, s78, 4096
    s_add_u32 s79, s79, 4096
    buffer_load_dwordx4 v[164:167], v2, s[24:27], s79 offen offset:0 sc1
    v_mfma_f32_16x16x32_bf16 v[68:71], v[228:231], v[120:123], v[68:71]
    ds_read_b64_tr_b16 v[220:221], v24 offset:36864
    v_mfma_f32_16x16x32_bf16 v[84:87], v[228:231], v[124:127], v[84:87]
    ds_read_b64_tr_b16 v[222:223], v24 offset:38912
    ds_write_b128 v193, a[68:71] offset:53248
    s_waitcnt lgkmcnt(8)
    v_mfma_f32_16x16x32_bf16 v[72:75], v[232:235], v[120:123], v[72:75]
    ds_read_b64_tr_b16 v[224:225], v21 offset:40960
    v_mfma_f32_16x16x32_bf16 v[88:91], v[232:235], v[124:127], v[88:91]
    ds_read_b64_tr_b16 v[226:227], v21 offset:43008
    buffer_load_dwordx4 v[160:163], v2, s[24:27], s78 offen offset:0 sc1
    v_mfma_f32_16x16x32_bf16 v[76:79], v[236:239], v[120:123], v[76:79]
    ds_read_b64_tr_b16 v[228:229], v22 offset:40960
    v_mfma_f32_16x16x32_bf16 v[92:95], v[236:239], v[124:127], v[92:95]
    ds_read_b64_tr_b16 v[230:231], v22 offset:43008
    s_waitcnt lgkmcnt(8)
    s_waitcnt vmcnt(8)
    v_mfma_f32_16x16x32_bf16 v[64:67], v[208:211], v[128:131], v[64:67]
    ds_read_b64_tr_b16 v[232:233], v23 offset:40960
    v_mfma_f32_16x16x32_bf16 v[80:83], v[208:211], v[132:135], v[80:83]
    ds_read_b64_tr_b16 v[234:235], v23 offset:43008
    buffer_load_dwordx4 v[172:175], v2, s[24:27], s79 offen offset:1024 sc1
    v_mfma_f32_16x16x32_bf16 v[68:71], v[212:215], v[128:131], v[68:71]
    ds_read_b64_tr_b16 v[236:237], v24 offset:40960
    v_mfma_f32_16x16x32_bf16 v[84:87], v[212:215], v[132:135], v[84:87]
    ds_read_b64_tr_b16 v[238:239], v24 offset:43008
    s_waitcnt lgkmcnt(8)
    v_mfma_f32_16x16x32_bf16 v[72:75], v[216:219], v[128:131], v[72:75]
    ds_read_b64_tr_b16 v[208:209], v21 offset:45056
    v_mfma_f32_16x16x32_bf16 v[88:91], v[216:219], v[132:135], v[88:91]
    ds_read_b64_tr_b16 v[210:211], v21 offset:47104
    buffer_load_dwordx4 v[168:171], v2, s[24:27], s78 offen offset:1024 sc1
    v_mfma_f32_16x16x32_bf16 v[76:79], v[220:223], v[128:131], v[76:79]
    ds_read_b64_tr_b16 v[212:213], v22 offset:45056
    v_mfma_f32_16x16x32_bf16 v[92:95], v[220:223], v[132:135], v[92:95]
    ds_read_b64_tr_b16 v[214:215], v22 offset:47104
    s_waitcnt lgkmcnt(8)
    s_waitcnt vmcnt(8)
    v_mfma_f32_16x16x32_bf16 v[64:67], v[224:227], v[136:139], v[64:67]
    ds_read_b64_tr_b16 v[216:217], v23 offset:45056
    v_mfma_f32_16x16x32_bf16 v[80:83], v[224:227], v[140:143], v[80:83]
    ds_read_b64_tr_b16 v[218:219], v23 offset:47104
    buffer_load_dwordx4 v[180:183], v2, s[24:27], s79 offen offset:2048 sc1
    v_mfma_f32_16x16x32_bf16 v[68:71], v[228:231], v[136:139], v[68:71]
    ds_read_b64_tr_b16 v[220:221], v24 offset:45056
    v_mfma_f32_16x16x32_bf16 v[84:87], v[228:231], v[140:143], v[84:87]
    ds_read_b64_tr_b16 v[222:223], v24 offset:47104
    s_waitcnt lgkmcnt(12)
    s_barrier
    s_waitcnt lgkmcnt(8)
    v_mfma_f32_16x16x32_bf16 v[72:75], v[232:235], v[136:139], v[72:75]
    ds_read_b64_tr_b16 v[224:225], v8 offset:0
    v_mfma_f32_16x16x32_bf16 v[88:91], v[232:235], v[140:143], v[88:91]
    ds_read_b64_tr_b16 v[226:227], v8 offset:2048
    buffer_load_dwordx4 v[176:179], v2, s[24:27], s78 offen offset:2048 sc1
    v_mfma_f32_16x16x32_bf16 v[76:79], v[236:239], v[136:139], v[76:79]
    ds_read_b64_tr_b16 v[228:229], v9 offset:0
    v_mfma_f32_16x16x32_bf16 v[92:95], v[236:239], v[140:143], v[92:95]
    ds_read_b64_tr_b16 v[230:231], v9 offset:2048
    s_waitcnt lgkmcnt(8)
    s_waitcnt vmcnt(8)
    v_mfma_f32_16x16x32_bf16 v[64:67], v[208:211], v[144:147], v[64:67]
    ds_read_b64_tr_b16 v[232:233], v10 offset:0
    v_mfma_f32_16x16x32_bf16 v[80:83], v[208:211], v[148:151], v[80:83]
    ds_read_b64_tr_b16 v[234:235], v10 offset:2048
    buffer_load_dwordx4 v[188:191], v2, s[24:27], s79 offen offset:3072 sc1
    v_mfma_f32_16x16x32_bf16 v[68:71], v[212:215], v[144:147], v[68:71]
    ds_read_b64_tr_b16 v[236:237], v11 offset:0
    v_mfma_f32_16x16x32_bf16 v[84:87], v[212:215], v[148:151], v[84:87]
    ds_read_b64_tr_b16 v[238:239], v11 offset:2048
    s_waitcnt lgkmcnt(8)
    v_mfma_f32_16x16x32_bf16 v[72:75], v[216:219], v[144:147], v[72:75]
    ds_read_b64_tr_b16 v[208:209], v8 offset:4096
    v_mfma_f32_16x16x32_bf16 v[88:91], v[216:219], v[148:151], v[88:91]
    ds_read_b64_tr_b16 v[210:211], v8 offset:6144
    buffer_load_dwordx4 v[184:187], v2, s[24:27], s78 offen offset:3072 sc1
    v_mfma_f32_16x16x32_bf16 v[76:79], v[220:223], v[144:147], v[76:79]
    ds_read_b64_tr_b16 v[212:213], v9 offset:4096
    v_mfma_f32_16x16x32_bf16 v[92:95], v[220:223], v[148:151], v[92:95]
    ds_read_b64_tr_b16 v[214:215], v9 offset:6144
    s_waitcnt lgkmcnt(8)
    s_waitcnt vmcnt(8)
    v_mfma_f32_16x16x32_bf16 v[64:67], v[224:227], v[152:155], v[64:67]
    ds_read_b64_tr_b16 v[216:217], v10 offset:4096
    v_mfma_f32_16x16x32_bf16 v[80:83], v[224:227], v[156:159], v[80:83]
    ds_read_b64_tr_b16 v[218:219], v10 offset:6144
    s_add_u32 s78, s78, 4096
    s_add_u32 s79, s79, 4096
    buffer_load_dwordx4 v[100:103], v2, s[24:27], s79 offen offset:0 sc1
    v_mfma_f32_16x16x32_bf16 v[68:71], v[228:231], v[152:155], v[68:71]
    ds_read_b64_tr_b16 v[220:221], v11 offset:4096
    v_mfma_f32_16x16x32_bf16 v[84:87], v[228:231], v[156:159], v[84:87]
    ds_read_b64_tr_b16 v[222:223], v11 offset:6144
    s_waitcnt lgkmcnt(8)
    v_mfma_f32_16x16x32_bf16 v[72:75], v[232:235], v[152:155], v[72:75]
    ds_read_b64_tr_b16 v[224:225], v8 offset:8192
    v_mfma_f32_16x16x32_bf16 v[88:91], v[232:235], v[156:159], v[88:91]
    ds_read_b64_tr_b16 v[226:227], v8 offset:10240
    buffer_load_dwordx4 v[96:99], v2, s[24:27], s78 offen offset:0 sc1
    v_mfma_f32_16x16x32_bf16 v[76:79], v[236:239], v[152:155], v[76:79]
    ds_read_b64_tr_b16 v[228:229], v9 offset:8192
    v_mfma_f32_16x16x32_bf16 v[92:95], v[236:239], v[156:159], v[92:95]
    ds_read_b64_tr_b16 v[230:231], v9 offset:10240
    s_waitcnt lgkmcnt(8)
    s_waitcnt vmcnt(8)
    v_mfma_f32_16x16x32_bf16 v[64:67], v[208:211], v[160:163], v[64:67]
    ds_read_b64_tr_b16 v[232:233], v10 offset:8192
    v_mfma_f32_16x16x32_bf16 v[80:83], v[208:211], v[164:167], v[80:83]
    ds_read_b64_tr_b16 v[234:235], v10 offset:10240
    buffer_load_dwordx4 v[108:111], v2, s[24:27], s79 offen offset:1024 sc1
    v_mfma_f32_16x16x32_bf16 v[68:71], v[212:215], v[160:163], v[68:71]
    ds_read_b64_tr_b16 v[236:237], v11 offset:8192
    v_mfma_f32_16x16x32_bf16 v[84:87], v[212:215], v[164:167], v[84:87]
    ds_read_b64_tr_b16 v[238:239], v11 offset:10240
    s_waitcnt lgkmcnt(8)
    v_mfma_f32_16x16x32_bf16 v[72:75], v[216:219], v[160:163], v[72:75]
    ds_read_b64_tr_b16 v[208:209], v8 offset:12288
    v_mfma_f32_16x16x32_bf16 v[88:91], v[216:219], v[164:167], v[88:91]
    ds_read_b64_tr_b16 v[210:211], v8 offset:14336
    buffer_load_dwordx4 v[104:107], v2, s[24:27], s78 offen offset:1024 sc1
    v_mfma_f32_16x16x32_bf16 v[76:79], v[220:223], v[160:163], v[76:79]
    ds_read_b64_tr_b16 v[212:213], v9 offset:12288
    v_mfma_f32_16x16x32_bf16 v[92:95], v[220:223], v[164:167], v[92:95]
    ds_read_b64_tr_b16 v[214:215], v9 offset:14336
    s_waitcnt lgkmcnt(8)
    s_waitcnt vmcnt(8)
    v_mfma_f32_16x16x32_bf16 v[64:67], v[224:227], v[168:171], v[64:67]
    ds_read_b64_tr_b16 v[216:217], v10 offset:12288
    v_mfma_f32_16x16x32_bf16 v[80:83], v[224:227], v[172:175], v[80:83]
    ds_read_b64_tr_b16 v[218:219], v10 offset:14336
    buffer_load_dwordx4 v[116:119], v2, s[24:27], s79 offen offset:2048 sc1
    v_mfma_f32_16x16x32_bf16 v[68:71], v[228:231], v[168:171], v[68:71]
    ds_read_b64_tr_b16 v[220:221], v11 offset:12288
    v_mfma_f32_16x16x32_bf16 v[84:87], v[228:231], v[172:175], v[84:87]
    ds_read_b64_tr_b16 v[222:223], v11 offset:14336
    s_waitcnt lgkmcnt(8)
    v_mfma_f32_16x16x32_bf16 v[72:75], v[232:235], v[168:171], v[72:75]
    ds_read_b64_tr_b16 v[224:225], v8 offset:16384
    v_mfma_f32_16x16x32_bf16 v[88:91], v[232:235], v[172:175], v[88:91]
    ds_read_b64_tr_b16 v[226:227], v8 offset:18432
    buffer_load_dwordx4 v[112:115], v2, s[24:27], s78 offen offset:2048 sc1
    v_mfma_f32_16x16x32_bf16 v[76:79], v[236:239], v[168:171], v[76:79]
    ds_read_b64_tr_b16 v[228:229], v9 offset:16384
    v_mfma_f32_16x16x32_bf16 v[92:95], v[236:239], v[172:175], v[92:95]
    ds_read_b64_tr_b16 v[230:231], v9 offset:18432
    s_waitcnt lgkmcnt(8)
    s_waitcnt vmcnt(8)
    v_mfma_f32_16x16x32_bf16 v[64:67], v[208:211], v[176:179], v[64:67]
    ds_read_b64_tr_b16 v[232:233], v10 offset:16384
    v_mfma_f32_16x16x32_bf16 v[80:83], v[208:211], v[180:183], v[80:83]
    ds_read_b64_tr_b16 v[234:235], v10 offset:18432
    buffer_load_dwordx4 v[124:127], v2, s[24:27], s79 offen offset:3072 sc1
    v_mfma_f32_16x16x32_bf16 v[68:71], v[212:215], v[176:179], v[68:71]
    ds_read_b64_tr_b16 v[236:237], v11 offset:16384
    v_mfma_f32_16x16x32_bf16 v[84:87], v[212:215], v[180:183], v[84:87]
    ds_read_b64_tr_b16 v[238:239], v11 offset:18432
    s_waitcnt lgkmcnt(8)
    v_mfma_f32_16x16x32_bf16 v[72:75], v[216:219], v[176:179], v[72:75]
    ds_read_b64_tr_b16 v[208:209], v8 offset:20480
    v_mfma_f32_16x16x32_bf16 v[88:91], v[216:219], v[180:183], v[88:91]
    ds_read_b64_tr_b16 v[210:211], v8 offset:22528
    buffer_load_dwordx4 v[120:123], v2, s[24:27], s78 offen offset:3072 sc1
    v_mfma_f32_16x16x32_bf16 v[76:79], v[220:223], v[176:179], v[76:79]
    ds_read_b64_tr_b16 v[212:213], v9 offset:20480
    v_mfma_f32_16x16x32_bf16 v[92:95], v[220:223], v[180:183], v[92:95]
    ds_read_b64_tr_b16 v[214:215], v9 offset:22528
    s_waitcnt lgkmcnt(8)
    s_waitcnt vmcnt(8)
    v_mfma_f32_16x16x32_bf16 v[64:67], v[224:227], v[184:187], v[64:67]
    ds_read_b64_tr_b16 v[216:217], v10 offset:20480
    v_mfma_f32_16x16x32_bf16 v[80:83], v[224:227], v[188:191], v[80:83]
    ds_read_b64_tr_b16 v[218:219], v10 offset:22528
    buffer_load_dwordx4 v[200:203], v2, s[24:27], s72 offen offset:0 sc1
    v_mfma_f32_16x16x32_bf16 v[68:71], v[228:231], v[184:187], v[68:71]
    ds_read_b64_tr_b16 v[220:221], v11 offset:20480
    v_mfma_f32_16x16x32_bf16 v[84:87], v[228:231], v[188:191], v[84:87]
    ds_read_b64_tr_b16 v[222:223], v11 offset:22528
    s_waitcnt lgkmcnt(8)
    v_mfma_f32_16x16x32_bf16 v[72:75], v[232:235], v[184:187], v[72:75]
    ds_read_b64_tr_b16 v[224:225], v8 offset:24576
    v_mfma_f32_16x16x32_bf16 v[88:91], v[232:235], v[188:191], v[88:91]
    ds_read_b64_tr_b16 v[226:227], v8 offset:26624
    buffer_load_dwordx4 v[204:207], v2, s[24:27], s72 offen offset:1024 sc1
    v_mfma_f32_16x16x32_bf16 v[76:79], v[236:239], v[184:187], v[76:79]
    ds_read_b64_tr_b16 v[228:229], v9 offset:24576
    v_mfma_f32_16x16x32_bf16 v[92:95], v[236:239], v[188:191], v[92:95]
    ds_read_b64_tr_b16 v[230:231], v9 offset:26624
    s_waitcnt lgkmcnt(8)
    s_waitcnt vmcnt(8)
    v_mfma_f32_16x16x32_bf16 v[64:67], v[208:211], v[96:99], v[64:67]
    ds_read_b64_tr_b16 v[232:233], v10 offset:24576
    v_mfma_f32_16x16x32_bf16 v[80:83], v[208:211], v[100:103], v[80:83]
    ds_read_b64_tr_b16 v[234:235], v10 offset:26624
    v_mfma_f32_16x16x32_bf16 v[68:71], v[212:215], v[96:99], v[68:71]
    ds_read_b64_tr_b16 v[236:237], v11 offset:24576
    v_mfma_f32_16x16x32_bf16 v[84:87], v[212:215], v[100:103], v[84:87]
    ds_read_b64_tr_b16 v[238:239], v11 offset:26624
    s_waitcnt lgkmcnt(8)
    v_mfma_f32_16x16x32_bf16 v[72:75], v[216:219], v[96:99], v[72:75]
    ds_read_b64_tr_b16 v[208:209], v21 offset:0
    v_mfma_f32_16x16x32_bf16 v[88:91], v[216:219], v[100:103], v[88:91]
    ds_read_b64_tr_b16 v[210:211], v21 offset:2048
    v_mfma_f32_16x16x32_bf16 v[76:79], v[220:223], v[96:99], v[76:79]
    ds_read_b64_tr_b16 v[212:213], v22 offset:0
    v_mfma_f32_16x16x32_bf16 v[92:95], v[220:223], v[100:103], v[92:95]
    ds_read_b64_tr_b16 v[214:215], v22 offset:2048
    s_waitcnt lgkmcnt(8)
    s_waitcnt vmcnt(6)
    v_mfma_f32_16x16x32_bf16 v[64:67], v[224:227], v[104:107], v[64:67]
    ds_read_b64_tr_b16 v[216:217], v23 offset:0
    v_mfma_f32_16x16x32_bf16 v[80:83], v[224:227], v[108:111], v[80:83]
    ds_read_b64_tr_b16 v[218:219], v23 offset:2048
    v_mfma_f32_16x16x32_bf16 v[68:71], v[228:231], v[104:107], v[68:71]
    ds_read_b64_tr_b16 v[220:221], v24 offset:0
    v_mfma_f32_16x16x32_bf16 v[84:87], v[228:231], v[108:111], v[84:87]
    ds_read_b64_tr_b16 v[222:223], v24 offset:2048
    s_waitcnt lgkmcnt(8)
    v_mfma_f32_16x16x32_bf16 v[72:75], v[232:235], v[104:107], v[72:75]
    ds_read_b64_tr_b16 v[224:225], v21 offset:4096
    v_mfma_f32_16x16x32_bf16 v[88:91], v[232:235], v[108:111], v[88:91]
    ds_read_b64_tr_b16 v[226:227], v21 offset:6144
    v_mfma_f32_16x16x32_bf16 v[76:79], v[236:239], v[104:107], v[76:79]
    ds_read_b64_tr_b16 v[228:229], v22 offset:4096
    v_mfma_f32_16x16x32_bf16 v[92:95], v[236:239], v[108:111], v[92:95]
    ds_read_b64_tr_b16 v[230:231], v22 offset:6144
    s_waitcnt lgkmcnt(8)
    s_waitcnt vmcnt(4)
    v_mfma_f32_16x16x32_bf16 v[64:67], v[208:211], v[112:115], v[64:67]
    ds_read_b64_tr_b16 v[232:233], v23 offset:4096
    v_mfma_f32_16x16x32_bf16 v[80:83], v[208:211], v[116:119], v[80:83]
    ds_read_b64_tr_b16 v[234:235], v23 offset:6144
    v_mfma_f32_16x16x32_bf16 v[68:71], v[212:215], v[112:115], v[68:71]
    ds_read_b64_tr_b16 v[236:237], v24 offset:4096
    v_mfma_f32_16x16x32_bf16 v[84:87], v[212:215], v[116:119], v[84:87]
    ds_read_b64_tr_b16 v[238:239], v24 offset:6144
    s_waitcnt lgkmcnt(8)
    v_mfma_f32_16x16x32_bf16 v[72:75], v[216:219], v[112:115], v[72:75]
    v_mfma_f32_16x16x32_bf16 v[88:91], v[216:219], v[116:119], v[88:91]
    v_mfma_f32_16x16x32_bf16 v[76:79], v[220:223], v[112:115], v[76:79]
    v_mfma_f32_16x16x32_bf16 v[92:95], v[220:223], v[116:119], v[92:95]
    s_waitcnt lgkmcnt(4)
    s_waitcnt vmcnt(2)
    v_mfma_f32_16x16x32_bf16 v[64:67], v[224:227], v[120:123], v[64:67]
    v_mfma_f32_16x16x32_bf16 v[80:83], v[224:227], v[124:127], v[80:83]
    v_mfma_f32_16x16x32_bf16 v[68:71], v[228:231], v[120:123], v[68:71]
    v_mfma_f32_16x16x32_bf16 v[84:87], v[228:231], v[124:127], v[84:87]
    s_waitcnt lgkmcnt(0)
    v_mfma_f32_16x16x32_bf16 v[72:75], v[232:235], v[120:123], v[72:75]
    v_mfma_f32_16x16x32_bf16 v[88:91], v[232:235], v[124:127], v[88:91]
    v_mfma_f32_16x16x32_bf16 v[76:79], v[236:239], v[120:123], v[76:79]
    v_mfma_f32_16x16x32_bf16 v[92:95], v[236:239], v[124:127], v[92:95]
    s_mul_i32 s89, s42, 3072
    s_add_u32 s89, s89, 6144
    v_add_u32 v208, s89, v2
    v_add_u32 v209, 61440, v208
    s_barrier
    ds_write_b128 v49, v[80:83] offset:0
    ds_write_b128 v49, v[84:87] offset:1024
    ds_write_b128 v49, v[88:91] offset:2048
    ds_write_b128 v49, v[92:95] offset:3072
    s_waitcnt vmcnt(1)
    v_lshlrev_b32 v160, 16, v200
    v_and_b32 v161, 0xffff0000, v200
    v_lshlrev_b32 v162, 16, v201
    v_and_b32 v163, 0xffff0000, v201
    v_lshlrev_b32 v164, 16, v202
    ds_write_b128 v208, a[72:75] offset:0
    v_and_b32 v165, 0xffff0000, v202
    v_lshlrev_b32 v166, 16, v203
    v_and_b32 v167, 0xffff0000, v203
    s_waitcnt vmcnt(0)
    v_lshlrev_b32 v168, 16, v204
    v_and_b32 v169, 0xffff0000, v204
    v_lshlrev_b32 v170, 16, v205
    v_and_b32 v171, 0xffff0000, v205
    v_lshlrev_b32 v172, 16, v206
    v_and_b32 v173, 0xffff0000, v206
    v_lshlrev_b32 v174, 16, v207
    ds_write_b128 v208, a[76:79] offset:1024
    v_and_b32 v175, 0xffff0000, v207
    ds_read_b128 v[144:147], v53 offset:1280
    ds_read_b128 v[148:151], v53 offset:1344
    ds_read_b128 v[152:155], v53 offset:1408
    ds_read_b128 v[156:159], v53 offset:1472
    v_pk_add_f32 v[64:65], v[64:65], v[160:161]
    v_pk_add_f32 v[66:67], v[66:67], v[162:163]
    v_pk_add_f32 v[68:69], v[68:69], v[164:165]
    v_pk_add_f32 v[70:71], v[70:71], v[166:167]
    v_pk_add_f32 v[72:73], v[72:73], v[168:169]
    ds_write_b128 v208, a[80:83] offset:2048
    v_pk_add_f32 v[74:75], v[74:75], v[170:171]
    v_pk_add_f32 v[76:77], v[76:77], v[172:173]
    v_pk_add_f32 v[78:79], v[78:79], v[174:175]
    s_waitcnt lgkmcnt(4)
    v_pk_add_f32 v[64:65], v[64:65], v[144:145]
    v_pk_add_f32 v[66:67], v[66:67], v[146:147]
    s_waitcnt lgkmcnt(3)
    v_pk_add_f32 v[68:69], v[68:69], v[148:149]
    v_pk_add_f32 v[70:71], v[70:71], v[150:151]
    s_waitcnt lgkmcnt(2)
    v_pk_add_f32 v[72:73], v[72:73], v[152:153]
    v_pk_add_f32 v[74:75], v[74:75], v[154:155]
    s_waitcnt lgkmcnt(1)
    v_pk_add_f32 v[76:77], v[76:77], v[156:157]
    ds_write_b128 v208, a[84:87] offset:12288
    v_pk_add_f32 v[78:79], v[78:79], v[158:159]
    s_add_u32 s82, s82, 2097152
    s_add_u32 s83, s83, 13631488
    s_waitcnt lgkmcnt(0)
    s_barrier
    ds_read_b128 v[128:131], v50 offset:0
    ds_read_b128 v[132:135], v50 offset:1024
    ds_read_b128 v[136:139], v50 offset:2048
    ds_read_b128 v[140:143], v50 offset:3072
    v_and_b32 v190, 15, v57
    ds_write_b128 v208, a[88:91] offset:13312
    v_lshlrev_b32 v190, 6, v190
    s_waitcnt lgkmcnt(4)
    v_pk_add_f32 v[64:65], v[64:65], v[128:129]
    v_pk_add_f32 v[66:67], v[66:67], v[130:131]
    s_waitcnt lgkmcnt(3)
    v_pk_add_f32 v[68:69], v[68:69], v[132:133]
    v_pk_add_f32 v[70:71], v[70:71], v[134:135]
    s_waitcnt lgkmcnt(2)
    v_pk_add_f32 v[72:73], v[72:73], v[136:137]
    v_pk_add_f32 v[74:75], v[74:75], v[138:139]
    s_waitcnt lgkmcnt(1)
    v_pk_add_f32 v[76:77], v[76:77], v[140:141]
    v_pk_add_f32 v[78:79], v[78:79], v[142:143]
    v_cvt_pk_bf16_f32 v176, v64, v65
    ds_write_b128 v208, a[92:95] offset:14336
    v_cvt_pk_bf16_f32 v177, v66, v67
    v_cvt_pk_bf16_f32 v178, v68, v69
    v_cvt_pk_bf16_f32 v179, v70, v71
    v_cvt_pk_bf16_f32 v180, v72, v73
    v_cvt_pk_bf16_f32 v181, v74, v75
    v_cvt_pk_bf16_f32 v182, v76, v77
    v_cvt_pk_bf16_f32 v183, v78, v79
    ds_write_b128 v208, a[96:99] offset:24576
    ds_write_b128 v208, a[100:103] offset:25600
    ds_write_b128 v208, a[104:107] offset:26624
    ds_write_b128 v208, a[108:111] offset:36864
    ds_write_b128 v208, a[112:115] offset:37888
    ds_write_b128 v208, a[116:119] offset:38912
    ds_write_b128 v208, a[120:123] offset:49152
    ds_write_b128 v208, a[124:127] offset:50176
    ds_write_b128 v208, a[128:131] offset:51200
    ds_write_b128 v209, a[132:135] offset:0
    ds_write_b128 v209, a[136:139] offset:1024
    ds_write_b128 v209, a[140:143] offset:2048
    ds_write_b128 v209, a[144:147] offset:12288
    ds_write_b128 v209, a[148:151] offset:13312
    ds_write_b128 v209, a[152:155] offset:14336
    s_cmp_eq_u32 s44, 0
    s_cbranch_scc1 L_st_slow_44
    buffer_store_dwordx4 v[176:179], v2, s[24:27], s82 offen offset:0
    buffer_store_dwordx4 v[180:183], v2, s[24:27], s82 offen offset:1024
    s_branch L_st_done_45
L_st_slow_44:
    buffer_store_dwordx4 v[176:179], v2, s[24:27], s82 offen offset:0 sc1
    buffer_store_dwordx4 v[180:183], v2, s[24:27], s82 offen offset:1024 sc1
L_st_done_45:
    v_pk_mul_f32 v[192:193], v[64:65], v[64:65]
    v_pk_fma_f32 v[192:193], v[66:67], v[66:67], v[192:193]
    v_pk_add_f32 v[184:185], v[64:65], v[66:67]
    v_pk_fma_f32 v[192:193], v[68:69], v[68:69], v[192:193]
    v_pk_add_f32 v[184:185], v[184:185], v[68:69]
    v_pk_fma_f32 v[192:193], v[70:71], v[70:71], v[192:193]
    v_pk_add_f32 v[184:185], v[184:185], v[70:71]
    v_pk_fma_f32 v[192:193], v[72:73], v[72:73], v[192:193]
    v_pk_add_f32 v[184:185], v[184:185], v[72:73]
    v_pk_fma_f32 v[192:193], v[74:75], v[74:75], v[192:193]
    v_pk_add_f32 v[184:185], v[184:185], v[74:75]
    v_pk_fma_f32 v[192:193], v[76:77], v[76:77], v[192:193]
    v_pk_add_f32 v[184:185], v[184:185], v[76:77]
    v_pk_fma_f32 v[192:193], v[78:79], v[78:79], v[192:193]
    v_pk_add_f32 v[184:185], v[184:185], v[78:79]
    v_add_f32 v188, v184, v185
    v_add_f32 v189, v192, v193
    v_mov_b32 v190, 0
    v_mov_b32 v191, 0
    v_and_b32 v185, 15, v57
    v_lshlrev_b32 v185, 6, v185
    v_mov_b32 v186, v188
    v_mov_b32 v187, v189
    s_nop 0
    v_permlane32_swap_b32 v186, v188
    v_permlane32_swap_b32 v187, v189
    v_add_f32 v188, v186, v188
    v_add_f32 v189, v187, v189
    v_mov_b32 v186, v188
    v_mov_b32 v187, v189
    s_nop 0
    v_permlane16_swap_b32 v186, v188
    v_permlane16_swap_b32 v187, v189
    v_add_f32 v188, v186, v188
    v_add_f32 v189, v187, v189
    s_cmp_eq_u32 s47, 6
    s_cbranch_scc1 L_st_last_46
    s_cmp_eq_u32 s44, 0
    s_cbranch_scc1 L_st_slow_48
    s_mov_b64 exec, s[98:99]
    buffer_store_dwordx2 v[188:189], v185, s[24:27], s83 offen
    s_mov_b64 exec, -1
    s_branch L_st_done_49
L_st_slow_48:
    s_mov_b64 exec, s[98:99]
    buffer_store_dwordx2 v[188:189], v185, s[24:27], s83 offen sc1
    s_mov_b64 exec, -1
L_st_done_49:
    s_branch L_st_join_47
L_st_last_46:
    s_cmp_eq_u32 s44, 0
    s_cbranch_scc1 L_st_slow_50
    s_mov_b64 exec, s[98:99]
    buffer_store_dwordx4 v[188:191], v185, s[24:27], s83 offen
    s_mov_b64 exec, -1
    s_branch L_st_done_51
L_st_slow_50:
    s_mov_b64 exec, s[98:99]
    buffer_store_dwordx4 v[188:191], v185, s[24:27], s83 offen sc1
    s_mov_b64 exec, -1
L_st_done_51:
L_st_join_47:
    s_add_u32 s45, s45, 1
    v_mov_b32 v254, s45
    v_mov_b32 v255, 0
    s_waitcnt vmcnt(0)
    s_mov_b64 exec, 1
    s_cmp_eq_u32 s44, 0
    s_cbranch_scc1 L_sig_slow_52
    buffer_store_dword v254, v255, s[24:27], s94 offen
    s_branch L_sig_done_53
L_sig_slow_52:
    buffer_store_dword v254, v255, s[24:27], s94 offen sc1
L_sig_done_53:
    s_mov_b64 exec, -1
    s_and_b32 s87, s46, s48
    s_cmp_eq_u32 s87, 0
    s_cbranch_scc1 L_nohalo_st_54
    s_lshl_b32 s88, s40, 14
    s_add_u32 s88, s88, 13893632
    s_lshl_b32 s87, s71, 10
    s_add_u32 s87, s87, s88
    s_mov_b32 exec_lo, 0xff00ff00
    s_mov_b32 exec_hi, 0xff00ff00
    buffer_store_dwordx4 v[176:179], v56, s[24:27], s87 offen offset:0 sc1
    buffer_store_dwordx4 v[180:183], v56, s[24:27], s87 offen offset:1024 sc1
    s_mov_b64 exec, -1
    v_bfe_u32 v186, v56, 4, 4
    v_lshlrev_b32 v186, 6, v186
    s_lshl_b32 s87, s47, 3
    s_add_u32 s87, s87, s88
    s_add_u32 s87, s87, 14336
    s_mov_b64 exec, 0xff00
    s_cmp_eq_u32 s47, 6
    s_cbranch_scc1 L_hst_last_55
    buffer_store_dwordx2 v[188:189], v186, s[24:27], s87 offen sc1
    s_branch L_hst_join_56
L_hst_last_55:
    buffer_store_dwordx4 v[188:191], v186, s[24:27], s87 offen sc1
L_hst_join_56:
    s_mov_b64 exec, -1
L_nohalo_st_54:
    s_branch L_w2_join_42
L_w2_idle_41:
    s_barrier
    s_add_u32 s45, s45, 1
    v_mov_b32 v254, s45
    v_mov_b32 v255, 0
    s_waitcnt vmcnt(0)
    s_mov_b64 exec, 1
    s_cmp_eq_u32 s44, 0
    s_cbranch_scc1 L_sig_slow_57
    buffer_store_dword v254, v255, s[24:27], s94 offen
    s_branch L_sig_done_58
L_sig_slow_57:
    buffer_store_dword v254, v255, s[24:27], s94 offen sc1
L_sig_done_58:
    s_mov_b64 exec, -1
    s_mul_i32 s89, s42, 3072
    s_add_u32 s89, s89, 6144
    v_add_u32 v208, s89, v2
    v_add_u32 v209, 61440, v208
    ds_write_b128 v208, a[72:75] offset:0
    ds_write_b128 v208, a[76:79] offset:1024
    ds_write_b128 v208, a[80:83] offset:2048
    ds_write_b128 v208, a[84:87] offset:12288
    ds_write_b128 v208, a[88:91] offset:13312
    ds_write_b128 v208, a[92:95] offset:14336
    ds_write_b128 v208, a[96:99] offset:24576
    ds_write_b128 v208, a[100:103] offset:25600
    ds_write_b128 v208, a[104:107] offset:26624
    ds_write_b128 v208, a[108:111] offset:36864
    ds_write_b128 v208, a[112:115] offset:37888
    ds_write_b128 v208, a[116:119] offset:38912
    ds_write_b128 v208, a[120:123] offset:49152
    ds_write_b128 v208, a[124:127] offset:50176
    ds_write_b128 v208, a[128:131] offset:51200
    ds_write_b128 v209, a[132:135] offset:0
    ds_write_b128 v209, a[136:139] offset:1024
    ds_write_b128 v209, a[140:143] offset:2048
    ds_write_b128 v209, a[144:147] offset:12288
    ds_write_b128 v209, a[148:151] offset:13312
    ds_write_b128 v209, a[152:155] offset:14336
L_w2_join_42:
    s_mul_i32 s78, s3, 14336
    s_add_u32 s78, s78, 2097152
    s_add_u32 s79, s78, 14336
    s_lshl_b32 s80, s3, 10
    s_add_u32 s80, s80, 13631488
    s_add_u32 s81, s80, 1024
    s_sub_u32 s82, s40, 1
    s_lshl_b32 s82, s82, 14
    s_add_u32 s82, s82, 13893632
    s_cmp_eq_u32 s40, 0
    s_cselect_b32 s82, 0x7ff00000, s82
    s_cselect_b32 s77, 0, 1
    s_add_u32 s83, s82, 14336
    s_sub_u32 s76, s70, 256
    v_and_b32 v249, 15, v57
    v_min_u32 v249, 13, v249
    v_lshlrev_b32 v249, 2, v249
    s_mov_b32 s96, 0
L_poll_59:
    buffer_load_dword v254, v3, s[24:27], s70 offen sc1
    s_add_u32 s96, s96, 1
    s_cmp_gt_u32 s96, 200000
    s_cbranch_scc1 L_end
    s_waitcnt vmcnt(0)
    v_cmp_gt_u32 vcc, s45, v254
    s_nop 3
    s_and_b64 vcc, vcc, s[36:37]
    s_cbranch_vccnz L_poll_59
    buffer_load_dwordx4 a[56:59], v2, s[24:27], s79 offen offset:0 sc1
    buffer_load_dwordx4 a[0:3], v2, s[24:27], s78 offen offset:0 sc1
    buffer_load_dwordx4 a[60:63], v2, s[24:27], s79 offen offset:1024 sc1
    buffer_load_dwordx4 a[4:7], v2, s[24:27], s78 offen offset:1024 sc1
    buffer_load_dwordx4 a[64:67], v2, s[24:27], s79 offen offset:2048 sc1
    buffer_load_dwordx4 a[8:11], v2, s[24:27], s78 offen offset:2048 sc1
    buffer_load_dwordx4 a[68:71], v2, s[24:27], s79 offen offset:3072 sc1
    buffer_load_dwordx4 a[12:15], v2, s[24:27], s78 offen offset:3072 sc1
    s_and_b32 s87, s46, s48
    s_and_b32 s87, s87, s66
    s_cmp_eq_u32 s87, 0
    s_cbranch_scc1 L_nohalo_flag_60
    s_lshl_b32 s87, s47, 1
    s_add_u32 s87, s87, s49
    s_lshl_b32 s87, s87, 2
    s_add_u32 s87, s87, s70
    s_add_u32 s87, s87, 256
    v_mov_b32 v246, 1
    v_mov_b32 v247, 0
    buffer_store_dword v246, v247, s[24:27], s87 offen sc1
L_nohalo_flag_60:
    s_waitcnt lgkmcnt(0)
    s_barrier
    buffer_load_dwordx4 v[200:203], v52, s[24:27], s80 offen sc1
    buffer_load_dwordx4 v[204:207], v52, s[24:27], s81 offen sc1
    v_add_u32 v184, 6144, v2
    v_add_u32 v185, 61440, v184
    s_add_u32 s89, s93, 2048
    v_add_u32 v186, s89, v184
    v_add_u32 v187, 61440, v186
    ds_read_b128 a[112:115], v184 offset:0
    ds_read_b128 a[116:119], v184 offset:1024
    ds_read_b128 a[120:123], v184 offset:2048
    ds_read_b128 a[124:127], v184 offset:3072
    ds_read_b128 a[128:131], v184 offset:4096
    ds_read_b128 a[132:135], v184 offset:5120
    s_waitcnt lgkmcnt(4)
    s_waitcnt vmcnt(8)
    v_mfma_f32_16x16x32_bf16 v[64:67], a[112:115], a[0:3], 0
    ds_read_b128 a[136:139], v184 offset:6144
    v_mfma_f32_16x16x32_bf16 v[72:75], a[112:115], a[56:59], 0
    ds_read_b128 v[128:131], v186 offset:0
    s_add_u32 s78, s78, 4096
    s_add_u32 s79, s79, 4096
    buffer_load_dwordx4 a[72:75], v2, s[24:27], s79 offen offset:0 sc1
    v_mfma_f32_16x16x32_bf16 v[68:71], a[116:119], a[0:3], 0
    ds_read_b128 a[140:143], v184 offset:7168
    v_mfma_f32_16x16x32_bf16 v[76:79], a[116:119], a[56:59], 0
    s_waitcnt lgkmcnt(4)
    v_mfma_f32_16x16x32_bf16 v[80:83], a[120:123], a[0:3], 0
    ds_read_b128 a[112:115], v184 offset:8192
    v_mfma_f32_16x16x32_bf16 v[88:91], a[120:123], a[56:59], 0
    buffer_load_dwordx4 a[16:19], v2, s[24:27], s78 offen offset:0 sc1
    v_mfma_f32_16x16x32_bf16 v[84:87], a[124:127], a[0:3], 0
    ds_read_b128 a[116:119], v184 offset:9216
    v_mfma_f32_16x16x32_bf16 v[92:95], a[124:127], a[56:59], 0
    s_waitcnt lgkmcnt(4)
    v_mfma_f32_16x16x32_bf16 v[96:99], a[0:3], a[128:131], 0
    ds_read_b128 a[120:123], v184 offset:10240
    v_mfma_f32_16x16x32_bf16 v[104:107], a[56:59], a[128:131], 0
    buffer_load_dwordx4 a[76:79], v2, s[24:27], s79 offen offset:1024 sc1
    v_mfma_f32_16x16x32_bf16 v[100:103], a[0:3], a[132:135], 0
    ds_read_b128 a[124:127], v184 offset:11264
    v_mfma_f32_16x16x32_bf16 v[108:111], a[56:59], a[132:135], 0
    s_waitcnt lgkmcnt(4)
    s_waitcnt vmcnt(9)
    v_mfma_f32_16x16x32_bf16 v[64:67], a[136:139], a[4:7], v[64:67]
    ds_read_b128 a[128:131], v184 offset:12288
    v_mfma_f32_16x16x32_bf16 v[72:75], a[136:139], a[60:63], v[72:75]
    ds_read_b128 v[132:135], v186 offset:6144
    buffer_load_dwordx4 a[20:23], v2, s[24:27], s78 offen offset:1024 sc1
    v_mfma_f32_16x16x32_bf16 v[68:71], a[140:143], a[4:7], v[68:71]
    ds_read_b128 a[132:135], v184 offset:13312
    v_mfma_f32_16x16x32_bf16 v[76:79], a[140:143], a[60:63], v[76:79]
    s_waitcnt lgkmcnt(4)
    v_mfma_f32_16x16x32_bf16 v[80:83], a[112:115], a[4:7], v[80:83]
    ds_read_b128 a[136:139], v184 offset:14336
    v_mfma_f32_16x16x32_bf16 v[88:91], a[112:115], a[60:63], v[88:91]
    buffer_load_dwordx4 a[80:83], v2, s[24:27], s79 offen offset:2048 sc1
    v_mfma_f32_16x16x32_bf16 v[84:87], a[116:119], a[4:7], v[84:87]
    ds_read_b128 a[140:143], v184 offset:15360
    v_mfma_f32_16x16x32_bf16 v[92:95], a[116:119], a[60:63], v[92:95]
    s_waitcnt lgkmcnt(4)
    v_mfma_f32_16x16x32_bf16 v[96:99], a[4:7], a[120:123], v[96:99]
    ds_read_b128 a[112:115], v184 offset:16384
    v_mfma_f32_16x16x32_bf16 v[104:107], a[60:63], a[120:123], v[104:107]
    buffer_load_dwordx4 a[24:27], v2, s[24:27], s78 offen offset:2048 sc1
    v_mfma_f32_16x16x32_bf16 v[100:103], a[4:7], a[124:127], v[100:103]
    ds_read_b128 a[116:119], v184 offset:17408
    v_mfma_f32_16x16x32_bf16 v[108:111], a[60:63], a[124:127], v[108:111]
    s_waitcnt lgkmcnt(4)
    s_waitcnt vmcnt(10)
    v_mfma_f32_16x16x32_bf16 v[64:67], a[128:131], a[8:11], v[64:67]
    ds_read_b128 a[120:123], v184 offset:18432
    v_mfma_f32_16x16x32_bf16 v[72:75], a[128:131], a[64:67], v[72:75]
    ds_read_b128 v[136:139], v186 offset:12288
    buffer_load_dwordx4 a[84:87], v2, s[24:27], s79 offen offset:3072 sc1
    v_mfma_f32_16x16x32_bf16 v[68:71], a[132:135], a[8:11], v[68:71]
    ds_read_b128 a[124:127], v184 offset:19456
    v_mfma_f32_16x16x32_bf16 v[76:79], a[132:135], a[64:67], v[76:79]
    s_waitcnt lgkmcnt(4)
    v_mfma_f32_16x16x32_bf16 v[80:83], a[136:139], a[8:11], v[80:83]
    ds_read_b128 a[128:131], v184 offset:20480
    v_mfma_f32_16x16x32_bf16 v[88:91], a[136:139], a[64:67], v[88:91]
    buffer_load_dwordx4 a[28:31], v2, s[24:27], s78 offen offset:3072 sc1
    v_mfma_f32_16x16x32_bf16 v[84:87], a[140:143], a[8:11], v[84:87]
    ds_read_b128 a[132:135], v184 offset:21504
    v_mfma_f32_16x16x32_bf16 v[92:95], a[140:143], a[64:67], v[92:95]
    s_waitcnt lgkmcnt(4)
    v_mfma_f32_16x16x32_bf16 v[96:99], a[8:11], a[112:115], v[96:99]
    ds_read_b128 a[136:139], v184 offset:22528
    v_mfma_f32_16x16x32_bf16 v[104:107], a[64:67], a[112:115], v[104:107]
    s_add_u32 s78, s78, 4096
    s_add_u32 s79, s79, 4096
    buffer_load_dwordx4 a[88:91], v2, s[24:27], s79 offen offset:0 sc1
    v_mfma_f32_16x16x32_bf16 v[100:103], a[8:11], a[116:119], v[100:103]
    ds_read_b128 a[140:143], v184 offset:23552
    v_mfma_f32_16x16x32_bf16 v[108:111], a[64:67], a[116:119], v[108:111]
    s_waitcnt lgkmcnt(4)
    s_waitcnt vmcnt(11)
    v_mfma_f32_16x16x32_bf16 v[64:67], a[120:123], a[12:15], v[64:67]
    ds_read_b128 a[112:115], v184 offset:24576
    v_mfma_f32_16x16x32_bf16 v[72:75], a[120:123], a[68:71], v[72:75]
    ds_read_b128 v[140:143], v186 offset:18432
    buffer_load_dwordx4 a[32:35], v2, s[24:27], s78 offen offset:0 sc1
    v_mfma_f32_16x16x32_bf16 v[68:71], a[124:127], a[12:15], v[68:71]
    ds_read_b128 a[116:119], v184 offset:25600
    v_mfma_f32_16x16x32_bf16 v[76:79], a[124:127], a[68:71], v[76:79]
    s_waitcnt vmcnt(11)
    v_add_f32 v200, v200, v202
    s_waitcnt lgkmcnt(4)
    v_mfma_f32_16x16x32_bf16 v[80:83], a[128:131], a[12:15], v[80:83]
    ds_read_b128 a[120:123], v184 offset:26624
    v_mfma_f32_16x16x32_bf16 v[88:91], a[128:131], a[68:71], v[88:91]
    v_add_f32 v201, v201, v203
    buffer_load_dwordx4 a[92:95], v2, s[24:27], s79 offen offset:1024 sc1
    v_mfma_f32_16x16x32_bf16 v[84:87], a[132:135], a[12:15], v[84:87]
    ds_read_b128 a[124:127], v184 offset:27648
    v_mfma_f32_16x16x32_bf16 v[92:95], a[132:135], a[68:71], v[92:95]
    s_waitcnt vmcnt(11)
    v_add_f32 v204, v204, v206
    s_waitcnt lgkmcnt(4)
    v_mfma_f32_16x16x32_bf16 v[96:99], a[12:15], a[136:139], v[96:99]
    ds_read_b128 a[128:131], v184 offset:28672
    v_mfma_f32_16x16x32_bf16 v[104:107], a[68:71], a[136:139], v[104:107]
    v_add_f32 v205, v205, v207
    buffer_load_dwordx4 a[36:39], v2, s[24:27], s78 offen offset:1024 sc1
    v_mfma_f32_16x16x32_bf16 v[100:103], a[12:15], a[140:143], v[100:103]
    ds_read_b128 a[132:135], v184 offset:29696
    v_mfma_f32_16x16x32_bf16 v[108:111], a[68:71], a[140:143], v[108:111]
    v_mov_b32 v220, v200
    s_waitcnt lgkmcnt(4)
    s_waitcnt vmcnt(10)
    v_mfma_f32_16x16x32_bf16 v[64:67], a[112:115], a[16:19], v[64:67]
    ds_read_b128 a[136:139], v184 offset:30720
    v_mfma_f32_16x16x32_bf16 v[72:75], a[112:115], a[72:75], v[72:75]
    ds_read_b128 v[144:147], v186 offset:24576
    buffer_load_dwordx4 a[96:99], v2, s[24:27], s79 offen offset:2048 sc1
    v_mfma_f32_16x16x32_bf16 v[68:71], a[116:119], a[16:19], v[68:71]
    ds_read_b128 a[140:143], v184 offset:31744
    v_mfma_f32_16x16x32_bf16 v[76:79], a[116:119], a[72:75], v[76:79]
    v_mov_b32 v221, v201
    s_waitcnt lgkmcnt(4)
    v_mfma_f32_16x16x32_bf16 v[80:83], a[120:123], a[16:19], v[80:83]
    ds_read_b128 a[112:115], v184 offset:32768
    v_mfma_f32_16x16x32_bf16 v[88:91], a[120:123], a[72:75], v[88:91]
    v_mov_b32 v222, v204
    buffer_load_dwordx4 a[40:43], v2, s[24:27], s78 offen offset:2048 sc1
    v_mfma_f32_16x16x32_bf16 v[84:87], a[124:127], a[16:19], v[84:87]
    ds_read_b128 a[116:119], v184 offset:33792
    v_mfma_f32_16x16x32_bf16 v[92:95], a[124:127], a[72:75], v[92:95]
    v_mov_b32 v223, v205
    s_waitcnt lgkmcnt(4)
    v_mfma_f32_16x16x32_bf16 v[96:99], a[16:19], a[128:131], v[96:99]
    ds_read_b128 a[120:123], v184 offset:34816
    v_mfma_f32_16x16x32_bf16 v[104:107], a[72:75], a[128:131], v[104:107]
    v_permlane32_swap_b32 v220, v200
    buffer_load_dwordx4 a[100:103], v2, s[24:27], s79 offen offset:3072 sc1
    v_mfma_f32_16x16x32_bf16 v[100:103], a[16:19], a[132:135], v[100:103]
    ds_read_b128 a[124:127], v184 offset:35840
    v_mfma_f32_16x16x32_bf16 v[108:111], a[72:75], a[132:135], v[108:111]
    v_permlane32_swap_b32 v221, v201
    s_waitcnt lgkmcnt(4)
    s_waitcnt vmcnt(11)
    v_mfma_f32_16x16x32_bf16 v[64:67], a[136:139], a[20:23], v[64:67]
    ds_read_b128 a[128:131], v184 offset:36864
    v_mfma_f32_16x16x32_bf16 v[72:75], a[136:139], a[76:79], v[72:75]
    ds_read_b128 v[148:151], v186 offset:30720
    buffer_load_dwordx4 a[44:47], v2, s[24:27], s78 offen offset:3072 sc1
    v_mfma_f32_16x16x32_bf16 v[68:71], a[140:143], a[20:23], v[68:71]
    ds_read_b128 a[132:135], v184 offset:37888
    v_mfma_f32_16x16x32_bf16 v[76:79], a[140:143], a[76:79], v[76:79]
    v_permlane32_swap_b32 v222, v204
    s_waitcnt lgkmcnt(4)
    v_mfma_f32_16x16x32_bf16 v[80:83], a[112:115], a[20:23], v[80:83]
    ds_read_b128 a[136:139], v184 offset:38912
    v_mfma_f32_16x16x32_bf16 v[88:91], a[112:115], a[76:79], v[88:91]
    v_permlane32_swap_b32 v223, v205
    s_add_u32 s78, s78, 4096
    s_add_u32 s79, s79, 4096
    buffer_load_dwordx4 a[104:107], v2, s[24:27], s79 offen offset:0 sc1
    v_mfma_f32_16x16x32_bf16 v[84:87], a[116:119], a[20:23], v[84:87]
    ds_read_b128 a[140:143], v184 offset:39936
    v_mfma_f32_16x16x32_bf16 v[92:95], a[116:119], a[76:79], v[92:95]
    v_add_f32 v200, v220, v200
    s_waitcnt lgkmcnt(4)
    v_mfma_f32_16x16x32_bf16 v[96:99], a[20:23], a[120:123], v[96:99]
    ds_read_b128 a[112:115], v184 offset:40960
    v_mfma_f32_16x16x32_bf16 v[104:107], a[76:79], a[120:123], v[104:107]
    v_add_f32 v201, v221, v201
    buffer_load_dwordx4 a[48:51], v2, s[24:27], s78 offen offset:0 sc1
    v_mfma_f32_16x16x32_bf16 v[100:103], a[20:23], a[124:127], v[100:103]
    ds_read_b128 a[116:119], v184 offset:41984
    v_mfma_f32_16x16x32_bf16 v[108:111], a[76:79], a[124:127], v[108:111]
    v_add_f32 v204, v222, v204
    s_waitcnt lgkmcnt(4)
    s_waitcnt vmcnt(12)
    v_mfma_f32_16x16x32_bf16 v[64:67], a[128:131], a[24:27], v[64:67]
    ds_read_b128 a[120:123], v184 offset:43008
    v_mfma_f32_16x16x32_bf16 v[72:75], a[128:131], a[80:83], v[72:75]
    ds_read_b128 v[152:155], v186 offset:36864
    buffer_load_dwordx4 a[108:111], v2, s[24:27], s79 offen offset:1024 sc1
    v_mfma_f32_16x16x32_bf16 v[68:71], a[132:135], a[24:27], v[68:71]
    ds_read_b128 a[124:127], v184 offset:44032
    v_mfma_f32_16x16x32_bf16 v[76:79], a[132:135], a[80:83], v[76:79]
    v_add_f32 v205, v223, v205
    s_waitcnt lgkmcnt(4)
    v_mfma_f32_16x16x32_bf16 v[80:83], a[136:139], a[24:27], v[80:83]
    ds_read_b128 a[128:131], v184 offset:45056
    v_mfma_f32_16x16x32_bf16 v[88:91], a[136:139], a[80:83], v[88:91]
    v_mov_b32 v220, v200
    buffer_load_dwordx4 a[52:55], v2, s[24:27], s78 offen offset:1024 sc1
    v_mfma_f32_16x16x32_bf16 v[84:87], a[140:143], a[24:27], v[84:87]
    ds_read_b128 a[132:135], v184 offset:46080
    v_mfma_f32_16x16x32_bf16 v[92:95], a[140:143], a[80:83], v[92:95]
    v_mov_b32 v221, v201
    s_waitcnt lgkmcnt(4)
    v_mfma_f32_16x16x32_bf16 v[96:99], a[24:27], a[112:115], v[96:99]
    ds_read_b128 a[136:139], v184 offset:47104
    v_mfma_f32_16x16x32_bf16 v[104:107], a[80:83], a[112:115], v[104:107]
    v_mov_b32 v222, v204
    v_mfma_f32_16x16x32_bf16 v[100:103], a[24:27], a[116:119], v[100:103]
    ds_read_b128 a[140:143], v184 offset:48128
    v_mfma_f32_16x16x32_bf16 v[108:111], a[80:83], a[116:119], v[108:111]
    v_mov_b32 v223, v205
    buffer_load_dword v248, v249, s[24:27], s76 offen sc1
    s_waitcnt lgkmcnt(4)
    s_waitcnt vmcnt(13)
    v_mfma_f32_16x16x32_bf16 v[64:67], a[120:123], a[28:31], v[64:67]
    ds_read_b128 a[112:115], v184 offset:49152
    v_mfma_f32_16x16x32_bf16 v[72:75], a[120:123], a[84:87], v[72:75]
    ds_read_b128 v[156:159], v186 offset:43008
    v_mfma_f32_16x16x32_bf16 v[68:71], a[124:127], a[28:31], v[68:71]
    ds_read_b128 a[116:119], v184 offset:50176
    v_mfma_f32_16x16x32_bf16 v[76:79], a[124:127], a[84:87], v[76:79]
    v_permlane16_swap_b32 v220, v200
    s_waitcnt lgkmcnt(4)
    v_mfma_f32_16x16x32_bf16 v[80:83], a[128:131], a[28:31], v[80:83]
    ds_read_b128 a[120:123], v184 offset:51200
    v_mfma_f32_16x16x32_bf16 v[88:91], a[128:131], a[84:87], v[88:91]
    v_permlane16_swap_b32 v221, v201
    v_mfma_f32_16x16x32_bf16 v[84:87], a[132:135], a[28:31], v[84:87]
    ds_read_b128 a[124:127], v184 offset:52224
    v_mfma_f32_16x16x32_bf16 v[92:95], a[132:135], a[84:87], v[92:95]
    v_permlane16_swap_b32 v222, v204
    s_waitcnt lgkmcnt(4)
    v_mfma_f32_16x16x32_bf16 v[96:99], a[28:31], a[136:139], v[96:99]
    ds_read_b128 a[128:131], v184 offset:53248
    v_mfma_f32_16x16x32_bf16 v[104:107], a[84:87], a[136:139], v[104:107]
    v_permlane16_swap_b32 v223, v205
    v_mfma_f32_16x16x32_bf16 v[100:103], a[28:31], a[140:143], v[100:103]
    ds_read_b128 a[132:135], v184 offset:54272
    v_mfma_f32_16x16x32_bf16 v[108:111], a[84:87], a[140:143], v[108:111]
    v_add_f32 v200, v220, v200
    s_waitcnt lgkmcnt(4)
    s_waitcnt vmcnt(11)
    v_mfma_f32_16x16x32_bf16 v[64:67], a[112:115], a[32:35], v[64:67]
    ds_read_b128 a[136:139], v184 offset:55296
    v_mfma_f32_16x16x32_bf16 v[72:75], a[112:115], a[88:91], v[72:75]
    ds_read_b128 v[160:163], v186 offset:49152
    v_mfma_f32_16x16x32_bf16 v[68:71], a[116:119], a[32:35], v[68:71]
    ds_read_b128 a[140:143], v184 offset:56320
    v_mfma_f32_16x16x32_bf16 v[76:79], a[116:119], a[88:91], v[76:79]
    v_add_f32 v201, v221, v201
    s_waitcnt lgkmcnt(4)
    v_mfma_f32_16x16x32_bf16 v[80:83], a[120:123], a[32:35], v[80:83]
    ds_read_b128 a[112:115], v184 offset:57344
    v_mfma_f32_16x16x32_bf16 v[88:91], a[120:123], a[88:91], v[88:91]
    v_add_f32 v204, v222, v204
    v_mfma_f32_16x16x32_bf16 v[84:87], a[124:127], a[32:35], v[84:87]
    ds_read_b128 a[116:119], v184 offset:58368
    v_mfma_f32_16x16x32_bf16 v[92:95], a[124:127], a[88:91], v[92:95]
    v_add_f32 v205, v223, v205
    s_waitcnt lgkmcnt(4)
    v_mfma_f32_16x16x32_bf16 v[96:99], a[32:35], a[128:131], v[96:99]
    ds_read_b128 a[120:123], v184 offset:59392
    v_mfma_f32_16x16x32_bf16 v[104:107], a[88:91], a[128:131], v[104:107]
    v_mfma_f32_16x16x32_bf16 v[100:103], a[32:35], a[132:135], v[100:103]
    ds_read_b128 a[124:127], v184 offset:60416
    v_mfma_f32_16x16x32_bf16 v[108:111], a[88:91], a[132:135], v[108:111]
    s_waitcnt lgkmcnt(4)
    s_waitcnt vmcnt(9)
    v_mfma_f32_16x16x32_bf16 v[64:67], a[136:139], a[36:39], v[64:67]
    ds_read_b128 a[128:131], v185 offset:0
    v_mfma_f32_16x16x32_bf16 v[72:75], a[136:139], a[92:95], v[72:75]
    ds_read_b128 v[164:167], v186 offset:55296
    v_mfma_f32_16x16x32_bf16 v[68:71], a[140:143], a[36:39], v[68:71]
    ds_read_b128 a[132:135], v185 offset:1024
    v_mfma_f32_16x16x32_bf16 v[76:79], a[140:143], a[92:95], v[76:79]
    s_waitcnt lgkmcnt(4)
    v_mfma_f32_16x16x32_bf16 v[80:83], a[112:115], a[36:39], v[80:83]
    ds_read_b128 a[136:139], v185 offset:2048
    v_mfma_f32_16x16x32_bf16 v[88:91], a[112:115], a[92:95], v[88:91]
    v_mfma_f32_16x16x32_bf16 v[84:87], a[116:119], a[36:39], v[84:87]
    ds_read_b128 a[140:143], v185 offset:3072
    v_mfma_f32_16x16x32_bf16 v[92:95], a[116:119], a[92:95], v[92:95]
    s_waitcnt lgkmcnt(4)
    v_mfma_f32_16x16x32_bf16 v[96:99], a[36:39], a[120:123], v[96:99]
    ds_read_b128 a[112:115], v185 offset:4096
    v_mfma_f32_16x16x32_bf16 v[104:107], a[92:95], a[120:123], v[104:107]
    v_mfma_f32_16x16x32_bf16 v[100:103], a[36:39], a[124:127], v[100:103]
    ds_read_b128 a[116:119], v185 offset:5120
    v_mfma_f32_16x16x32_bf16 v[108:111], a[92:95], a[124:127], v[108:111]
    s_waitcnt vmcnt(0)
    v_cmp_gt_u32 vcc, s77, v248
    s_cbranch_vccz L_halo_ok_61
    s_mov_b32 s96, 0
L_halo_wait_62:
    buffer_load_dword v248, v249, s[24:27], s76 offen sc1
    s_add_u32 s96, s96, 1
    s_cmp_gt_u32 s96, 200000
    s_cbranch_scc1 L_end
    s_waitcnt vmcnt(0)
    v_cmp_gt_u32 vcc, s77, v248
    s_cbranch_vccnz L_halo_wait_62
L_halo_ok_61:
    s_add_u32 s90, s93, s82
    s_add_u32 s90, s90, 0
    s_add_u32 m0, s93, 92160
    s_nop 0
    buffer_load_dwordx4 v2, s[24:27], s90 offen sc1 lds
    s_add_u32 s90, s93, s82
    s_add_u32 s90, s90, 4096
    s_add_u32 m0, s93, 96256
    s_nop 0
    buffer_load_dwordx4 v2, s[24:27], s90 offen sc1 lds
    s_add_u32 s90, s93, s82
    s_add_u32 s90, s90, 8192
    s_add_u32 m0, s93, 100352
    s_nop 0
    buffer_load_dwordx4 v2, s[24:27], s90 offen sc1 lds
    s_cmp_ge_u32 s42, 2
    s_cbranch_scc1 L_skip_63
    s_add_u32 s90, s93, s82
    s_add_u32 s90, s90, 12288
    s_add_u32 m0, s93, 104448
    s_nop 0
    buffer_load_dwordx4 v2, s[24:27], s90 offen sc1 lds
L_skip_63:
    buffer_load_dwordx4 v[208:211], v52, s[24:27], s83 offen sc1
    s_waitcnt lgkmcnt(4)
    v_mfma_f32_16x16x32_bf16 v[64:67], a[128:131], a[40:43], v[64:67]
    ds_read_b128 a[120:123], v185 offset:6144
    v_mfma_f32_16x16x32_bf16 v[72:75], a[128:131], a[96:99], v[72:75]
    ds_read_b128 v[168:171], v187 offset:0
    buffer_load_dword a150, v0, s[24:27], 0 offen
    v_mfma_f32_16x16x32_bf16 v[68:71], a[132:135], a[40:43], v[68:71]
    ds_read_b128 a[124:127], v185 offset:7168
    v_mfma_f32_16x16x32_bf16 v[76:79], a[132:135], a[96:99], v[76:79]
    s_waitcnt lgkmcnt(4)
    v_mfma_f32_16x16x32_bf16 v[80:83], a[136:139], a[40:43], v[80:83]
    ds_read_b128 a[128:131], v185 offset:8192
    v_mfma_f32_16x16x32_bf16 v[88:91], a[136:139], a[96:99], v[88:91]
    s_mov_b32 s90, 0
    s_add_u32 m0, s93, 106496
    v_mfma_f32_16x16x32_bf16 v[84:87], a[140:143], a[40:43], v[84:87]
    buffer_load_dwordx4 v7, s[12:15], s90 offen lds
    ds_read_b128 a[132:135], v185 offset:9216
    v_mfma_f32_16x16x32_bf16 v[92:95], a[140:143], a[96:99], v[92:95]
    s_waitcnt lgkmcnt(4)
    v_mfma_f32_16x16x32_bf16 v[96:99], a[40:43], a[112:115], v[96:99]
    ds_read_b128 a[136:139], v185 offset:10240
    v_mfma_f32_16x16x32_bf16 v[104:107], a[96:99], a[112:115], v[104:107]
    s_mov_b32 s90, 25088
    s_add_u32 m0, s93, 110592
    v_mfma_f32_16x16x32_bf16 v[100:103], a[40:43], a[116:119], v[100:103]
    buffer_load_dwordx4 v7, s[12:15], s90 offen lds
    ds_read_b128 a[140:143], v185 offset:11264
    v_mfma_f32_16x16x32_bf16 v[108:111], a[96:99], a[116:119], v[108:111]
    s_waitcnt lgkmcnt(4)
    v_mfma_f32_16x16x32_bf16 v[64:67], a[120:123], a[44:47], v[64:67]
    ds_read_b128 a[112:115], v185 offset:12288
    v_mfma_f32_16x16x32_bf16 v[72:75], a[120:123], a[100:103], v[72:75]
    ds_read_b128 v[172:175], v187 offset:6144
    s_mov_b32 s90, 50176
    s_add_u32 m0, s93, 114688
    v_mfma_f32_16x16x32_bf16 v[68:71], a[124:127], a[44:47], v[68:71]
    buffer_load_dwordx4 v7, s[12:15], s90 offen lds
    ds_read_b128 a[116:119], v185 offset:13312
    v_mfma_f32_16x16x32_bf16 v[76:79], a[124:127], a[100:103], v[76:79]
    s_waitcnt lgkmcnt(4)
    v_mfma_f32_16x16x32_bf16 v[80:83], a[128:131], a[44:47], v[80:83]
    ds_read_b128 a[120:123], v185 offset:14336
    v_mfma_f32_16x16x32_bf16 v[88:91], a[128:131], a[100:103], v[88:91]
    s_mov_b32 s90, 75264
    s_add_u32 m0, s93, 118784
    v_mfma_f32_16x16x32_bf16 v[84:87], a[132:135], a[44:47], v[84:87]
    buffer_load_dwordx4 v7, s[12:15], s90 offen lds
    ds_read_b128 a[124:127], v185 offset:15360
    v_mfma_f32_16x16x32_bf16 v[92:95], a[132:135], a[100:103], v[92:95]
    s_waitcnt lgkmcnt(4)
    v_mfma_f32_16x16x32_bf16 v[96:99], a[44:47], a[136:139], v[96:99]
    ds_read_b128 a[128:131], v185 offset:16384
    v_mfma_f32_16x16x32_bf16 v[104:107], a[100:103], a[136:139], v[104:107]
    s_mov_b32 s90, 100352
    s_add_u32 m0, s93, 122880
    v_mfma_f32_16x16x32_bf16 v[100:103], a[44:47], a[140:143], v[100:103]
    buffer_load_dwordx4 v7, s[12:15], s90 offen lds
    ds_read_b128 a[132:135], v185 offset:17408
    v_mfma_f32_16x16x32_bf16 v[108:111], a[100:103], a[140:143], v[108:111]
    s_waitcnt lgkmcnt(4)
    v_mfma_f32_16x16x32_bf16 v[64:67], a[112:115], a[48:51], v[64:67]
    ds_read_b128 a[136:139], v185 offset:18432
    v_mfma_f32_16x16x32_bf16 v[72:75], a[112:115], a[104:107], v[72:75]
    ds_read_b128 v[176:179], v187 offset:12288
    s_mov_b32 s90, 125440
    s_add_u32 m0, s93, 126976
    v_mfma_f32_16x16x32_bf16 v[68:71], a[116:119], a[48:51], v[68:71]
    buffer_load_dwordx4 v7, s[12:15], s90 offen lds
    ds_read_b128 a[140:143], v185 offset:19456
    v_mfma_f32_16x16x32_bf16 v[76:79], a[116:119], a[104:107], v[76:79]
    s_waitcnt lgkmcnt(4)
    v_mfma_f32_16x16x32_bf16 v[80:83], a[120:123], a[48:51], v[80:83]
    ds_read_b128 a[112:115], v185 offset:20480
    v_mfma_f32_16x16x32_bf16 v[88:91], a[120:123], a[104:107], v[88:91]
    s_mov_b32 s90, 150528
    s_add_u32 m0, s93, 131072
    v_mfma_f32_16x16x32_bf16 v[84:87], a[124:127], a[48:51], v[84:87]
    buffer_load_dwordx4 v7, s[12:15], s90 offen lds
    ds_read_b128 a[116:119], v185 offset:21504
    v_mfma_f32_16x16x32_bf16 v[92:95], a[124:127], a[104:107], v[92:95]
    s_waitcnt lgkmcnt(4)
    v_mfma_f32_16x16x32_bf16 v[96:99], a[48:51], a[128:131], v[96:99]
    ds_read_b128 a[120:123], v185 offset:22528
    v_mfma_f32_16x16x32_bf16 v[104:107], a[104:107], a[128:131], v[104:107]
    s_mov_b32 s90, 200704
    s_add_u32 m0, s93, 135168
    v_mfma_f32_16x16x32_bf16 v[100:103], a[48:51], a[132:135], v[100:103]
    buffer_load_dwordx4 v7, s[12:15], s90 offen lds
    ds_read_b128 a[124:127], v185 offset:23552
    v_mfma_f32_16x16x32_bf16 v[108:111], a[104:107], a[132:135], v[108:111]
    s_waitcnt lgkmcnt(4)
    v_mfma_f32_16x16x32_bf16 v[64:67], a[136:139], a[52:55], v[64:67]
    v_mfma_f32_16x16x32_bf16 v[72:75], a[136:139], a[108:111], v[72:75]
    ds_read_b128 v[180:183], v187 offset:18432
    s_mov_b32 s90, 225792
    s_add_u32 m0, s93, 139264
    v_mfma_f32_16x16x32_bf16 v[68:71], a[140:143], a[52:55], v[68:71]
    buffer_load_dwordx4 v7, s[12:15], s90 offen lds
    v_mfma_f32_16x16x32_bf16 v[76:79], a[140:143], a[108:111], v[76:79]
    s_waitcnt lgkmcnt(2)
    v_mfma_f32_16x16x32_bf16 v[80:83], a[112:115], a[52:55], v[80:83]
    v_mfma_f32_16x16x32_bf16 v[88:91], a[112:115], a[108:111], v[88:91]
    s_mov_b32 s90, 250880
    s_add_u32 m0, s93, 143360
    v_mfma_f32_16x16x32_bf16 v[84:87], a[116:119], a[52:55], v[84:87]
    buffer_load_dwordx4 v7, s[12:15], s90 offen lds
    v_mfma_f32_16x16x32_bf16 v[92:95], a[116:119], a[108:111], v[92:95]
    s_waitcnt lgkmcnt(0)
    v_mfma_f32_16x16x32_bf16 v[96:99], a[52:55], a[120:123], v[96:99]
    v_mfma_f32_16x16x32_bf16 v[104:107], a[108:111], a[120:123], v[104:107]
    s_mov_b32 s90, 275968
    s_add_u32 m0, s93, 147456
    v_mfma_f32_16x16x32_bf16 v[100:103], a[52:55], a[124:127], v[100:103]
    buffer_load_dwordx4 v7, s[12:15], s90 offen lds
    v_mfma_f32_16x16x32_bf16 v[108:111], a[108:111], a[124:127], v[108:111]
    s_waitcnt vmcnt(12)
    v_add_f32 v208, v208, v210
    v_add_f32 v209, v209, v211
    v_mov_b32 v220, v208
    v_mov_b32 v221, v209
    s_nop 0
    v_permlane32_swap_b32 v220, v208
    v_permlane32_swap_b32 v221, v209
    v_add_f32 v208, v220, v208
    v_add_f32 v209, v221, v209
    v_mov_b32 v220, v208
    v_mov_b32 v221, v209
    s_nop 0
    v_permlane16_swap_b32 v220, v208
    v_permlane16_swap_b32 v221, v209
    v_add_f32 v208, v220, v208
    v_add_f32 v209, v221, v209
    s_barrier
    v_add_u32 v221, 92160, v2
    ds_read_b128 a[56:59], v221 offset:0
    ds_read_b128 a[60:63], v221 offset:1024
    ds_read_b128 a[64:67], v221 offset:2048
    ds_read_b128 a[68:71], v221 offset:3072
    ds_read_b128 a[72:75], v221 offset:4096
    ds_read_b128 a[76:79], v221 offset:5120
    ds_read_b128 a[80:83], v221 offset:6144
    ds_read_b128 a[84:87], v221 offset:7168
    ds_read_b128 a[88:91], v221 offset:8192
    ds_read_b128 a[92:95], v221 offset:9216
    ds_read_b128 a[96:99], v221 offset:10240
    ds_read_b128 a[100:103], v221 offset:11264
    ds_read_b128 a[104:107], v221 offset:12288
    ds_read_b128 a[108:111], v221 offset:13312
    s_waitcnt lgkmcnt(0)
    s_barrier
    s_cmp_ge_u32 s42, 2
    s_cbranch_scc1 L_halo_v_64
    v_mfma_f32_16x16x32_bf16 v[112:115], v[128:131], a[56:59], 0
    v_mfma_f32_16x16x32_bf16 v[112:115], v[132:135], a[60:63], v[112:115]
    v_mfma_f32_16x16x32_bf16 v[112:115], v[136:139], a[64:67], v[112:115]
    v_mfma_f32_16x16x32_bf16 v[112:115], v[140:143], a[68:71], v[112:115]
    v_mfma_f32_16x16x32_bf16 v[112:115], v[144:147], a[72:75], v[112:115]
    v_mfma_f32_16x16x32_bf16 v[112:115], v[148:151], a[76:79], v[112:115]
    v_mfma_f32_16x16x32_bf16 v[112:115], v[152:155], a[80:83], v[112:115]
    v_mfma_f32_16x16x32_bf16 v[112:115], v[156:159], a[84:87], v[112:115]
    v_mfma_f32_16x16x32_bf16 v[112:115], v[160:163], a[88:91], v[112:115]
    v_mfma_f32_16x16x32_bf16 v[112:115], v[164:167], a[92:95], v[112:115]
    v_mfma_f32_16x16x32_bf16 v[112:115], v[168:171], a[96:99], v[112:115]
    v_mfma_f32_16x16x32_bf16 v[112:115], v[172:175], a[100:103], v[112:115]
    v_mfma_f32_16x16x32_bf16 v[112:115], v[176:179], a[104:107], v[112:115]
    v_mfma_f32_16x16x32_bf16 v[112:115], v[180:183], a[108:111], v[112:115]
    s_branch L_halo_d_65
L_halo_v_64:
    s_nop 6
    v_mfma_f32_16x16x32_bf16 v[112:115], a[56:59], v[128:131], 0
    v_mfma_f32_16x16x32_bf16 v[112:115], a[60:63], v[132:135], v[112:115]
    v_mfma_f32_16x16x32_bf16 v[112:115], a[64:67], v[136:139], v[112:115]
    v_mfma_f32_16x16x32_bf16 v[112:115], a[68:71], v[140:143], v[112:115]
    v_mfma_f32_16x16x32_bf16 v[112:115], a[72:75], v[144:147], v[112:115]
    v_mfma_f32_16x16x32_bf16 v[112:115], a[76:79], v[148:151], v[112:115]
    v_mfma_f32_16x16x32_bf16 v[112:115], a[80:83], v[152:155], v[112:115]
    v_mfma_f32_16x16x32_bf16 v[112:115], a[84:87], v[156:159], v[112:115]
    v_mfma_f32_16x16x32_bf16 v[112:115], a[88:91], v[160:163], v[112:115]
    v_mfma_f32_16x16x32_bf16 v[112:115], a[92:95], v[164:167], v[112:115]
    v_mfma_f32_16x16x32_bf16 v[112:115], a[96:99], v[168:171], v[112:115]
    v_mfma_f32_16x16x32_bf16 v[112:115], a[100:103], v[172:175], v[112:115]
    v_mfma_f32_16x16x32_bf16 v[112:115], a[104:107], v[176:179], v[112:115]
    v_mfma_f32_16x16x32_bf16 v[112:115], a[108:111], v[180:183], v[112:115]
L_halo_d_65:
    s_lshl_b32 s84, s3, 4
    s_add_u32 s84, s84, s41
    s_lshl_b32 s84, s84, 10
    s_add_u32 s84, s84, 0
    s_add_u32 s85, s84, 16384
    s_mul_i32 s89, s42, 7168
    s_add_u32 s89, s89, 6144
    v_add_u32 v240, s89, v2
    v_add_u32 v241, 61440, v240
    v_mul_f32 v200, 0x3b124925, v200
    v_mul_f32 v201, 0x3b124925, v201
    v_fma_f32 v201, -v200, v200, v201
    v_max_f32 v201, 0, v201
    v_add_f32 v128, 0x3727c5ac, v201
    v_rsq_f32 v212, v128
    s_nop 0
    v_mul_f32 v215, v200, v212
    v_mul_f32 v204, 0x3b124925, v204
    v_mul_f32 v205, 0x3b124925, v205
    v_fma_f32 v205, -v204, v204, v205
    v_max_f32 v205, 0, v205
    v_add_f32 v129, 0x3727c5ac, v205
    v_rsq_f32 v213, v129
    s_mov_b32 s90, 301056
    s_add_u32 m0, s93, 151552
    v_mul_f32 v216, v204, v213
    buffer_load_dwordx4 v7, s[12:15], s90 offen lds
    v_mul_f32 v208, 0x3b124925, v208
    v_mul_f32 v209, 0x3b124925, v209
    v_fma_f32 v209, -v208, v208, v209
    v_max_f32 v209, 0, v209
    v_add_f32 v130, 0x3727c5ac, v209
    v_rsq_f32 v214, v130
    s_nop 0
    v_mul_f32 v217, v208, v214
    s_mov_b64 exec, s[98:99]
    ds_write_b32 v54, v212 offset:0
    ds_write_b32 v54, v215 offset:64
    ds_write_b32 v54, v213 offset:128
    ds_write_b32 v54, v216 offset:192
    ds_write_b32 v54, v214 offset:256
    ds_write_b32 v54, v217 offset:320
    s_mov_b64 exec, -1
    ds_read_b128 v[132:135], v53 offset:0
    ds_read_b128 v[136:139], v53 offset:64
    ds_read_b128 v[140:143], v53 offset:128
    ds_read_b128 v[144:147], v53 offset:192
    v_and_b32 v128, 15, v57
    v_lshlrev_b32 v128, 2, v128
    s_mov_b32 s90, 326144
    s_add_u32 m0, s93, 155648
    ds_read_b32 v148, v128 offset:256
    buffer_load_dwordx4 v7, s[12:15], s90 offen lds
    ds_read_b32 v150, v128 offset:320
    ds_read_b128 v[152:155], v55 offset:0
    ds_read_b128 v[156:159], v55 offset:64
    ds_read_b128 v[160:163], v55 offset:128
    ds_read_b128 v[164:167], v55 offset:192
    ds_read_b128 v[168:171], v55 offset:256
    ds_read_b128 v[172:175], v55 offset:320
    v_mov_b32 v176, v212
    v_mov_b32 v177, v215
    v_mov_b32 v178, v213
    v_mov_b32 v179, v216
    v_mov_b32 v180, v214
    v_mov_b32 v181, v217
    v_mul_f32 v182, 0x3e8b97f6, v212
    s_mov_b32 s90, 351232
    s_add_u32 m0, s93, 159744
    v_mul_f32 v183, 0x3e8b97f6, v215
    buffer_load_dwordx4 v7, s[12:15], s90 offen lds
    v_mul_f32 v184, 0x3e8b97f6, v213
    v_mul_f32 v185, 0x3e8b97f6, v216
    v_pk_mul_f32 v[80:81], v[80:81], v[176:177] op_sel_hi:[1,0]
    v_pk_mul_f32 v[82:83], v[82:83], v[176:177] op_sel_hi:[1,0]
    s_waitcnt lgkmcnt(9)
    v_pk_fma_f32 v[80:81], v[140:141], v[176:177], v[80:81] op_sel:[0,1,0] op_sel_hi:[1,1,1] neg_lo:[0,1,0] neg_hi:[0,1,0]
    v_pk_fma_f32 v[82:83], v[142:143], v[176:177], v[82:83] op_sel:[0,1,0] op_sel_hi:[1,1,1] neg_lo:[0,1,0] neg_hi:[0,1,0]
    v_cvt_pk_bf16_f32 v196, v80, v81
    v_cvt_pk_bf16_f32 v197, v82, v83
    v_pk_mul_f32 v[84:85], v[84:85], v[176:177] op_sel_hi:[1,0]
    v_pk_mul_f32 v[86:87], v[86:87], v[176:177] op_sel_hi:[1,0]
    s_waitcnt lgkmcnt(8)
    v_pk_fma_f32 v[84:85], v[144:145], v[176:177], v[84:85] op_sel:[0,1,0] op_sel_hi:[1,1,1] neg_lo:[0,1,0] neg_hi:[0,1,0]
    v_pk_fma_f32 v[86:87], v[146:147], v[176:177], v[86:87] op_sel:[0,1,0] op_sel_hi:[1,1,1] neg_lo:[0,1,0] neg_hi:[0,1,0]
    v_cvt_pk_bf16_f32 v198, v84, v85
    v_cvt_pk_bf16_f32 v199, v86, v87
    ds_write_b128 v240, a[156:159] offset:0
    v_pk_mul_f32 v[88:89], v[88:89], v[178:179] op_sel_hi:[1,0]
    v_pk_mul_f32 v[90:91], v[90:91], v[178:179] op_sel_hi:[1,0]
    v_pk_fma_f32 v[88:89], v[140:141], v[178:179], v[88:89] op_sel:[0,1,0] op_sel_hi:[1,1,1] neg_lo:[0,1,0] neg_hi:[0,1,0]
    v_pk_fma_f32 v[90:91], v[142:143], v[178:179], v[90:91] op_sel:[0,1,0] op_sel_hi:[1,1,1] neg_lo:[0,1,0] neg_hi:[0,1,0]
    v_cvt_pk_bf16_f32 v200, v88, v89
    v_cvt_pk_bf16_f32 v201, v90, v91
    v_pk_mul_f32 v[92:93], v[92:93], v[178:179] op_sel_hi:[1,0]
    v_pk_mul_f32 v[94:95], v[94:95], v[178:179] op_sel_hi:[1,0]
    v_pk_fma_f32 v[92:93], v[144:145], v[178:179], v[92:93] op_sel:[0,1,0] op_sel_hi:[1,1,1] neg_lo:[0,1,0] neg_hi:[0,1,0]
    v_pk_fma_f32 v[94:95], v[146:147], v[178:179], v[94:95] op_sel:[0,1,0] op_sel_hi:[1,1,1] neg_lo:[0,1,0] neg_hi:[0,1,0]
    v_cvt_pk_bf16_f32 v202, v92, v93
    v_cvt_pk_bf16_f32 v203, v94, v95
    s_waitcnt lgkmcnt(6)
    v_pk_mul_f32 v[96:97], v[96:97], v[152:153]
    v_pk_mul_f32 v[98:99], v[98:99], v[154:155]
    s_waitcnt lgkmcnt(5)
    v_pk_fma_f32 v[96:97], v[156:157], v[148:149], v[96:97] op_sel_hi:[1,0,1] neg_lo:[1,0,0] neg_hi:[1,0,0]
    ds_write_b128 v240, a[160:163] offset:1024
    v_pk_fma_f32 v[98:99], v[158:159], v[148:149], v[98:99] op_sel_hi:[1,0,1] neg_lo:[1,0,0] neg_hi:[1,0,0]
    v_pk_mul_f32 v[100:101], v[100:101], v[152:153]
    v_pk_mul_f32 v[102:103], v[102:103], v[154:155]
    v_pk_fma_f32 v[100:101], v[156:157], v[150:151], v[100:101] op_sel_hi:[1,0,1] neg_lo:[1,0,0] neg_hi:[1,0,0]
    v_pk_fma_f32 v[102:103], v[158:159], v[150:151], v[102:103] op_sel_hi:[1,0,1] neg_lo:[1,0,0] neg_hi:[1,0,0]
    s_waitcnt lgkmcnt(5)
    v_pk_mul_f32 v[104:105], v[104:105], v[160:161]
    v_pk_mul_f32 v[106:107], v[106:107], v[162:163]
    s_waitcnt lgkmcnt(4)
    v_pk_fma_f32 v[104:105], v[164:165], v[148:149], v[104:105] op_sel_hi:[1,0,1] neg_lo:[1,0,0] neg_hi:[1,0,0]
    v_pk_fma_f32 v[106:107], v[166:167], v[148:149], v[106:107] op_sel_hi:[1,0,1] neg_lo:[1,0,0] neg_hi:[1,0,0]
    v_pk_mul_f32 v[108:109], v[108:109], v[160:161]
    v_pk_mul_f32 v[110:111], v[110:111], v[162:163]
    v_pk_fma_f32 v[108:109], v[164:165], v[150:151], v[108:109] op_sel_hi:[1,0,1] neg_lo:[1,0,0] neg_hi:[1,0,0]
    v_pk_fma_f32 v[110:111], v[166:167], v[150:151], v[110:111] op_sel_hi:[1,0,1] neg_lo:[1,0,0] neg_hi:[1,0,0]
    v_cvt_pk_bf16_f32 v206, v96, v97
    v_cvt_pk_bf16_f32 v207, v98, v99
    ds_write_b128 v240, a[164:167] offset:2048
    v_cvt_pk_bf16_f32 v210, v100, v101
    v_cvt_pk_bf16_f32 v211, v102, v103
    v_cvt_pk_bf16_f32 v214, v104, v105
    v_cvt_pk_bf16_f32 v215, v106, v107
    v_cvt_pk_bf16_f32 v218, v108, v109
    v_cvt_pk_bf16_f32 v219, v110, v111
    s_cmp_ge_u32 s42, 2
    s_cbranch_scc1 L_haff_v_66
    s_lshl_b32 s72, s42, 6
    v_add_u32 v128, s72, v53
    ds_read_b128 v[232:235], v128 offset:128
    s_waitcnt lgkmcnt(0)
    v_pk_mul_f32 v[112:113], v[112:113], v[180:181] op_sel_hi:[1,0]
    v_pk_mul_f32 v[114:115], v[114:115], v[180:181] op_sel_hi:[1,0]
    v_pk_fma_f32 v[112:113], v[232:233], v[180:181], v[112:113] op_sel:[0,1,0] op_sel_hi:[1,1,1] neg_lo:[0,1,0] neg_hi:[0,1,0]
    v_pk_fma_f32 v[114:115], v[234:235], v[180:181], v[114:115] op_sel:[0,1,0] op_sel_hi:[1,1,1] neg_lo:[0,1,0] neg_hi:[0,1,0]
    s_branch L_haff_d_67
L_haff_v_66:
    s_and_b32 s72, s42, 1
    s_cmp_eq_u32 s72, 1
    s_cselect_b64 vcc, -1, 0
    s_waitcnt lgkmcnt(0)
    v_cndmask_b32 v232, v148, v150, vcc
    v_pk_mul_f32 v[112:113], v[112:113], v[168:169]
    v_pk_mul_f32 v[114:115], v[114:115], v[170:171]
    v_pk_fma_f32 v[112:113], v[172:173], v[232:233], v[112:113] op_sel_hi:[1,0,1] neg_lo:[1,0,0] neg_hi:[1,0,0]
    v_pk_fma_f32 v[114:115], v[174:175], v[232:233], v[114:115] op_sel_hi:[1,0,1] neg_lo:[1,0,0] neg_hi:[1,0,0]
L_haff_d_67:
    v_cvt_pk_bf16_f32 v186, v112, v113
    v_cvt_pk_bf16_f32 v187, v114, v115
    s_cmp_eq_u32 s42, 3
    s_cbranch_scc1 L_skip_68
    ds_write_b128 v44, v[196:199] offset:0
    ds_write_b64 v44, v[206:207] offset:2048
    ds_write_b64 v44, v[210:211] offset:2056
    ds_write_b128 v44, v[200:203] offset:1024
    ds_write_b64 v44, v[214:215] offset:3072
    ds_write_b64 v44, v[218:219] offset:3080
L_skip_68:
    s_lshr_b32 s72, s42, 1
    s_lshl_b32 s72, s72, 10
    s_and_b32 s73, s42, 1
    s_lshl_b32 s73, s73, 3
    s_add_u32 s72, s72, s73
    s_add_u32 s72, s72, 92160
    v_add_u32 v128, s72, v2
    ds_write_b128 v240, a[168:171] offset:3072
    ds_write_b64 v128, v[186:187]
    v_pk_mul_f32 v[64:65], v[64:65], v[182:183] op_sel_hi:[1,0]
    v_pk_mul_f32 v[66:67], v[66:67], v[182:183] op_sel_hi:[1,0]
    v_pk_fma_f32 v[64:65], v[132:133], v[182:183], v[64:65] op_sel:[0,1,0] op_sel_hi:[1,1,1] neg_lo:[0,1,0] neg_hi:[0,1,0]
    v_pk_fma_f32 v[66:67], v[134:135], v[182:183], v[66:67] op_sel:[0,1,0] op_sel_hi:[1,1,1] neg_lo:[0,1,0] neg_hi:[0,1,0]
    v_cvt_pk_bf16_f32 v188, v64, v65
    v_cvt_pk_bf16_f32 v189, v66, v67
    v_pk_mul_f32 v[68:69], v[68:69], v[182:183] op_sel_hi:[1,0]
    v_pk_mul_f32 v[70:71], v[70:71], v[182:183] op_sel_hi:[1,0]
    v_pk_fma_f32 v[68:69], v[136:137], v[182:183], v[68:69] op_sel:[0,1,0] op_sel_hi:[1,1,1] neg_lo:[0,1,0] neg_hi:[0,1,0]
    v_pk_fma_f32 v[70:71], v[138:139], v[182:183], v[70:71] op_sel:[0,1,0] op_sel_hi:[1,1,1] neg_lo:[0,1,0] neg_hi:[0,1,0]
    v_cvt_pk_bf16_f32 v190, v68, v69
    v_cvt_pk_bf16_f32 v191, v70, v71
    v_pk_mul_f32 v[72:73], v[72:73], v[184:185] op_sel_hi:[1,0]
    v_pk_mul_f32 v[74:75], v[74:75], v[184:185] op_sel_hi:[1,0]
    ds_write_b128 v240, a[172:175] offset:4096
    v_pk_fma_f32 v[72:73], v[132:133], v[184:185], v[72:73] op_sel:[0,1,0] op_sel_hi:[1,1,1] neg_lo:[0,1,0] neg_hi:[0,1,0]
    v_pk_fma_f32 v[74:75], v[134:135], v[184:185], v[74:75] op_sel:[0,1,0] op_sel_hi:[1,1,1] neg_lo:[0,1,0] neg_hi:[0,1,0]
    v_cvt_pk_bf16_f32 v192, v72, v73
    v_cvt_pk_bf16_f32 v193, v74, v75
    v_pk_mul_f32 v[76:77], v[76:77], v[184:185] op_sel_hi:[1,0]
    v_pk_mul_f32 v[78:79], v[78:79], v[184:185] op_sel_hi:[1,0]
    v_pk_fma_f32 v[76:77], v[136:137], v[184:185], v[76:77] op_sel:[0,1,0] op_sel_hi:[1,1,1] neg_lo:[0,1,0] neg_hi:[0,1,0]
    v_pk_fma_f32 v[78:79], v[138:139], v[184:185], v[78:79] op_sel:[0,1,0] op_sel_hi:[1,1,1] neg_lo:[0,1,0] neg_hi:[0,1,0]
    v_cvt_pk_bf16_f32 v194, v76, v77
    v_cvt_pk_bf16_f32 v195, v78, v79
    s_mov_b32 exec_lo, 0
    s_mov_b32 exec_hi, 0xffff0000
    v_mov_b32 v190, 0
    v_mov_b32 v191, 0
    v_mov_b32 v194, 0
    v_mov_b32 v195, 0
    s_mov_b64 exec, -1
    s_waitcnt lgkmcnt(0)
    s_barrier
    ds_read_b128 v[224:227], v45
    ds_read_b64 v[204:205], v47 offset:0
    ds_read_b64 v[208:209], v47 offset:8
    ds_write_b128 v240, a[176:179] offset:5120
    ds_read_b128 v[228:231], v46
    ds_read_b64 v[212:213], v48 offset:0
    ds_read_b64 v[216:217], v48 offset:8
    v_mfma_f32_16x16x32_bf16 v[140:143], v[196:199], v[188:191], 0
    v_mfma_f32_16x16x32_bf16 v[144:147], v[200:203], v[192:195], 0
    s_waitcnt lgkmcnt(6)
    v_mfma_f32_16x16x32_bf16 v[132:135], v[224:227], v[188:191], 0
    s_waitcnt lgkmcnt(2)
    v_mfma_f32_16x16x32_bf16 v[136:139], v[228:231], v[192:195], 0
    v_mov_b32 v148, 0xff7fffff
    s_nop 4
    v_cndmask_b32 v152, v140, v132, s[50:51]
    s_nop 0
    v_cndmask_b32 v156, v144, v136, s[50:51]
    v_cndmask_b32 v153, v141, v133, s[52:53]
    ds_write_b128 v240, a[180:183] offset:6144
    v_cndmask_b32 v157, v145, v137, s[52:53]
    v_cndmask_b32 v154, v142, v134, s[54:55]
    v_cndmask_b32 v158, v146, v138, s[54:55]
    v_cndmask_b32 v155, v143, v135, s[56:57]
    v_cndmask_b32 v159, v147, v139, s[56:57]
    v_cndmask_b32 v152, v148, v152, s[58:59]
    v_cndmask_b32 v156, v148, v156, s[58:59]
    v_cndmask_b32 v153, v148, v153, s[60:61]
    v_cndmask_b32 v157, v148, v157, s[60:61]
    v_cndmask_b32 v154, v148, v154, s[62:63]
    v_cndmask_b32 v158, v148, v158, s[62:63]
    v_cndmask_b32 v155, v148, v155, s[64:65]
    v_cndmask_b32 v159, v148, v159, s[64:65]
    v_max3_f32 v160, v152, v153, v154
    v_max3_f32 v161, v156, v157, v158
    ds_write_b128 v240, a[184:187] offset:28672
    v_max_f32 v160, v160, v155
    v_max_f32 v161, v161, v159
    v_mov_b32 v128, v160
    v_mov_b32 v129, v161
    s_nop 0
    v_permlane32_swap_b32 v128, v160
    v_permlane32_swap_b32 v129, v161
    v_max_f32 v160, v128, v160
    v_max_f32 v161, v129, v161
    v_mov_b32 v128, v160
    v_mov_b32 v129, v161
    s_nop 0
    v_permlane16_swap_b32 v128, v160
    v_permlane16_swap_b32 v129, v161
    v_max_f32 v160, v128, v160
    v_max_f32 v161, v129, v161
    v_pk_add_f32 v[152:153], v[152:153], v[160:161] op_sel:[0,0] op_sel_hi:[1,0] neg_lo:[0,1] neg_hi:[0,1]
    ds_write_b128 v240, a[188:191] offset:29696
    v_pk_add_f32 v[154:155], v[154:155], v[160:161] op_sel:[0,0] op_sel_hi:[1,0] neg_lo:[0,1] neg_hi:[0,1]
    v_pk_add_f32 v[156:157], v[156:157], v[160:161] op_sel:[0,1] op_sel_hi:[1,1] neg_lo:[0,1] neg_hi:[0,1]
    v_pk_add_f32 v[158:159], v[158:159], v[160:161] op_sel:[0,1] op_sel_hi:[1,1] neg_lo:[0,1] neg_hi:[0,1]
    v_exp_f32 v152, v152
    v_exp_f32 v153, v153
    v_exp_f32 v154, v154
    v_exp_f32 v155, v155
    v_exp_f32 v156, v156
    v_exp_f32 v157, v157
    ds_write_b128 v240, a[192:195] offset:30720
    v_exp_f32 v158, v158
    v_exp_f32 v159, v159
    v_cvt_pk_bf16_f32 v128, v152, v153
    v_cvt_pk_bf16_f32 v129, v154, v155
    v_cvt_pk_bf16_f32 v130, v156, v157
    v_cvt_pk_bf16_f32 v131, v158, v159
    v_and_b32 v164, v40, v128
    v_and_b32 v165, v41, v129
    v_and_b32 v166, v42, v128
    v_and_b32 v167, v43, v129
    v_and_b32 v168, v40, v130
    v_and_b32 v169, v41, v131
    v_and_b32 v170, v42, v130
    ds_write_b128 v240, a[196:199] offset:31744
    v_and_b32 v171, v43, v131
    v_mfma_f32_16x16x32_bf16 v[172:175], v[204:207], v[164:167], 0
    v_mfma_f32_16x16x32_bf16 v[176:179], v[208:211], v[164:167], 0
    s_waitcnt lgkmcnt(6)
    v_mfma_f32_16x16x32_bf16 v[180:183], v[212:215], v[168:171], 0
    s_waitcnt lgkmcnt(5)
    v_mfma_f32_16x16x32_bf16 v[184:187], v[216:219], v[168:171], 0
    v_add_f32 v162, v152, v153
    v_add_f32 v154, v154, v155
    v_add_f32 v163, v156, v157
    v_add_f32 v158, v158, v159
    v_add_f32 v162, v162, v154
    v_add_f32 v163, v163, v158
    ds_write_b128 v240, a[200:203] offset:32768
    v_mov_b32 v128, v162
    v_mov_b32 v129, v163
    s_nop 0
    v_permlane32_swap_b32 v128, v162
    v_permlane32_swap_b32 v129, v163
    v_add_f32 v162, v128, v162
    v_add_f32 v163, v129, v163
    v_mov_b32 v128, v162
    v_mov_b32 v129, v163
    s_nop 0
    v_permlane16_swap_b32 v128, v162
    v_permlane16_swap_b32 v129, v163
    v_add_f32 v162, v128, v162
    v_add_f32 v163, v129, v163
    v_rcp_f32 v162, v162
    v_rcp_f32 v163, v163
    ds_write_b128 v240, a[204:207] offset:33792
    v_pk_mul_f32 v[172:173], v[172:173], v[162:163] op_sel:[0,0] op_sel_hi:[1,0]
    v_pk_mul_f32 v[174:175], v[174:175], v[162:163] op_sel:[0,0] op_sel_hi:[1,0]
    v_pk_mul_f32 v[176:177], v[176:177], v[162:163] op_sel:[0,0] op_sel_hi:[1,0]
    v_pk_mul_f32 v[178:179], v[178:179], v[162:163] op_sel:[0,0] op_sel_hi:[1,0]
    v_cvt_pk_bf16_f32 v232, v172, v173
    v_cvt_pk_bf16_f32 v233, v174, v175
    v_cvt_pk_bf16_f32 v234, v176, v177
    v_cvt_pk_bf16_f32 v235, v178, v179
    v_pk_mul_f32 v[180:181], v[180:181], v[162:163] op_sel:[0,1] op_sel_hi:[1,1]
    v_pk_mul_f32 v[182:183], v[182:183], v[162:163] op_sel:[0,1] op_sel_hi:[1,1]
    v_pk_mul_f32 v[184:185], v[184:185], v[162:163] op_sel:[0,1] op_sel_hi:[1,1]
    v_pk_mul_f32 v[186:187], v[186:187], v[162:163] op_sel:[0,1] op_sel_hi:[1,1]
    v_cvt_pk_bf16_f32 v236, v180, v181
    v_cvt_pk_bf16_f32 v237, v182, v183
    v_cvt_pk_bf16_f32 v238, v184, v185
    ds_write_b128 v240, a[208:211] offset:34816
    v_cvt_pk_bf16_f32 v239, v186, v187
    s_mov_b32 exec_lo, 0
    s_mov_b32 exec_hi, 0xffff0000
    v_mov_b32 v234, 0
    v_mov_b32 v235, 0
    v_mov_b32 v238, 0
    v_mov_b32 v239, 0
    s_mov_b64 exec, -1
    ds_write_b128 v240, a[212:215] offset:57344
    ds_write_b128 v240, a[216:219] offset:58368
    ds_write_b128 v240, a[220:223] offset:59392
    ds_write_b128 v240, a[224:227] offset:60416
    ds_write_b128 v240, a[228:231] offset:61440
    ds_write_b128 v240, a[232:235] offset:62464
    ds_write_b128 v240, a[236:239] offset:63488
    s_cmp_eq_u32 s44, 0
    s_cbranch_scc1 L_st_slow_69
    buffer_store_dwordx4 v[232:235], v2, s[24:27], s84 offen
    buffer_store_dwordx4 v[236:239], v2, s[24:27], s85 offen
    s_branch L_st_done_70
L_st_slow_69:
    buffer_store_dwordx4 v[232:235], v2, s[24:27], s84 offen sc1
    buffer_store_dwordx4 v[236:239], v2, s[24:27], s85 offen sc1
L_st_done_70:
    s_barrier
    s_add_u32 s45, s45, 1
    v_mov_b32 v254, s45
    v_mov_b32 v255, 0
    s_waitcnt vmcnt(0)
    s_mov_b64 exec, 1
    s_cmp_eq_u32 s44, 0
    s_cbranch_scc1 L_sig_slow_71
    buffer_store_dword v254, v255, s[24:27], s94 offen
    s_branch L_sig_done_72
L_sig_slow_71:
    buffer_store_dword v254, v255, s[24:27], s94 offen sc1
L_sig_done_72:
    s_mov_b64 exec, -1
    s_mov_b32 s90, 175616
    s_add_u32 m0, s93, 92160
    s_nop 0
    buffer_load_dwordx4 v7, s[12:15], s90 offen lds
    s_mov_b32 s90, 376320
    s_add_u32 m0, s93, 96256
    s_nop 0
    buffer_load_dwordx4 v7, s[12:15], s90 offen lds
    s_xor_b32 s79, s0, 1
    s_mul_i32 s78, s0, 16384
    s_mul_i32 s79, s79, 16384
    s_mul_i32 s81, s49, 8192
    s_add_u32 s81, s81, 0
    s_add_u32 s78, s78, s81
    s_add_u32 s79, s79, s81
    s_mul_i32 s82, s0, 14
    s_add_u32 s82, s82, s71
    s_lshl_b32 s82, s82, 10
    s_lshl_b32 s83, s0, 10
    s_lshl_b32 s84, s47, 3
    s_add_u32 s83, s83, s84
    s_add_u32 s72, s82, 2097152
    s_mov_b32 s96, 0
L_poll_75:
    buffer_load_dword v254, v3, s[24:27], s70 offen sc1
    s_add_u32 s96, s96, 1
    s_cmp_gt_u32 s96, 200000
    s_cbranch_scc1 L_end
    s_waitcnt vmcnt(0)
    v_cmp_gt_u32 vcc, s45, v254
    s_nop 3
    s_and_b64 vcc, vcc, s[68:69]
    s_cbranch_vccnz L_poll_75
    s_cmp_eq_u32 s66, 0
    s_cbranch_scc1 L_wo_idle_73
    buffer_load_dwordx4 a[104:107], v2, s[24:27], s79 offen offset:0 sc1
    buffer_load_dwordx4 a[72:75], v2, s[24:27], s78 offen offset:0 sc1
    buffer_load_dwordx4 a[108:111], v2, s[24:27], s79 offen offset:1024 sc1
    buffer_load_dwordx4 a[76:79], v2, s[24:27], s78 offen offset:1024 sc1
    buffer_load_dwordx4 a[112:115], v2, s[24:27], s79 offen offset:2048 sc1
    buffer_load_dwordx4 a[80:83], v2, s[24:27], s78 offen offset:2048 sc1
    buffer_load_dwordx4 a[116:119], v2, s[24:27], s79 offen offset:3072 sc1
    buffer_load_dwordx4 a[84:87], v2, s[24:27], s78 offen offset:3072 sc1
    s_barrier
    s_mul_i32 s73, s49, 24576
    s_add_u32 s73, s73, 14336
    v_subrev_u32 v208, s73, v8
    v_subrev_u32 v209, s73, v9
    v_subrev_u32 v210, s73, v10
    v_subrev_u32 v211, s73, v11
    ds_read_b64_tr_b16 v[212:213], v8 offset:0
    ds_read_b64_tr_b16 v[214:215], v8 offset:2048
    ds_read_b64_tr_b16 v[216:217], v9 offset:0
    ds_read_b64_tr_b16 v[218:219], v9 offset:2048
    ds_read_b64_tr_b16 v[220:221], v10 offset:0
    ds_read_b64_tr_b16 v[222:223], v10 offset:2048
    ds_read_b64_tr_b16 v[224:225], v11 offset:0
    ds_read_b64_tr_b16 v[226:227], v11 offset:2048
    ds_read_b64_tr_b16 v[228:229], v8 offset:4096
    ds_read_b64_tr_b16 v[230:231], v8 offset:6144
    ds_read_b64_tr_b16 v[232:233], v9 offset:4096
    ds_read_b64_tr_b16 v[234:235], v9 offset:6144
    s_waitcnt lgkmcnt(8)
    s_waitcnt vmcnt(6)
    v_mfma_f32_16x16x32_bf16 v[64:67], v[212:215], a[72:75], 0
    ds_read_b64_tr_b16 v[236:237], v10 offset:4096
    v_mfma_f32_16x16x32_bf16 v[80:83], v[212:215], a[104:107], 0
    ds_read_b64_tr_b16 v[238:239], v10 offset:6144
    s_add_u32 s78, s78, 4096
    s_add_u32 s79, s79, 4096
    buffer_load_dwordx4 a[120:123], v2, s[24:27], s79 offen offset:0 sc1
    v_mfma_f32_16x16x32_bf16 v[68:71], v[216:219], a[72:75], 0
    ds_read_b64_tr_b16 v[240:241], v11 offset:4096
    v_mfma_f32_16x16x32_bf16 v[84:87], v[216:219], a[104:107], 0
    ds_read_b64_tr_b16 v[242:243], v11 offset:6144
    buffer_load_dwordx4 a[88:91], v2, s[24:27], s78 offen offset:0 sc1
    s_waitcnt lgkmcnt(8)
    v_mfma_f32_16x16x32_bf16 v[72:75], v[220:223], a[72:75], 0
    ds_read_b64_tr_b16 v[212:213], v8 offset:8192
    v_mfma_f32_16x16x32_bf16 v[88:91], v[220:223], a[104:107], 0
    ds_read_b64_tr_b16 v[214:215], v8 offset:10240
    buffer_load_dwordx4 a[124:127], v2, s[24:27], s79 offen offset:1024 sc1
    v_mfma_f32_16x16x32_bf16 v[76:79], v[224:227], a[72:75], 0
    ds_read_b64_tr_b16 v[216:217], v9 offset:8192
    v_mfma_f32_16x16x32_bf16 v[92:95], v[224:227], a[104:107], 0
    ds_read_b64_tr_b16 v[218:219], v9 offset:10240
    buffer_load_dwordx4 a[92:95], v2, s[24:27], s78 offen offset:1024 sc1
    s_waitcnt lgkmcnt(8)
    s_waitcnt vmcnt(8)
    v_mfma_f32_16x16x32_bf16 v[64:67], v[228:231], a[76:79], v[64:67]
    ds_read_b64_tr_b16 v[220:221], v10 offset:8192
    v_mfma_f32_16x16x32_bf16 v[80:83], v[228:231], a[108:111], v[80:83]
    ds_read_b64_tr_b16 v[222:223], v10 offset:10240
    buffer_load_dwordx4 a[128:131], v2, s[24:27], s79 offen offset:2048 sc1
    v_mfma_f32_16x16x32_bf16 v[68:71], v[232:235], a[76:79], v[68:71]
    ds_read_b64_tr_b16 v[224:225], v11 offset:8192
    v_mfma_f32_16x16x32_bf16 v[84:87], v[232:235], a[108:111], v[84:87]
    ds_read_b64_tr_b16 v[226:227], v11 offset:10240
    buffer_load_dwordx4 a[96:99], v2, s[24:27], s78 offen offset:2048 sc1
    s_waitcnt lgkmcnt(8)
    v_mfma_f32_16x16x32_bf16 v[72:75], v[236:239], a[76:79], v[72:75]
    ds_read_b64_tr_b16 v[228:229], v8 offset:12288
    v_mfma_f32_16x16x32_bf16 v[88:91], v[236:239], a[108:111], v[88:91]
    ds_read_b64_tr_b16 v[230:231], v8 offset:14336
    buffer_load_dwordx4 a[132:135], v2, s[24:27], s79 offen offset:3072 sc1
    v_mfma_f32_16x16x32_bf16 v[76:79], v[240:243], a[76:79], v[76:79]
    ds_read_b64_tr_b16 v[232:233], v9 offset:12288
    v_mfma_f32_16x16x32_bf16 v[92:95], v[240:243], a[108:111], v[92:95]
    ds_read_b64_tr_b16 v[234:235], v9 offset:14336
    buffer_load_dwordx4 a[100:103], v2, s[24:27], s78 offen offset:3072 sc1
    s_waitcnt lgkmcnt(8)
    s_waitcnt vmcnt(10)
    v_mfma_f32_16x16x32_bf16 v[64:67], v[212:215], a[80:83], v[64:67]
    ds_read_b64_tr_b16 v[236:237], v10 offset:12288
    v_mfma_f32_16x16x32_bf16 v[80:83], v[212:215], a[112:115], v[80:83]
    ds_read_b64_tr_b16 v[238:239], v10 offset:14336
    buffer_load_dwordx4 v[200:203], v2, s[24:27], s72 offen offset:0 sc1
    v_mfma_f32_16x16x32_bf16 v[68:71], v[216:219], a[80:83], v[68:71]
    ds_read_b64_tr_b16 v[240:241], v11 offset:12288
    v_mfma_f32_16x16x32_bf16 v[84:87], v[216:219], a[112:115], v[84:87]
    ds_read_b64_tr_b16 v[242:243], v11 offset:14336
    buffer_load_dwordx4 v[204:207], v2, s[24:27], s72 offen offset:1024 sc1
    s_waitcnt lgkmcnt(8)
    v_mfma_f32_16x16x32_bf16 v[72:75], v[220:223], a[80:83], v[72:75]
    ds_read_b64_tr_b16 v[212:213], v8 offset:16384
    v_mfma_f32_16x16x32_bf16 v[88:91], v[220:223], a[112:115], v[88:91]
    ds_read_b64_tr_b16 v[214:215], v8 offset:18432
    v_mfma_f32_16x16x32_bf16 v[76:79], v[224:227], a[80:83], v[76:79]
    ds_read_b64_tr_b16 v[216:217], v9 offset:16384
    v_mfma_f32_16x16x32_bf16 v[92:95], v[224:227], a[112:115], v[92:95]
    ds_read_b64_tr_b16 v[218:219], v9 offset:18432
    s_waitcnt lgkmcnt(8)
    s_waitcnt vmcnt(10)
    v_mfma_f32_16x16x32_bf16 v[64:67], v[228:231], a[84:87], v[64:67]
    ds_read_b64_tr_b16 v[220:221], v10 offset:16384
    v_mfma_f32_16x16x32_bf16 v[80:83], v[228:231], a[116:119], v[80:83]
    ds_read_b64_tr_b16 v[222:223], v10 offset:18432
    v_mfma_f32_16x16x32_bf16 v[68:71], v[232:235], a[84:87], v[68:71]
    ds_read_b64_tr_b16 v[224:225], v11 offset:16384
    v_mfma_f32_16x16x32_bf16 v[84:87], v[232:235], a[116:119], v[84:87]
    ds_read_b64_tr_b16 v[226:227], v11 offset:18432
    s_waitcnt lgkmcnt(8)
    v_mfma_f32_16x16x32_bf16 v[72:75], v[236:239], a[84:87], v[72:75]
    ds_read_b64_tr_b16 v[228:229], v8 offset:20480
    v_mfma_f32_16x16x32_bf16 v[88:91], v[236:239], a[116:119], v[88:91]
    ds_read_b64_tr_b16 v[230:231], v8 offset:22528
    v_mfma_f32_16x16x32_bf16 v[76:79], v[240:243], a[84:87], v[76:79]
    ds_read_b64_tr_b16 v[232:233], v9 offset:20480
    v_mfma_f32_16x16x32_bf16 v[92:95], v[240:243], a[116:119], v[92:95]
    ds_read_b64_tr_b16 v[234:235], v9 offset:22528
    s_waitcnt lgkmcnt(8)
    s_waitcnt vmcnt(8)
    v_mfma_f32_16x16x32_bf16 v[64:67], v[212:215], a[88:91], v[64:67]
    ds_read_b64_tr_b16 v[236:237], v10 offset:20480
    v_mfma_f32_16x16x32_bf16 v[80:83], v[212:215], a[120:123], v[80:83]
    ds_read_b64_tr_b16 v[238:239], v10 offset:22528
    v_mfma_f32_16x16x32_bf16 v[68:71], v[216:219], a[88:91], v[68:71]
    ds_read_b64_tr_b16 v[240:241], v11 offset:20480
    v_mfma_f32_16x16x32_bf16 v[84:87], v[216:219], a[120:123], v[84:87]
    ds_read_b64_tr_b16 v[242:243], v11 offset:22528
    s_waitcnt lgkmcnt(8)
    v_mfma_f32_16x16x32_bf16 v[72:75], v[220:223], a[88:91], v[72:75]
    ds_read_b64_tr_b16 v[212:213], v8 offset:24576
    v_mfma_f32_16x16x32_bf16 v[88:91], v[220:223], a[120:123], v[88:91]
    ds_read_b64_tr_b16 v[214:215], v8 offset:26624
    v_mfma_f32_16x16x32_bf16 v[76:79], v[224:227], a[88:91], v[76:79]
    ds_read_b64_tr_b16 v[216:217], v9 offset:24576
    v_mfma_f32_16x16x32_bf16 v[92:95], v[224:227], a[120:123], v[92:95]
    ds_read_b64_tr_b16 v[218:219], v9 offset:26624
    s_waitcnt lgkmcnt(8)
    s_waitcnt vmcnt(6)
    v_mfma_f32_16x16x32_bf16 v[64:67], v[228:231], a[92:95], v[64:67]
    ds_read_b64_tr_b16 v[220:221], v10 offset:24576
    v_mfma_f32_16x16x32_bf16 v[80:83], v[228:231], a[124:127], v[80:83]
    ds_read_b64_tr_b16 v[222:223], v10 offset:26624
    v_mfma_f32_16x16x32_bf16 v[68:71], v[232:235], a[92:95], v[68:71]
    ds_read_b64_tr_b16 v[224:225], v11 offset:24576
    v_mfma_f32_16x16x32_bf16 v[84:87], v[232:235], a[124:127], v[84:87]
    ds_read_b64_tr_b16 v[226:227], v11 offset:26624
    s_waitcnt lgkmcnt(8)
    v_mfma_f32_16x16x32_bf16 v[72:75], v[236:239], a[92:95], v[72:75]
    ds_read_b64_tr_b16 v[228:229], v208 offset:0
    v_mfma_f32_16x16x32_bf16 v[88:91], v[236:239], a[124:127], v[88:91]
    ds_read_b64_tr_b16 v[230:231], v208 offset:2048
    v_mfma_f32_16x16x32_bf16 v[76:79], v[240:243], a[92:95], v[76:79]
    ds_read_b64_tr_b16 v[232:233], v209 offset:0
    v_mfma_f32_16x16x32_bf16 v[92:95], v[240:243], a[124:127], v[92:95]
    ds_read_b64_tr_b16 v[234:235], v209 offset:2048
    s_waitcnt lgkmcnt(8)
    s_waitcnt vmcnt(4)
    v_mfma_f32_16x16x32_bf16 v[64:67], v[212:215], a[96:99], v[64:67]
    ds_read_b64_tr_b16 v[236:237], v210 offset:0
    v_mfma_f32_16x16x32_bf16 v[80:83], v[212:215], a[128:131], v[80:83]
    ds_read_b64_tr_b16 v[238:239], v210 offset:2048
    v_mfma_f32_16x16x32_bf16 v[68:71], v[216:219], a[96:99], v[68:71]
    ds_read_b64_tr_b16 v[240:241], v211 offset:0
    v_mfma_f32_16x16x32_bf16 v[84:87], v[216:219], a[128:131], v[84:87]
    ds_read_b64_tr_b16 v[242:243], v211 offset:2048
    s_waitcnt lgkmcnt(8)
    v_mfma_f32_16x16x32_bf16 v[72:75], v[220:223], a[96:99], v[72:75]
    v_mfma_f32_16x16x32_bf16 v[88:91], v[220:223], a[128:131], v[88:91]
    v_mfma_f32_16x16x32_bf16 v[76:79], v[224:227], a[96:99], v[76:79]
    v_mfma_f32_16x16x32_bf16 v[92:95], v[224:227], a[128:131], v[92:95]
    s_waitcnt lgkmcnt(4)
    s_waitcnt vmcnt(2)
    v_mfma_f32_16x16x32_bf16 v[64:67], v[228:231], a[100:103], v[64:67]
    v_mfma_f32_16x16x32_bf16 v[80:83], v[228:231], a[132:135], v[80:83]
    v_mfma_f32_16x16x32_bf16 v[68:71], v[232:235], a[100:103], v[68:71]
    v_mfma_f32_16x16x32_bf16 v[84:87], v[232:235], a[132:135], v[84:87]
    s_waitcnt lgkmcnt(0)
    v_mfma_f32_16x16x32_bf16 v[72:75], v[236:239], a[100:103], v[72:75]
    v_mfma_f32_16x16x32_bf16 v[88:91], v[236:239], a[132:135], v[88:91]
    v_mfma_f32_16x16x32_bf16 v[76:79], v[240:243], a[100:103], v[76:79]
    v_mfma_f32_16x16x32_bf16 v[92:95], v[240:243], a[132:135], v[92:95]
    s_barrier
    s_lshr_b32 s89, s42, 1
    s_mul_i32 s89, s89, 7
    s_and_b32 s88, s42, 1
    s_lshl_b32 s88, s88, 2
    s_add_u32 s89, s89, s88
    s_lshl_b32 s89, s89, 10
    s_add_u32 s89, s89, 92160
    v_add_u32 v196, s89, v2
    ds_write_b128 v49, v[80:83] offset:0
    ds_write_b128 v49, v[84:87] offset:1024
    ds_write_b128 v49, v[88:91] offset:2048
    ds_write_b128 v49, v[92:95] offset:3072
    s_waitcnt vmcnt(1)
    v_lshlrev_b32 v160, 16, v200
    v_and_b32 v161, 0xffff0000, v200
    v_lshlrev_b32 v162, 16, v201
    v_and_b32 v163, 0xffff0000, v201
    v_lshlrev_b32 v164, 16, v202
    v_and_b32 v165, 0xffff0000, v202
    v_lshlrev_b32 v166, 16, v203
    v_and_b32 v167, 0xffff0000, v203
    s_waitcnt vmcnt(0)
    v_lshlrev_b32 v168, 16, v204
    v_and_b32 v169, 0xffff0000, v204
    v_lshlrev_b32 v170, 16, v205
    v_and_b32 v171, 0xffff0000, v205
    v_lshlrev_b32 v172, 16, v206
    v_and_b32 v173, 0xffff0000, v206
    v_lshlrev_b32 v174, 16, v207
    ds_write_b128 v196, a[240:243] offset:0
    v_and_b32 v175, 0xffff0000, v207
    v_pk_add_f32 v[64:65], v[64:65], v[160:161]
    v_pk_add_f32 v[66:67], v[66:67], v[162:163]
    v_pk_add_f32 v[68:69], v[68:69], v[164:165]
    v_pk_add_f32 v[70:71], v[70:71], v[166:167]
    v_pk_add_f32 v[72:73], v[72:73], v[168:169]
    v_pk_add_f32 v[74:75], v[74:75], v[170:171]
    v_pk_add_f32 v[76:77], v[76:77], v[172:173]
    v_pk_add_f32 v[78:79], v[78:79], v[174:175]
    s_add_u32 s82, s82, 2097152
    s_add_u32 s83, s83, 13631488
    s_waitcnt lgkmcnt(0)
    s_barrier
    ds_read_b128 v[128:131], v50 offset:0
    ds_read_b128 v[132:135], v50 offset:1024
    ds_read_b128 v[136:139], v50 offset:2048
    ds_read_b128 v[140:143], v50 offset:3072
    v_and_b32 v190, 15, v57
    v_lshlrev_b32 v190, 6, v190
    ds_write_b128 v196, a[244:247] offset:1024
    s_waitcnt lgkmcnt(4)
    v_pk_add_f32 v[64:65], v[64:65], v[128:129]
    v_pk_add_f32 v[66:67], v[66:67], v[130:131]
    s_waitcnt lgkmcnt(3)
    v_pk_add_f32 v[68:69], v[68:69], v[132:133]
    v_pk_add_f32 v[70:71], v[70:71], v[134:135]
    s_waitcnt lgkmcnt(2)
    v_pk_add_f32 v[72:73], v[72:73], v[136:137]
    v_pk_add_f32 v[74:75], v[74:75], v[138:139]
    s_waitcnt lgkmcnt(1)
    v_pk_add_f32 v[76:77], v[76:77], v[140:141]
    v_pk_add_f32 v[78:79], v[78:79], v[142:143]
    v_cvt_pk_bf16_f32 v176, v64, v65
    v_cvt_pk_bf16_f32 v177, v66, v67
    v_cvt_pk_bf16_f32 v178, v68, v69
    v_cvt_pk_bf16_f32 v179, v70, v71
    v_cvt_pk_bf16_f32 v180, v72, v73
    v_cvt_pk_bf16_f32 v181, v74, v75
    v_cvt_pk_bf16_f32 v182, v76, v77
    v_cvt_pk_bf16_f32 v183, v78, v79
    ds_write_b128 v196, a[248:251] offset:2048
    s_cmp_eq_u32 s44, 0
    s_cbranch_scc1 L_st_slow_76
    buffer_store_dwordx4 v[176:179], v2, s[24:27], s82 offen offset:0
    buffer_store_dwordx4 v[180:183], v2, s[24:27], s82 offen offset:1024
    s_branch L_st_done_77
L_st_slow_76:
    buffer_store_dwordx4 v[176:179], v2, s[24:27], s82 offen offset:0 sc1
    buffer_store_dwordx4 v[180:183], v2, s[24:27], s82 offen offset:1024 sc1
L_st_done_77:
    v_pk_mul_f32 v[192:193], v[64:65], v[64:65]
    v_pk_fma_f32 v[192:193], v[66:67], v[66:67], v[192:193]
    v_pk_add_f32 v[184:185], v[64:65], v[66:67]
    v_pk_fma_f32 v[192:193], v[68:69], v[68:69], v[192:193]
    v_pk_add_f32 v[184:185], v[184:185], v[68:69]
    v_pk_fma_f32 v[192:193], v[70:71], v[70:71], v[192:193]
    v_pk_add_f32 v[184:185], v[184:185], v[70:71]
    v_pk_fma_f32 v[192:193], v[72:73], v[72:73], v[192:193]
    v_pk_add_f32 v[184:185], v[184:185], v[72:73]
    v_pk_fma_f32 v[192:193], v[74:75], v[74:75], v[192:193]
    v_pk_add_f32 v[184:185], v[184:185], v[74:75]
    v_pk_fma_f32 v[192:193], v[76:77], v[76:77], v[192:193]
    v_pk_add_f32 v[184:185], v[184:185], v[76:77]
    v_pk_fma_f32 v[192:193], v[78:79], v[78:79], v[192:193]
    v_pk_add_f32 v[184:185], v[184:185], v[78:79]
    v_add_f32 v188, v184, v185
    v_add_f32 v189, v192, v193
    v_mov_b32 v190, 0
    v_mov_b32 v191, 0
    v_and_b32 v185, 15, v57
    v_lshlrev_b32 v185, 6, v185
    v_mov_b32 v186, v188
    v_mov_b32 v187, v189
    s_nop 0
    v_permlane32_swap_b32 v186, v188
    v_permlane32_swap_b32 v187, v189
    v_add_f32 v188, v186, v188
    v_add_f32 v189, v187, v189
    v_mov_b32 v186, v188
    v_mov_b32 v187, v189
    s_nop 0
    v_permlane16_swap_b32 v186, v188
    v_permlane16_swap_b32 v187, v189
    v_add_f32 v188, v186, v188
    v_add_f32 v189, v187, v189
    s_cmp_eq_u32 s47, 6
    s_cbranch_scc1 L_st_last_78
    s_cmp_eq_u32 s44, 0
    s_cbranch_scc1 L_st_slow_80
    s_mov_b64 exec, s[98:99]
    buffer_store_dwordx2 v[188:189], v185, s[24:27], s83 offen
    s_mov_b64 exec, -1
    s_branch L_st_done_81
L_st_slow_80:
    s_mov_b64 exec, s[98:99]
    buffer_store_dwordx2 v[188:189], v185, s[24:27], s83 offen sc1
    s_mov_b64 exec, -1
L_st_done_81:
    s_branch L_st_join_79
L_st_last_78:
    s_cmp_eq_u32 s44, 0
    s_cbranch_scc1 L_st_slow_82
    s_mov_b64 exec, s[98:99]
    buffer_store_dwordx4 v[188:191], v185, s[24:27], s83 offen
    s_mov_b64 exec, -1
    s_branch L_st_done_83
L_st_slow_82:
    s_mov_b64 exec, s[98:99]
    buffer_store_dwordx4 v[188:191], v185, s[24:27], s83 offen sc1
    s_mov_b64 exec, -1
L_st_done_83:
L_st_join_79:
    s_add_u32 s45, s45, 1
    v_mov_b32 v254, s45
    v_mov_b32 v255, 0
    s_waitcnt vmcnt(0)
    s_mov_b64 exec, 1
    s_cmp_eq_u32 s44, 0
    s_cbranch_scc1 L_sig_slow_84
    buffer_store_dword v254, v255, s[24:27], s94 offen
    s_branch L_sig_done_85
L_sig_slow_84:
    buffer_store_dword v254, v255, s[24:27], s94 offen sc1
L_sig_done_85:
    s_mov_b64 exec, -1
    s_mov_b32 s90, 802816
    s_add_u32 m0, s93, 135168
    s_nop 0
    buffer_load_dwordx4 v7, s[20:23], s90 offen lds
    s_mov_b32 s90, 831488
    s_add_u32 m0, s93, 139264
    s_nop 0
    buffer_load_dwordx4 v7, s[20:23], s90 offen lds
    s_mov_b32 s90, 860160
    s_add_u32 m0, s93, 143360
    s_nop 0
    buffer_load_dwordx4 v7, s[20:23], s90 offen lds
    s_mov_b32 s90, 888832
    s_add_u32 m0, s93, 147456
    s_nop 0
    buffer_load_dwordx4 v7, s[20:23], s90 offen lds
    s_mov_b32 s90, 114688
    s_add_u32 m0, s93, 122880
    s_nop 0
    buffer_load_dwordx4 v7, s[20:23], s90 offen lds
    s_mov_b32 s90, 917504
    s_add_u32 m0, s93, 151552
    s_nop 0
    buffer_load_dwordx4 v7, s[20:23], s90 offen lds
    s_mov_b32 s90, 143360
    s_add_u32 m0, s93, 126976
    s_nop 0
    buffer_load_dwordx4 v7, s[20:23], s90 offen lds
    s_mov_b32 s90, 946176
    s_add_u32 m0, s93, 155648
    s_nop 0
    buffer_load_dwordx4 v7, s[20:23], s90 offen lds
    s_mov_b32 s90, 172032
    s_add_u32 m0, s93, 131072
    s_nop 0
    buffer_load_dwordx4 v7, s[20:23], s90 offen lds
    s_mov_b32 s90, 974848
    s_add_u32 m0, s93, 159744
    s_nop 0
    buffer_load_dwordx4 v7, s[20:23], s90 offen lds
    s_branch L_wo_join_74
L_wo_idle_73:
    s_barrier
    s_lshr_b32 s89, s42, 1
    s_mul_i32 s89, s89, 7
    s_and_b32 s88, s42, 1
    s_lshl_b32 s88, s88, 2
    s_add_u32 s89, s89, s88
    s_lshl_b32 s89, s89, 10
    s_add_u32 s89, s89, 92160
    v_add_u32 v196, s89, v2
    ds_write_b128 v196, a[240:243] offset:0
    ds_write_b128 v196, a[244:247] offset:1024
    ds_write_b128 v196, a[248:251] offset:2048
    s_add_u32 s45, s45, 1
    v_mov_b32 v254, s45
    v_mov_b32 v255, 0
    s_waitcnt vmcnt(0)
    s_mov_b64 exec, 1
    s_cmp_eq_u32 s44, 0
    s_cbranch_scc1 L_sig_slow_86
    buffer_store_dword v254, v255, s[24:27], s94 offen
    s_branch L_sig_done_87
L_sig_slow_86:
    buffer_store_dword v254, v255, s[24:27], s94 offen sc1
L_sig_done_87:
    s_mov_b64 exec, -1
L_wo_join_74:
    s_bitcmp1_b32 s42, 0
    s_cbranch_scc1 L_skip_88
    ds_write_b128 v196, a[252:255] offset:3072
L_skip_88:
    s_mul_i32 s78, s3, 14336
    s_add_u32 s78, s78, 2097152
    s_add_u32 s79, s78, 14336
    s_lshl_b32 s80, s3, 10
    s_add_u32 s80, s80, 13631488
    s_mul_i32 s82, s41, 7
    s_lshr_b32 s82, s82, 1
    s_mul_i32 s83, s3, 56
    s_add_u32 s82, s82, s83
    s_lshl_b32 s82, s82, 10
    s_add_u32 s82, s82, 4194304
    s_add_u32 s83, s82, 57344
    s_mov_b32 s96, 0
L_poll_89:
    buffer_load_dword v254, v3, s[24:27], s70 offen sc1
    s_add_u32 s96, s96, 1
    s_cmp_gt_u32 s96, 200000
    s_cbranch_scc1 L_end
    s_waitcnt vmcnt(0)
    v_cmp_gt_u32 vcc, s45, v254
    s_nop 3
    s_and_b64 vcc, vcc, s[36:37]
    s_cbranch_vccnz L_poll_89
    buffer_load_dwordx4 a[76:79], v2, s[24:27], s79 offen offset:0 sc1
    buffer_load_dwordx4 a[72:75], v2, s[24:27], s78 offen offset:0 sc1
    buffer_load_dwordx4 a[84:87], v2, s[24:27], s79 offen offset:1024 sc1
    buffer_load_dwordx4 a[80:83], v2, s[24:27], s78 offen offset:1024 sc1
    buffer_load_dwordx4 a[92:95], v2, s[24:27], s79 offen offset:2048 sc1
    buffer_load_dwordx4 a[88:91], v2, s[24:27], s78 offen offset:2048 sc1
    buffer_load_dwordx4 a[100:103], v2, s[24:27], s79 offen offset:3072 sc1
    buffer_load_dwordx4 a[96:99], v2, s[24:27], s78 offen offset:3072 sc1
    s_waitcnt lgkmcnt(0)
    s_barrier
    buffer_load_dwordx4 v[200:203], v52, s[24:27], s80 offen sc1
    s_add_u32 s80, s80, 1024
    buffer_load_dwordx4 v[204:207], v52, s[24:27], s80 offen sc1
    v_add_u32 v224, 6144, v2
    v_add_u32 v225, 61440, v224
    ds_read_b128 a[184:187], v224 offset:0
    ds_read_b128 a[188:191], v224 offset:1024
    ds_read_b128 a[192:195], v224 offset:2048
    ds_read_b128 a[196:199], v224 offset:3072
    ds_read_b128 a[200:203], v224 offset:4096
    ds_read_b128 a[204:207], v224 offset:5120
    s_waitcnt lgkmcnt(4)
    s_waitcnt vmcnt(8)
    v_mfma_f32_16x16x32_bf16 v[64:67], a[184:187], a[72:75], 0
    ds_read_b128 a[208:211], v224 offset:6144
    v_mfma_f32_16x16x32_bf16 v[92:95], a[184:187], a[76:79], 0
    s_add_u32 s78, s78, 4096
    s_add_u32 s79, s79, 4096
    buffer_load_dwordx4 a[108:111], v2, s[24:27], s79 offen offset:0 sc1
    v_mfma_f32_16x16x32_bf16 v[68:71], a[188:191], a[72:75], 0
    ds_read_b128 a[212:215], v224 offset:7168
    v_mfma_f32_16x16x32_bf16 v[96:99], a[188:191], a[76:79], 0
    s_waitcnt lgkmcnt(4)
    v_mfma_f32_16x16x32_bf16 v[72:75], a[192:195], a[72:75], 0
    ds_read_b128 a[184:187], v224 offset:8192
    v_mfma_f32_16x16x32_bf16 v[100:103], a[192:195], a[76:79], 0
    buffer_load_dwordx4 a[104:107], v2, s[24:27], s78 offen offset:0 sc1
    v_mfma_f32_16x16x32_bf16 v[76:79], a[196:199], a[72:75], 0
    ds_read_b128 a[188:191], v224 offset:9216
    v_mfma_f32_16x16x32_bf16 v[104:107], a[196:199], a[76:79], 0
    s_waitcnt lgkmcnt(4)
    v_mfma_f32_16x16x32_bf16 v[80:83], a[200:203], a[72:75], 0
    ds_read_b128 a[192:195], v224 offset:10240
    v_mfma_f32_16x16x32_bf16 v[108:111], a[200:203], a[76:79], 0
    buffer_load_dwordx4 a[116:119], v2, s[24:27], s79 offen offset:1024 sc1
    v_mfma_f32_16x16x32_bf16 v[84:87], a[204:207], a[72:75], 0
    ds_read_b128 a[196:199], v224 offset:11264
    v_mfma_f32_16x16x32_bf16 v[112:115], a[204:207], a[76:79], 0
    s_waitcnt lgkmcnt(4)
    v_mfma_f32_16x16x32_bf16 v[88:91], a[208:211], a[72:75], 0
    ds_read_b128 a[200:203], v224 offset:12288
    v_mfma_f32_16x16x32_bf16 v[116:119], a[208:211], a[76:79], 0
    buffer_load_dwordx4 a[112:115], v2, s[24:27], s78 offen offset:1024 sc1
    s_waitcnt vmcnt(10)
    v_mfma_f32_16x16x32_bf16 v[64:67], a[212:215], a[80:83], v[64:67]
    ds_read_b128 a[204:207], v224 offset:13312
    v_mfma_f32_16x16x32_bf16 v[92:95], a[212:215], a[84:87], v[92:95]
    s_waitcnt lgkmcnt(4)
    v_mfma_f32_16x16x32_bf16 v[68:71], a[184:187], a[80:83], v[68:71]
    ds_read_b128 a[208:211], v224 offset:14336
    v_mfma_f32_16x16x32_bf16 v[96:99], a[184:187], a[84:87], v[96:99]
    buffer_load_dwordx4 a[124:127], v2, s[24:27], s79 offen offset:2048 sc1
    v_mfma_f32_16x16x32_bf16 v[72:75], a[188:191], a[80:83], v[72:75]
    ds_read_b128 a[212:215], v224 offset:15360
    v_mfma_f32_16x16x32_bf16 v[100:103], a[188:191], a[84:87], v[100:103]
    s_waitcnt lgkmcnt(4)
    v_mfma_f32_16x16x32_bf16 v[76:79], a[192:195], a[80:83], v[76:79]
    ds_read_b128 a[184:187], v224 offset:16384
    v_mfma_f32_16x16x32_bf16 v[104:107], a[192:195], a[84:87], v[104:107]
    v_mfma_f32_16x16x32_bf16 v[80:83], a[196:199], a[80:83], v[80:83]
    ds_read_b128 a[188:191], v224 offset:17408
    v_mfma_f32_16x16x32_bf16 v[108:111], a[196:199], a[84:87], v[108:111]
    buffer_load_dwordx4 a[120:123], v2, s[24:27], s78 offen offset:2048 sc1
    s_waitcnt lgkmcnt(4)
    v_mfma_f32_16x16x32_bf16 v[84:87], a[200:203], a[80:83], v[84:87]
    ds_read_b128 a[192:195], v224 offset:18432
    v_mfma_f32_16x16x32_bf16 v[112:115], a[200:203], a[84:87], v[112:115]
    v_mfma_f32_16x16x32_bf16 v[88:91], a[204:207], a[80:83], v[88:91]
    ds_read_b128 a[196:199], v224 offset:19456
    v_mfma_f32_16x16x32_bf16 v[116:119], a[204:207], a[84:87], v[116:119]
    buffer_load_dwordx4 a[132:135], v2, s[24:27], s79 offen offset:3072 sc1
    s_waitcnt lgkmcnt(4)
    s_waitcnt vmcnt(11)
    v_mfma_f32_16x16x32_bf16 v[64:67], a[208:211], a[88:91], v[64:67]
    ds_read_b128 a[200:203], v224 offset:20480
    v_mfma_f32_16x16x32_bf16 v[92:95], a[208:211], a[92:95], v[92:95]
    v_mfma_f32_16x16x32_bf16 v[68:71], a[212:215], a[88:91], v[68:71]
    ds_read_b128 a[204:207], v224 offset:21504
    v_mfma_f32_16x16x32_bf16 v[96:99], a[212:215], a[92:95], v[96:99]
    buffer_load_dwordx4 a[128:131], v2, s[24:27], s78 offen offset:3072 sc1
    s_waitcnt lgkmcnt(4)
    v_mfma_f32_16x16x32_bf16 v[72:75], a[184:187], a[88:91], v[72:75]
    ds_read_b128 a[208:211], v224 offset:22528
    v_mfma_f32_16x16x32_bf16 v[100:103], a[184:187], a[92:95], v[100:103]
    v_mfma_f32_16x16x32_bf16 v[76:79], a[188:191], a[88:91], v[76:79]
    ds_read_b128 a[212:215], v224 offset:23552
    v_mfma_f32_16x16x32_bf16 v[104:107], a[188:191], a[92:95], v[104:107]
    s_add_u32 s78, s78, 4096
    s_add_u32 s79, s79, 4096
    buffer_load_dwordx4 a[140:143], v2, s[24:27], s79 offen offset:0 sc1
    s_waitcnt lgkmcnt(4)
    v_mfma_f32_16x16x32_bf16 v[80:83], a[192:195], a[88:91], v[80:83]
    ds_read_b128 a[184:187], v224 offset:24576
    v_mfma_f32_16x16x32_bf16 v[108:111], a[192:195], a[92:95], v[108:111]
    v_mfma_f32_16x16x32_bf16 v[84:87], a[196:199], a[88:91], v[84:87]
    ds_read_b128 a[188:191], v224 offset:25600
    v_mfma_f32_16x16x32_bf16 v[112:115], a[196:199], a[92:95], v[112:115]
    buffer_load_dwordx4 a[136:139], v2, s[24:27], s78 offen offset:0 sc1
    s_waitcnt lgkmcnt(4)
    v_mfma_f32_16x16x32_bf16 v[88:91], a[200:203], a[88:91], v[88:91]
    ds_read_b128 a[192:195], v224 offset:26624
    v_mfma_f32_16x16x32_bf16 v[116:119], a[200:203], a[92:95], v[116:119]
    s_waitcnt vmcnt(12)
    v_mfma_f32_16x16x32_bf16 v[64:67], a[204:207], a[96:99], v[64:67]
    ds_read_b128 a[196:199], v224 offset:27648
    v_mfma_f32_16x16x32_bf16 v[92:95], a[204:207], a[100:103], v[92:95]
    s_waitcnt lgkmcnt(4)
    v_mfma_f32_16x16x32_bf16 v[68:71], a[208:211], a[96:99], v[68:71]
    ds_read_b128 a[200:203], v224 offset:28672
    v_mfma_f32_16x16x32_bf16 v[96:99], a[208:211], a[100:103], v[96:99]
    buffer_load_dwordx4 a[148:151], v2, s[24:27], s79 offen offset:1024 sc1
    v_mfma_f32_16x16x32_bf16 v[72:75], a[212:215], a[96:99], v[72:75]
    ds_read_b128 a[204:207], v224 offset:29696
    v_mfma_f32_16x16x32_bf16 v[100:103], a[212:215], a[100:103], v[100:103]
    s_waitcnt lgkmcnt(4)
    v_mfma_f32_16x16x32_bf16 v[76:79], a[184:187], a[96:99], v[76:79]
    ds_read_b128 a[208:211], v224 offset:30720
    v_mfma_f32_16x16x32_bf16 v[104:107], a[184:187], a[100:103], v[104:107]
    buffer_load_dwordx4 a[144:147], v2, s[24:27], s78 offen offset:1024 sc1
    v_mfma_f32_16x16x32_bf16 v[80:83], a[188:191], a[96:99], v[80:83]
    ds_read_b128 a[212:215], v224 offset:31744
    v_mfma_f32_16x16x32_bf16 v[108:111], a[188:191], a[100:103], v[108:111]
    s_waitcnt lgkmcnt(4)
    v_mfma_f32_16x16x32_bf16 v[84:87], a[192:195], a[96:99], v[84:87]
    ds_read_b128 a[184:187], v224 offset:32768
    v_mfma_f32_16x16x32_bf16 v[112:115], a[192:195], a[100:103], v[112:115]
    buffer_load_dwordx4 a[156:159], v2, s[24:27], s79 offen offset:2048 sc1
    v_mfma_f32_16x16x32_bf16 v[88:91], a[196:199], a[96:99], v[88:91]
    ds_read_b128 a[188:191], v224 offset:33792
    v_mfma_f32_16x16x32_bf16 v[116:119], a[196:199], a[100:103], v[116:119]
    s_waitcnt lgkmcnt(4)
    s_waitcnt vmcnt(11)
    v_mfma_f32_16x16x32_bf16 v[64:67], a[200:203], a[104:107], v[64:67]
    ds_read_b128 a[192:195], v224 offset:34816
    v_mfma_f32_16x16x32_bf16 v[92:95], a[200:203], a[108:111], v[92:95]
    v_add_f32 v200, v200, v202
    buffer_load_dwordx4 a[152:155], v2, s[24:27], s78 offen offset:2048 sc1
    v_mfma_f32_16x16x32_bf16 v[68:71], a[204:207], a[104:107], v[68:71]
    ds_read_b128 a[196:199], v224 offset:35840
    v_mfma_f32_16x16x32_bf16 v[96:99], a[204:207], a[108:111], v[96:99]
    v_add_f32 v201, v201, v203
    s_waitcnt lgkmcnt(4)
    v_mfma_f32_16x16x32_bf16 v[72:75], a[208:211], a[104:107], v[72:75]
    ds_read_b128 a[200:203], v224 offset:36864
    v_mfma_f32_16x16x32_bf16 v[100:103], a[208:211], a[108:111], v[100:103]
    v_add_f32 v204, v204, v206
    buffer_load_dwordx4 a[164:167], v2, s[24:27], s79 offen offset:3072 sc1
    v_mfma_f32_16x16x32_bf16 v[76:79], a[212:215], a[104:107], v[76:79]
    ds_read_b128 a[204:207], v224 offset:37888
    v_mfma_f32_16x16x32_bf16 v[104:107], a[212:215], a[108:111], v[104:107]
    v_add_f32 v205, v205, v207
    s_waitcnt lgkmcnt(4)
    v_mfma_f32_16x16x32_bf16 v[80:83], a[184:187], a[104:107], v[80:83]
    ds_read_b128 a[208:211], v224 offset:38912
    v_mfma_f32_16x16x32_bf16 v[108:111], a[184:187], a[108:111], v[108:111]
    v_mov_b32 v220, v200
    v_mfma_f32_16x16x32_bf16 v[84:87], a[188:191], a[104:107], v[84:87]
    ds_read_b128 a[212:215], v224 offset:39936
    v_mfma_f32_16x16x32_bf16 v[112:115], a[188:191], a[108:111], v[112:115]
    v_mov_b32 v221, v201
    buffer_load_dwordx4 a[160:163], v2, s[24:27], s78 offen offset:3072 sc1
    s_waitcnt lgkmcnt(4)
    v_mfma_f32_16x16x32_bf16 v[88:91], a[192:195], a[104:107], v[88:91]
    ds_read_b128 a[184:187], v224 offset:40960
    v_mfma_f32_16x16x32_bf16 v[116:119], a[192:195], a[108:111], v[116:119]
    v_mov_b32 v222, v204
    s_waitcnt vmcnt(12)
    v_mfma_f32_16x16x32_bf16 v[64:67], a[196:199], a[112:115], v[64:67]
    ds_read_b128 a[188:191], v224 offset:41984
    v_mfma_f32_16x16x32_bf16 v[92:95], a[196:199], a[116:119], v[92:95]
    v_mov_b32 v223, v205
    s_add_u32 s78, s78, 4096
    s_add_u32 s79, s79, 4096
    buffer_load_dwordx4 a[172:175], v2, s[24:27], s79 offen offset:0 sc1
    s_waitcnt lgkmcnt(4)
    v_mfma_f32_16x16x32_bf16 v[68:71], a[200:203], a[112:115], v[68:71]
    ds_read_b128 a[192:195], v224 offset:43008
    v_mfma_f32_16x16x32_bf16 v[96:99], a[200:203], a[116:119], v[96:99]
    v_permlane32_swap_b32 v220, v200
    v_mfma_f32_16x16x32_bf16 v[72:75], a[204:207], a[112:115], v[72:75]
    ds_read_b128 a[196:199], v224 offset:44032
    v_mfma_f32_16x16x32_bf16 v[100:103], a[204:207], a[116:119], v[100:103]
    v_permlane32_swap_b32 v221, v201
    buffer_load_dwordx4 a[168:171], v2, s[24:27], s78 offen offset:0 sc1
    s_waitcnt lgkmcnt(4)
    v_mfma_f32_16x16x32_bf16 v[76:79], a[208:211], a[112:115], v[76:79]
    ds_read_b128 a[200:203], v224 offset:45056
    v_mfma_f32_16x16x32_bf16 v[104:107], a[208:211], a[116:119], v[104:107]
    v_permlane32_swap_b32 v222, v204
    v_mfma_f32_16x16x32_bf16 v[80:83], a[212:215], a[112:115], v[80:83]
    ds_read_b128 a[204:207], v224 offset:46080
    v_mfma_f32_16x16x32_bf16 v[108:111], a[212:215], a[116:119], v[108:111]
    v_permlane32_swap_b32 v223, v205
    buffer_load_dwordx4 a[180:183], v2, s[24:27], s79 offen offset:1024 sc1
    s_waitcnt lgkmcnt(4)
    v_mfma_f32_16x16x32_bf16 v[84:87], a[184:187], a[112:115], v[84:87]
    ds_read_b128 a[208:211], v224 offset:47104
    v_mfma_f32_16x16x32_bf16 v[112:115], a[184:187], a[116:119], v[112:115]
    v_add_f32 v200, v220, v200
    v_mfma_f32_16x16x32_bf16 v[88:91], a[188:191], a[112:115], v[88:91]
    ds_read_b128 a[212:215], v224 offset:48128
    v_mfma_f32_16x16x32_bf16 v[116:119], a[188:191], a[116:119], v[116:119]
    v_add_f32 v201, v221, v201
    buffer_load_dwordx4 a[176:179], v2, s[24:27], s78 offen offset:1024 sc1
    s_waitcnt lgkmcnt(4)
    s_waitcnt vmcnt(14)
    v_mfma_f32_16x16x32_bf16 v[64:67], a[192:195], a[120:123], v[64:67]
    ds_read_b128 a[184:187], v224 offset:49152
    v_mfma_f32_16x16x32_bf16 v[92:95], a[192:195], a[124:127], v[92:95]
    v_add_f32 v204, v222, v204
    v_mfma_f32_16x16x32_bf16 v[68:71], a[196:199], a[120:123], v[68:71]
    ds_read_b128 a[188:191], v224 offset:50176
    v_mfma_f32_16x16x32_bf16 v[96:99], a[196:199], a[124:127], v[96:99]
    v_add_f32 v205, v223, v205
    s_waitcnt lgkmcnt(4)
    v_mfma_f32_16x16x32_bf16 v[72:75], a[200:203], a[120:123], v[72:75]
    ds_read_b128 a[192:195], v224 offset:51200
    v_mfma_f32_16x16x32_bf16 v[100:103], a[200:203], a[124:127], v[100:103]
    v_mov_b32 v220, v200
    s_mov_b32 s90, 0
    s_add_u32 m0, s93, 106496
    v_mfma_f32_16x16x32_bf16 v[76:79], a[204:207], a[120:123], v[76:79]
    buffer_load_dwordx4 v7, s[20:23], s90 offen lds
    ds_read_b128 a[196:199], v224 offset:52224
    v_mfma_f32_16x16x32_bf16 v[104:107], a[204:207], a[124:127], v[104:107]
    v_mov_b32 v221, v201
    s_waitcnt lgkmcnt(4)
    v_mfma_f32_16x16x32_bf16 v[80:83], a[208:211], a[120:123], v[80:83]
    ds_read_b128 a[200:203], v224 offset:53248
    v_mfma_f32_16x16x32_bf16 v[108:111], a[208:211], a[124:127], v[108:111]
    v_mov_b32 v222, v204
    s_mov_b32 s90, 28672
    s_add_u32 m0, s93, 110592
    v_mfma_f32_16x16x32_bf16 v[84:87], a[212:215], a[120:123], v[84:87]
    buffer_load_dwordx4 v7, s[20:23], s90 offen lds
    ds_read_b128 a[204:207], v224 offset:54272
    v_mfma_f32_16x16x32_bf16 v[112:115], a[212:215], a[124:127], v[112:115]
    v_mov_b32 v223, v205
    s_waitcnt lgkmcnt(4)
    v_mfma_f32_16x16x32_bf16 v[88:91], a[184:187], a[120:123], v[88:91]
    ds_read_b128 a[208:211], v224 offset:55296
    v_mfma_f32_16x16x32_bf16 v[116:119], a[184:187], a[124:127], v[116:119]
    v_permlane16_swap_b32 v220, v200
    s_mov_b32 s90, 57344
    s_add_u32 m0, s93, 114688
    s_waitcnt vmcnt(14)
    v_mfma_f32_16x16x32_bf16 v[64:67], a[188:191], a[128:131], v[64:67]
    buffer_load_dwordx4 v7, s[20:23], s90 offen lds
    ds_read_b128 a[212:215], v224 offset:56320
    v_mfma_f32_16x16x32_bf16 v[92:95], a[188:191], a[132:135], v[92:95]
    v_permlane16_swap_b32 v221, v201
    s_waitcnt lgkmcnt(4)
    v_mfma_f32_16x16x32_bf16 v[68:71], a[192:195], a[128:131], v[68:71]
    ds_read_b128 a[184:187], v224 offset:57344
    v_mfma_f32_16x16x32_bf16 v[96:99], a[192:195], a[132:135], v[96:99]
    v_permlane16_swap_b32 v222, v204
    s_mov_b32 s90, 86016
    s_add_u32 m0, s93, 118784
    v_mfma_f32_16x16x32_bf16 v[72:75], a[196:199], a[128:131], v[72:75]
    buffer_load_dwordx4 v7, s[20:23], s90 offen lds
    ds_read_b128 a[188:191], v224 offset:58368
    v_mfma_f32_16x16x32_bf16 v[100:103], a[196:199], a[132:135], v[100:103]
    v_permlane16_swap_b32 v223, v205
    s_waitcnt lgkmcnt(4)
    v_mfma_f32_16x16x32_bf16 v[76:79], a[200:203], a[128:131], v[76:79]
    ds_read_b128 a[192:195], v224 offset:59392
    v_mfma_f32_16x16x32_bf16 v[104:107], a[200:203], a[132:135], v[104:107]
    v_add_f32 v200, v220, v200
    s_mov_b32 s90, 544768
    buffer_load_dwordx4 a[0:3], v7, s[20:23], s90 offen
    v_mfma_f32_16x16x32_bf16 v[80:83], a[204:207], a[128:131], v[80:83]
    ds_read_b128 a[196:199], v224 offset:60416
    v_mfma_f32_16x16x32_bf16 v[108:111], a[204:207], a[132:135], v[108:111]
    v_add_f32 v201, v221, v201
    s_waitcnt lgkmcnt(4)
    v_mfma_f32_16x16x32_bf16 v[84:87], a[208:211], a[128:131], v[84:87]
    ds_read_b128 a[200:203], v225 offset:0
    v_mfma_f32_16x16x32_bf16 v[112:115], a[208:211], a[132:135], v[112:115]
    v_add_f32 v204, v222, v204
    v_mfma_f32_16x16x32_bf16 v[88:91], a[212:215], a[128:131], v[88:91]
    ds_read_b128 a[204:207], v225 offset:1024
    v_mfma_f32_16x16x32_bf16 v[116:119], a[212:215], a[132:135], v[116:119]
    v_add_f32 v205, v223, v205
    s_mov_b32 s90, 1347584
    buffer_load_dwordx4 a[36:39], v7, s[20:23], s90 offen
    s_waitcnt lgkmcnt(4)
    s_waitcnt vmcnt(16)
    v_mfma_f32_16x16x32_bf16 v[64:67], a[184:187], a[136:139], v[64:67]
    ds_read_b128 a[208:211], v225 offset:2048
    v_mfma_f32_16x16x32_bf16 v[92:95], a[184:187], a[140:143], v[92:95]
    v_mul_f32 v200, 0x3b124925, v200
    v_mfma_f32_16x16x32_bf16 v[68:71], a[188:191], a[136:139], v[68:71]
    ds_read_b128 a[212:215], v225 offset:3072
    v_mfma_f32_16x16x32_bf16 v[96:99], a[188:191], a[140:143], v[96:99]
    v_mul_f32 v201, 0x3b124925, v201
    s_mov_b32 s90, 573440
    buffer_load_dwordx4 a[4:7], v7, s[20:23], s90 offen
    s_waitcnt lgkmcnt(4)
    v_mfma_f32_16x16x32_bf16 v[72:75], a[192:195], a[136:139], v[72:75]
    ds_read_b128 a[184:187], v225 offset:4096
    v_mfma_f32_16x16x32_bf16 v[100:103], a[192:195], a[140:143], v[100:103]
    v_fma_f32 v201, -v200, v200, v201
    v_mfma_f32_16x16x32_bf16 v[76:79], a[196:199], a[136:139], v[76:79]
    ds_read_b128 a[188:191], v225 offset:5120
    v_mfma_f32_16x16x32_bf16 v[104:107], a[196:199], a[140:143], v[104:107]
    v_max_f32 v201, 0, v201
    s_mov_b32 s90, 1376256
    buffer_load_dwordx4 a[40:43], v7, s[20:23], s90 offen
    s_waitcnt lgkmcnt(4)
    v_mfma_f32_16x16x32_bf16 v[80:83], a[200:203], a[136:139], v[80:83]
    ds_read_b128 a[192:195], v225 offset:6144
    v_mfma_f32_16x16x32_bf16 v[108:111], a[200:203], a[140:143], v[108:111]
    v_add_f32 v220, 0x3727c5ac, v201
    v_mfma_f32_16x16x32_bf16 v[84:87], a[204:207], a[136:139], v[84:87]
    ds_read_b128 a[196:199], v225 offset:7168
    v_mfma_f32_16x16x32_bf16 v[112:115], a[204:207], a[140:143], v[112:115]
    v_rsq_f32 v212, v220
    s_mov_b32 s90, 602112
    buffer_load_dwordx4 a[8:11], v7, s[20:23], s90 offen
    s_waitcnt lgkmcnt(4)
    v_mfma_f32_16x16x32_bf16 v[88:91], a[208:211], a[136:139], v[88:91]
    ds_read_b128 a[200:203], v225 offset:8192
    v_mfma_f32_16x16x32_bf16 v[116:119], a[208:211], a[140:143], v[116:119]
    v_mul_f32 v220, v212, v212
    s_waitcnt vmcnt(17)
    v_mfma_f32_16x16x32_bf16 v[64:67], a[212:215], a[144:147], v[64:67]
    ds_read_b128 a[204:207], v225 offset:9216
    v_mfma_f32_16x16x32_bf16 v[92:95], a[212:215], a[148:151], v[92:95]
    v_mul_f32 v220, v220, v201
    s_mov_b32 s90, 1404928
    buffer_load_dwordx4 a[44:47], v7, s[20:23], s90 offen
    s_waitcnt lgkmcnt(4)
    v_mfma_f32_16x16x32_bf16 v[68:71], a[184:187], a[144:147], v[68:71]
    ds_read_b128 a[208:211], v225 offset:10240
    v_mfma_f32_16x16x32_bf16 v[96:99], a[184:187], a[148:151], v[96:99]
    v_add_f32 v220, 0x3727c5ac, v220
    v_mfma_f32_16x16x32_bf16 v[72:75], a[188:191], a[144:147], v[72:75]
    ds_read_b128 a[212:215], v225 offset:11264
    v_mfma_f32_16x16x32_bf16 v[100:103], a[188:191], a[148:151], v[100:103]
    v_rsq_f32 v220, v220
    s_waitcnt lgkmcnt(4)
    v_mfma_f32_16x16x32_bf16 v[76:79], a[192:195], a[144:147], v[76:79]
    ds_read_b128 a[184:187], v225 offset:12288
    v_mfma_f32_16x16x32_bf16 v[104:107], a[192:195], a[148:151], v[104:107]
    v_mul_f32 v212, v212, v220
    s_mov_b32 s90, 630784
    buffer_load_dwordx4 a[12:15], v7, s[20:23], s90 offen
    v_mfma_f32_16x16x32_bf16 v[80:83], a[196:199], a[144:147], v[80:83]
    ds_read_b128 a[188:191], v225 offset:13312
    v_mfma_f32_16x16x32_bf16 v[108:111], a[196:199], a[148:151], v[108:111]
    v_mul_f32 v213, v200, v212
    s_waitcnt lgkmcnt(4)
    v_mfma_f32_16x16x32_bf16 v[84:87], a[200:203], a[144:147], v[84:87]
    ds_read_b128 a[192:195], v225 offset:14336
    v_mfma_f32_16x16x32_bf16 v[112:115], a[200:203], a[148:151], v[112:115]
    v_mul_f32 v204, 0x3b124925, v204
    s_mov_b32 s90, 1433600
    buffer_load_dwordx4 a[48:51], v7, s[20:23], s90 offen
    v_mfma_f32_16x16x32_bf16 v[88:91], a[204:207], a[144:147], v[88:91]
    ds_read_b128 a[196:199], v225 offset:15360
    v_mfma_f32_16x16x32_bf16 v[116:119], a[204:207], a[148:151], v[116:119]
    v_mul_f32 v205, 0x3b124925, v205
    s_waitcnt lgkmcnt(4)
    s_waitcnt vmcnt(18)
    v_mfma_f32_16x16x32_bf16 v[64:67], a[208:211], a[152:155], v[64:67]
    ds_read_b128 a[200:203], v225 offset:16384
    v_mfma_f32_16x16x32_bf16 v[92:95], a[208:211], a[156:159], v[92:95]
    v_fma_f32 v205, -v204, v204, v205
    s_mov_b32 s90, 659456
    buffer_load_dwordx4 a[16:19], v7, s[20:23], s90 offen
    v_mfma_f32_16x16x32_bf16 v[68:71], a[212:215], a[152:155], v[68:71]
    ds_read_b128 a[204:207], v225 offset:17408
    v_mfma_f32_16x16x32_bf16 v[96:99], a[212:215], a[156:159], v[96:99]
    v_max_f32 v205, 0, v205
    s_waitcnt lgkmcnt(4)
    v_mfma_f32_16x16x32_bf16 v[72:75], a[184:187], a[152:155], v[72:75]
    ds_read_b128 a[208:211], v225 offset:18432
    v_mfma_f32_16x16x32_bf16 v[100:103], a[184:187], a[156:159], v[100:103]
    v_add_f32 v221, 0x3727c5ac, v205
    s_mov_b32 s90, 1462272
    buffer_load_dwordx4 a[52:55], v7, s[20:23], s90 offen
    v_mfma_f32_16x16x32_bf16 v[76:79], a[188:191], a[152:155], v[76:79]
    ds_read_b128 a[212:215], v225 offset:19456
    v_mfma_f32_16x16x32_bf16 v[104:107], a[188:191], a[156:159], v[104:107]
    v_rsq_f32 v214, v221
    s_waitcnt lgkmcnt(4)
    v_mfma_f32_16x16x32_bf16 v[80:83], a[192:195], a[152:155], v[80:83]
    ds_read_b128 a[184:187], v225 offset:20480
    v_mfma_f32_16x16x32_bf16 v[108:111], a[192:195], a[156:159], v[108:111]
    v_mul_f32 v221, v214, v214
    s_mov_b32 s90, 688128
    buffer_load_dwordx4 a[20:23], v7, s[20:23], s90 offen
    v_mfma_f32_16x16x32_bf16 v[84:87], a[196:199], a[152:155], v[84:87]
    ds_read_b128 a[188:191], v225 offset:21504
    v_mfma_f32_16x16x32_bf16 v[112:115], a[196:199], a[156:159], v[112:115]
    v_mul_f32 v221, v221, v205
    s_waitcnt lgkmcnt(4)
    v_mfma_f32_16x16x32_bf16 v[88:91], a[200:203], a[152:155], v[88:91]
    ds_read_b128 a[192:195], v225 offset:22528
    v_mfma_f32_16x16x32_bf16 v[116:119], a[200:203], a[156:159], v[116:119]
    v_add_f32 v221, 0x3727c5ac, v221
    s_waitcnt vmcnt(19)
    v_mfma_f32_16x16x32_bf16 v[64:67], a[204:207], a[160:163], v[64:67]
    ds_read_b128 a[196:199], v225 offset:23552
    v_mfma_f32_16x16x32_bf16 v[92:95], a[204:207], a[164:167], v[92:95]
    v_rsq_f32 v221, v221
    s_mov_b32 s90, 1490944
    buffer_load_dwordx4 a[56:59], v7, s[20:23], s90 offen
    s_waitcnt lgkmcnt(4)
    v_mfma_f32_16x16x32_bf16 v[68:71], a[208:211], a[160:163], v[68:71]
    ds_read_b128 a[200:203], v225 offset:24576
    v_mfma_f32_16x16x32_bf16 v[96:99], a[208:211], a[164:167], v[96:99]
    v_mul_f32 v214, v214, v221
    v_mfma_f32_16x16x32_bf16 v[72:75], a[212:215], a[160:163], v[72:75]
    ds_read_b128 a[204:207], v225 offset:25600
    v_mfma_f32_16x16x32_bf16 v[100:103], a[212:215], a[164:167], v[100:103]
    v_mul_f32 v215, v204, v214
    s_mov_b32 s90, 716800
    buffer_load_dwordx4 a[24:27], v7, s[20:23], s90 offen
    s_waitcnt lgkmcnt(4)
    v_mfma_f32_16x16x32_bf16 v[76:79], a[184:187], a[160:163], v[76:79]
    ds_read_b128 a[208:211], v225 offset:26624
    v_mfma_f32_16x16x32_bf16 v[104:107], a[184:187], a[164:167], v[104:107]
    v_mfma_f32_16x16x32_bf16 v[80:83], a[188:191], a[160:163], v[80:83]
    ds_read_b128 a[212:215], v225 offset:27648
    v_mfma_f32_16x16x32_bf16 v[108:111], a[188:191], a[164:167], v[108:111]
    s_mov_b32 s90, 1519616
    buffer_load_dwordx4 a[60:63], v7, s[20:23], s90 offen
    s_waitcnt lgkmcnt(4)
    v_mfma_f32_16x16x32_bf16 v[84:87], a[192:195], a[160:163], v[84:87]
    ds_read_b128 a[184:187], v225 offset:28672
    v_mfma_f32_16x16x32_bf16 v[112:115], a[192:195], a[164:167], v[112:115]
    v_mfma_f32_16x16x32_bf16 v[88:91], a[196:199], a[160:163], v[88:91]
    ds_read_b128 a[188:191], v225 offset:29696
    v_mfma_f32_16x16x32_bf16 v[116:119], a[196:199], a[164:167], v[116:119]
    s_mov_b32 s90, 745472
    buffer_load_dwordx4 a[28:31], v7, s[20:23], s90 offen
    s_waitcnt lgkmcnt(4)
    s_waitcnt vmcnt(21)
    v_mfma_f32_16x16x32_bf16 v[64:67], a[200:203], a[168:171], v[64:67]
    ds_read_b128 a[192:195], v225 offset:30720
    v_mfma_f32_16x16x32_bf16 v[92:95], a[200:203], a[172:175], v[92:95]
    v_mfma_f32_16x16x32_bf16 v[68:71], a[204:207], a[168:171], v[68:71]
    ds_read_b128 a[196:199], v225 offset:31744
    v_mfma_f32_16x16x32_bf16 v[96:99], a[204:207], a[172:175], v[96:99]
    s_mov_b32 s90, 1548288
    buffer_load_dwordx4 a[64:67], v7, s[20:23], s90 offen
    s_waitcnt lgkmcnt(4)
    v_mfma_f32_16x16x32_bf16 v[72:75], a[208:211], a[168:171], v[72:75]
    ds_read_b128 a[200:203], v225 offset:32768
    v_mfma_f32_16x16x32_bf16 v[100:103], a[208:211], a[172:175], v[100:103]
    v_mfma_f32_16x16x32_bf16 v[76:79], a[212:215], a[168:171], v[76:79]
    ds_read_b128 a[204:207], v225 offset:33792
    v_mfma_f32_16x16x32_bf16 v[104:107], a[212:215], a[172:175], v[104:107]
    s_waitcnt lgkmcnt(4)
    v_mfma_f32_16x16x32_bf16 v[80:83], a[184:187], a[168:171], v[80:83]
    ds_read_b128 a[208:211], v225 offset:34816
    v_mfma_f32_16x16x32_bf16 v[108:111], a[184:187], a[172:175], v[108:111]
    s_mov_b32 s90, 774144
    buffer_load_dwordx4 a[32:35], v7, s[20:23], s90 offen
    v_mfma_f32_16x16x32_bf16 v[84:87], a[188:191], a[168:171], v[84:87]
    ds_read_b128 a[212:215], v225 offset:35840
    v_mfma_f32_16x16x32_bf16 v[112:115], a[188:191], a[172:175], v[112:115]
    s_waitcnt lgkmcnt(4)
    v_mfma_f32_16x16x32_bf16 v[88:91], a[192:195], a[168:171], v[88:91]
    ds_read_b128 a[184:187], v225 offset:36864
    v_mfma_f32_16x16x32_bf16 v[116:119], a[192:195], a[172:175], v[116:119]
    s_mov_b32 s90, 1576960
    buffer_load_dwordx4 a[68:71], v7, s[20:23], s90 offen
    s_waitcnt vmcnt(22)
    v_mfma_f32_16x16x32_bf16 v[64:67], a[196:199], a[176:179], v[64:67]
    ds_read_b128 a[188:191], v225 offset:37888
    v_mfma_f32_16x16x32_bf16 v[92:95], a[196:199], a[180:183], v[92:95]
    s_waitcnt lgkmcnt(4)
    v_mfma_f32_16x16x32_bf16 v[68:71], a[200:203], a[176:179], v[68:71]
    v_mfma_f32_16x16x32_bf16 v[96:99], a[200:203], a[180:183], v[96:99]
    v_mfma_f32_16x16x32_bf16 v[72:75], a[204:207], a[176:179], v[72:75]
    v_mfma_f32_16x16x32_bf16 v[100:103], a[204:207], a[180:183], v[100:103]
    s_waitcnt lgkmcnt(2)
    v_mfma_f32_16x16x32_bf16 v[76:79], a[208:211], a[176:179], v[76:79]
    v_mfma_f32_16x16x32_bf16 v[104:107], a[208:211], a[180:183], v[104:107]
    v_mfma_f32_16x16x32_bf16 v[80:83], a[212:215], a[176:179], v[80:83]
    v_mfma_f32_16x16x32_bf16 v[108:111], a[212:215], a[180:183], v[108:111]
    s_waitcnt lgkmcnt(0)
    v_mfma_f32_16x16x32_bf16 v[84:87], a[184:187], a[176:179], v[84:87]
    v_mfma_f32_16x16x32_bf16 v[112:115], a[184:187], a[180:183], v[112:115]
    v_mfma_f32_16x16x32_bf16 v[88:91], a[188:191], a[176:179], v[88:91]
    v_mfma_f32_16x16x32_bf16 v[116:119], a[188:191], a[180:183], v[116:119]
    s_barrier
    ds_read_b128 v[160:163], v53 offset:384
    ds_read_b128 v[164:167], v53 offset:832
    ds_read_b128 v[168:171], v53 offset:448
    ds_read_b128 v[172:175], v53 offset:896
    s_waitcnt lgkmcnt(2)
    v_pk_fma_f32 v[176:177], v[160:161], v[212:213], v[164:165] op_sel:[0,1,0] op_sel_hi:[1,1,1] neg_lo:[0,1,0] neg_hi:[0,1,0]
    v_pk_fma_f32 v[178:179], v[162:163], v[212:213], v[166:167] op_sel:[0,1,0] op_sel_hi:[1,1,1] neg_lo:[0,1,0] neg_hi:[0,1,0]
    v_pk_fma_f32 v[180:181], v[160:161], v[214:215], v[164:165] op_sel:[0,1,0] op_sel_hi:[1,1,1] neg_lo:[0,1,0] neg_hi:[0,1,0]
    v_pk_fma_f32 v[182:183], v[162:163], v[214:215], v[166:167] op_sel:[0,1,0] op_sel_hi:[1,1,1] neg_lo:[0,1,0] neg_hi:[0,1,0]
    v_pk_fma_f32 v[176:177], v[64:65], v[212:213], v[176:177] op_sel_hi:[1,0,1]
    v_pk_fma_f32 v[178:179], v[66:67], v[212:213], v[178:179] op_sel_hi:[1,0,1]
    v_pk_fma_f32 v[180:181], v[92:93], v[214:215], v[180:181] op_sel_hi:[1,0,1]
    v_pk_fma_f32 v[182:183], v[94:95], v[214:215], v[182:183] op_sel_hi:[1,0,1]
    v_pk_mul_f32 v[184:185], v[176:177], v[176:177]
    v_pk_mul_f32 v[186:187], v[178:179], v[178:179]
    v_pk_mul_f32 v[188:189], v[180:181], v[180:181]
    v_pk_mul_f32 v[190:191], v[182:183], v[182:183]
    v_pk_fma_f32 v[184:185], v[184:185], v[62:63], v[62:63] op_sel:[0,1,0] op_sel_hi:[1,1,0]
    v_pk_fma_f32 v[186:187], v[186:187], v[62:63], v[62:63] op_sel:[0,1,0] op_sel_hi:[1,1,0]
    v_pk_fma_f32 v[188:189], v[188:189], v[62:63], v[62:63] op_sel:[0,1,0] op_sel_hi:[1,1,0]
    v_pk_fma_f32 v[190:191], v[190:191], v[62:63], v[62:63] op_sel:[0,1,0] op_sel_hi:[1,1,0]
    v_pk_mul_f32 v[184:185], v[184:185], v[176:177]
    s_mov_b32 s90, 200704
    s_add_u32 m0, s93, 6144
    v_pk_mul_f32 v[186:187], v[186:187], v[178:179]
    buffer_load_dwordx4 v7, s[20:23], s90 offen lds
    v_pk_mul_f32 v[188:189], v[188:189], v[180:181]
    v_pk_mul_f32 v[190:191], v[190:191], v[182:183]
    v_exp_f32 v184, v184
    v_exp_f32 v185, v185
    v_exp_f32 v186, v186
    v_exp_f32 v187, v187
    v_exp_f32 v188, v188
    v_exp_f32 v189, v189
    v_exp_f32 v190, v190
    v_exp_f32 v191, v191
    v_pk_add_f32 v[184:185], v[184:185], 1.0 op_sel_hi:[1,0]
    v_pk_add_f32 v[186:187], v[186:187], 1.0 op_sel_hi:[1,0]
    s_mov_b32 s90, 1003520
    s_add_u32 m0, s93, 55296
    v_pk_add_f32 v[188:189], v[188:189], 1.0 op_sel_hi:[1,0]
    buffer_load_dwordx4 v7, s[20:23], s90 offen lds
    v_pk_add_f32 v[190:191], v[190:191], 1.0 op_sel_hi:[1,0]
    v_rcp_f32 v184, v184
    v_rcp_f32 v185, v185
    v_rcp_f32 v186, v186
    v_rcp_f32 v187, v187
    v_rcp_f32 v188, v188
    v_rcp_f32 v189, v189
    v_rcp_f32 v190, v190
    v_rcp_f32 v191, v191
    v_pk_mul_f32 v[184:185], v[184:185], v[176:177]
    v_pk_mul_f32 v[186:187], v[186:187], v[178:179]
    v_pk_mul_f32 v[188:189], v[188:189], v[180:181]
    s_mov_b32 s90, 229376
    s_add_u32 m0, s93, 10240
    v_pk_mul_f32 v[190:191], v[190:191], v[182:183]
    buffer_load_dwordx4 v7, s[20:23], s90 offen lds
    v_cvt_pk_bf16_f32 v128, v184, v185
    v_cvt_pk_bf16_f32 v129, v186, v187
    v_cvt_pk_bf16_f32 v142, v188, v189
    v_cvt_pk_bf16_f32 v143, v190, v191
    ds_read_b128 v[160:163], v53 offset:512
    ds_read_b128 v[164:167], v53 offset:960
    s_waitcnt lgkmcnt(2)
    v_pk_fma_f32 v[176:177], v[168:169], v[212:213], v[172:173] op_sel:[0,1,0] op_sel_hi:[1,1,1] neg_lo:[0,1,0] neg_hi:[0,1,0]
    v_pk_fma_f32 v[178:179], v[170:171], v[212:213], v[174:175] op_sel:[0,1,0] op_sel_hi:[1,1,1] neg_lo:[0,1,0] neg_hi:[0,1,0]
    v_pk_fma_f32 v[180:181], v[168:169], v[214:215], v[172:173] op_sel:[0,1,0] op_sel_hi:[1,1,1] neg_lo:[0,1,0] neg_hi:[0,1,0]
    v_pk_fma_f32 v[182:183], v[170:171], v[214:215], v[174:175] op_sel:[0,1,0] op_sel_hi:[1,1,1] neg_lo:[0,1,0] neg_hi:[0,1,0]
    v_pk_fma_f32 v[176:177], v[68:69], v[212:213], v[176:177] op_sel_hi:[1,0,1]
    v_pk_fma_f32 v[178:179], v[70:71], v[212:213], v[178:179] op_sel_hi:[1,0,1]
    v_pk_fma_f32 v[180:181], v[96:97], v[214:215], v[180:181] op_sel_hi:[1,0,1]
    v_pk_fma_f32 v[182:183], v[98:99], v[214:215], v[182:183] op_sel_hi:[1,0,1]
    v_pk_mul_f32 v[184:185], v[176:177], v[176:177]
    v_pk_mul_f32 v[186:187], v[178:179], v[178:179]
    v_pk_mul_f32 v[188:189], v[180:181], v[180:181]
    v_pk_mul_f32 v[190:191], v[182:183], v[182:183]
    v_pk_fma_f32 v[184:185], v[184:185], v[62:63], v[62:63] op_sel:[0,1,0] op_sel_hi:[1,1,0]
    v_pk_fma_f32 v[186:187], v[186:187], v[62:63], v[62:63] op_sel:[0,1,0] op_sel_hi:[1,1,0]
    s_mov_b32 s90, 1032192
    s_add_u32 m0, s93, 59392
    v_pk_fma_f32 v[188:189], v[188:189], v[62:63], v[62:63] op_sel:[0,1,0] op_sel_hi:[1,1,0]
    buffer_load_dwordx4 v7, s[20:23], s90 offen lds
    v_pk_fma_f32 v[190:191], v[190:191], v[62:63], v[62:63] op_sel:[0,1,0] op_sel_hi:[1,1,0]
    v_pk_mul_f32 v[184:185], v[184:185], v[176:177]
    v_pk_mul_f32 v[186:187], v[186:187], v[178:179]
    v_pk_mul_f32 v[188:189], v[188:189], v[180:181]
    v_pk_mul_f32 v[190:191], v[190:191], v[182:183]
    v_exp_f32 v184, v184
    v_exp_f32 v185, v185
    v_exp_f32 v186, v186
    v_exp_f32 v187, v187
    v_exp_f32 v188, v188
    v_exp_f32 v189, v189
    v_exp_f32 v190, v190
    v_exp_f32 v191, v191
    s_mov_b32 s90, 258048
    s_add_u32 m0, s93, 14336
    v_pk_add_f32 v[184:185], v[184:185], 1.0 op_sel_hi:[1,0]
    buffer_load_dwordx4 v7, s[20:23], s90 offen lds
    v_pk_add_f32 v[186:187], v[186:187], 1.0 op_sel_hi:[1,0]
    v_pk_add_f32 v[188:189], v[188:189], 1.0 op_sel_hi:[1,0]
    v_pk_add_f32 v[190:191], v[190:191], 1.0 op_sel_hi:[1,0]
    v_rcp_f32 v184, v184
    v_rcp_f32 v185, v185
    v_rcp_f32 v186, v186
    v_rcp_f32 v187, v187
    v_rcp_f32 v188, v188
    v_rcp_f32 v189, v189
    v_rcp_f32 v190, v190
    v_rcp_f32 v191, v191
    v_pk_mul_f32 v[184:185], v[184:185], v[176:177]
    s_mov_b32 s90, 1060864
    s_add_u32 m0, s93, 63488
    v_pk_mul_f32 v[186:187], v[186:187], v[178:179]
    buffer_load_dwordx4 v7, s[20:23], s90 offen lds
    v_pk_mul_f32 v[188:189], v[188:189], v[180:181]
    v_pk_mul_f32 v[190:191], v[190:191], v[182:183]
    v_cvt_pk_bf16_f32 v130, v184, v185
    v_cvt_pk_bf16_f32 v131, v186, v187
    v_cvt_pk_bf16_f32 v144, v188, v189
    v_cvt_pk_bf16_f32 v145, v190, v191
    ds_read_b128 v[168:171], v53 offset:576
    ds_read_b128 v[172:175], v53 offset:1024
    s_waitcnt lgkmcnt(2)
    v_pk_fma_f32 v[176:177], v[160:161], v[212:213], v[164:165] op_sel:[0,1,0] op_sel_hi:[1,1,1] neg_lo:[0,1,0] neg_hi:[0,1,0]
    v_pk_fma_f32 v[178:179], v[162:163], v[212:213], v[166:167] op_sel:[0,1,0] op_sel_hi:[1,1,1] neg_lo:[0,1,0] neg_hi:[0,1,0]
    v_pk_fma_f32 v[180:181], v[160:161], v[214:215], v[164:165] op_sel:[0,1,0] op_sel_hi:[1,1,1] neg_lo:[0,1,0] neg_hi:[0,1,0]
    v_pk_fma_f32 v[182:183], v[162:163], v[214:215], v[166:167] op_sel:[0,1,0] op_sel_hi:[1,1,1] neg_lo:[0,1,0] neg_hi:[0,1,0]
    v_pk_fma_f32 v[176:177], v[72:73], v[212:213], v[176:177] op_sel_hi:[1,0,1]
    v_pk_fma_f32 v[178:179], v[74:75], v[212:213], v[178:179] op_sel_hi:[1,0,1]
    v_pk_fma_f32 v[180:181], v[100:101], v[214:215], v[180:181] op_sel_hi:[1,0,1]
    v_pk_fma_f32 v[182:183], v[102:103], v[214:215], v[182:183] op_sel_hi:[1,0,1]
    v_pk_mul_f32 v[184:185], v[176:177], v[176:177]
    v_pk_mul_f32 v[186:187], v[178:179], v[178:179]
    v_pk_mul_f32 v[188:189], v[180:181], v[180:181]
    v_pk_mul_f32 v[190:191], v[182:183], v[182:183]
    s_mov_b32 s90, 286720
    s_add_u32 m0, s93, 18432
    v_pk_fma_f32 v[184:185], v[184:185], v[62:63], v[62:63] op_sel:[0,1,0] op_sel_hi:[1,1,0]
    buffer_load_dwordx4 v7, s[20:23], s90 offen lds
    v_pk_fma_f32 v[186:187], v[186:187], v[62:63], v[62:63] op_sel:[0,1,0] op_sel_hi:[1,1,0]
    v_pk_fma_f32 v[188:189], v[188:189], v[62:63], v[62:63] op_sel:[0,1,0] op_sel_hi:[1,1,0]
    v_pk_fma_f32 v[190:191], v[190:191], v[62:63], v[62:63] op_sel:[0,1,0] op_sel_hi:[1,1,0]
    v_pk_mul_f32 v[184:185], v[184:185], v[176:177]
    v_pk_mul_f32 v[186:187], v[186:187], v[178:179]
    v_pk_mul_f32 v[188:189], v[188:189], v[180:181]
    v_pk_mul_f32 v[190:191], v[190:191], v[182:183]
    v_exp_f32 v184, v184
    v_exp_f32 v185, v185
    v_exp_f32 v186, v186
    v_exp_f32 v187, v187
    v_exp_f32 v188, v188
    v_exp_f32 v189, v189
    v_exp_f32 v190, v190
    s_mov_b32 s90, 1089536
    s_add_u32 m0, s93, 67584
    v_exp_f32 v191, v191
    buffer_load_dwordx4 v7, s[20:23], s90 offen lds
    v_pk_add_f32 v[184:185], v[184:185], 1.0 op_sel_hi:[1,0]
    v_pk_add_f32 v[186:187], v[186:187], 1.0 op_sel_hi:[1,0]
    v_pk_add_f32 v[188:189], v[188:189], 1.0 op_sel_hi:[1,0]
    v_pk_add_f32 v[190:191], v[190:191], 1.0 op_sel_hi:[1,0]
    v_rcp_f32 v184, v184
    v_rcp_f32 v185, v185
    v_rcp_f32 v186, v186
    v_rcp_f32 v187, v187
    v_rcp_f32 v188, v188
    v_rcp_f32 v189, v189
    v_rcp_f32 v190, v190
    v_rcp_f32 v191, v191
    s_mov_b32 s90, 315392
    s_add_u32 m0, s93, 22528
    v_pk_mul_f32 v[184:185], v[184:185], v[176:177]
    buffer_load_dwordx4 v7, s[20:23], s90 offen lds
    v_pk_mul_f32 v[186:187], v[186:187], v[178:179]
    v_pk_mul_f32 v[188:189], v[188:189], v[180:181]
    v_pk_mul_f32 v[190:191], v[190:191], v[182:183]
    v_cvt_pk_bf16_f32 v132, v184, v185
    v_cvt_pk_bf16_f32 v133, v186, v187
    v_cvt_pk_bf16_f32 v146, v188, v189
    v_cvt_pk_bf16_f32 v147, v190, v191
    ds_read_b128 v[160:163], v53 offset:640
    ds_read_b128 v[164:167], v53 offset:1088
    s_waitcnt lgkmcnt(2)
    v_pk_fma_f32 v[176:177], v[168:169], v[212:213], v[172:173] op_sel:[0,1,0] op_sel_hi:[1,1,1] neg_lo:[0,1,0] neg_hi:[0,1,0]
    v_pk_fma_f32 v[178:179], v[170:171], v[212:213], v[174:175] op_sel:[0,1,0] op_sel_hi:[1,1,1] neg_lo:[0,1,0] neg_hi:[0,1,0]
    v_pk_fma_f32 v[180:181], v[168:169], v[214:215], v[172:173] op_sel:[0,1,0] op_sel_hi:[1,1,1] neg_lo:[0,1,0] neg_hi:[0,1,0]
    v_pk_fma_f32 v[182:183], v[170:171], v[214:215], v[174:175] op_sel:[0,1,0] op_sel_hi:[1,1,1] neg_lo:[0,1,0] neg_hi:[0,1,0]
    v_pk_fma_f32 v[176:177], v[76:77], v[212:213], v[176:177] op_sel_hi:[1,0,1]
    v_pk_fma_f32 v[178:179], v[78:79], v[212:213], v[178:179] op_sel_hi:[1,0,1]
    v_pk_fma_f32 v[180:181], v[104:105], v[214:215], v[180:181] op_sel_hi:[1,0,1]
    v_pk_fma_f32 v[182:183], v[106:107], v[214:215], v[182:183] op_sel_hi:[1,0,1]
    v_pk_mul_f32 v[184:185], v[176:177], v[176:177]
    v_pk_mul_f32 v[186:187], v[178:179], v[178:179]
    v_pk_mul_f32 v[188:189], v[180:181], v[180:181]
    s_mov_b32 s90, 1118208
    s_add_u32 m0, s93, 71680
    v_pk_mul_f32 v[190:191], v[182:183], v[182:183]
    buffer_load_dwordx4 v7, s[20:23], s90 offen lds
    v_pk_fma_f32 v[184:185], v[184:185], v[62:63], v[62:63] op_sel:[0,1,0] op_sel_hi:[1,1,0]
    v_pk_fma_f32 v[186:187], v[186:187], v[62:63], v[62:63] op_sel:[0,1,0] op_sel_hi:[1,1,0]
    v_pk_fma_f32 v[188:189], v[188:189], v[62:63], v[62:63] op_sel:[0,1,0] op_sel_hi:[1,1,0]
    v_pk_fma_f32 v[190:191], v[190:191], v[62:63], v[62:63] op_sel:[0,1,0] op_sel_hi:[1,1,0]
    v_pk_mul_f32 v[184:185], v[184:185], v[176:177]
    v_pk_mul_f32 v[186:187], v[186:187], v[178:179]
    v_pk_mul_f32 v[188:189], v[188:189], v[180:181]
    v_pk_mul_f32 v[190:191], v[190:191], v[182:183]
    v_exp_f32 v184, v184
    v_exp_f32 v185, v185
    v_exp_f32 v186, v186
    v_exp_f32 v187, v187
    v_exp_f32 v188, v188
    v_exp_f32 v189, v189
    s_mov_b32 s90, 344064
    s_add_u32 m0, s93, 26624
    v_exp_f32 v190, v190
    buffer_load_dwordx4 v7, s[20:23], s90 offen lds
    v_exp_f32 v191, v191
    v_pk_add_f32 v[184:185], v[184:185], 1.0 op_sel_hi:[1,0]
    v_pk_add_f32 v[186:187], v[186:187], 1.0 op_sel_hi:[1,0]
    v_pk_add_f32 v[188:189], v[188:189], 1.0 op_sel_hi:[1,0]
    v_pk_add_f32 v[190:191], v[190:191], 1.0 op_sel_hi:[1,0]
    v_rcp_f32 v184, v184
    v_rcp_f32 v185, v185
    v_rcp_f32 v186, v186
    v_rcp_f32 v187, v187
    v_rcp_f32 v188, v188
    v_rcp_f32 v189, v189
    v_rcp_f32 v190, v190
    s_mov_b32 s90, 1146880
    s_add_u32 m0, s93, 75776
    v_rcp_f32 v191, v191
    buffer_load_dwordx4 v7, s[20:23], s90 offen lds
    v_pk_mul_f32 v[184:185], v[184:185], v[176:177]
    v_pk_mul_f32 v[186:187], v[186:187], v[178:179]
    v_pk_mul_f32 v[188:189], v[188:189], v[180:181]
    v_pk_mul_f32 v[190:191], v[190:191], v[182:183]
    v_cvt_pk_bf16_f32 v134, v184, v185
    v_cvt_pk_bf16_f32 v135, v186, v187
    v_cvt_pk_bf16_f32 v148, v188, v189
    v_cvt_pk_bf16_f32 v149, v190, v191
    ds_read_b128 v[168:171], v53 offset:704
    ds_read_b128 v[172:175], v53 offset:1152
    s_waitcnt lgkmcnt(2)
    v_pk_fma_f32 v[176:177], v[160:161], v[212:213], v[164:165] op_sel:[0,1,0] op_sel_hi:[1,1,1] neg_lo:[0,1,0] neg_hi:[0,1,0]
    v_pk_fma_f32 v[178:179], v[162:163], v[212:213], v[166:167] op_sel:[0,1,0] op_sel_hi:[1,1,1] neg_lo:[0,1,0] neg_hi:[0,1,0]
    v_pk_fma_f32 v[180:181], v[160:161], v[214:215], v[164:165] op_sel:[0,1,0] op_sel_hi:[1,1,1] neg_lo:[0,1,0] neg_hi:[0,1,0]
    v_pk_fma_f32 v[182:183], v[162:163], v[214:215], v[166:167] op_sel:[0,1,0] op_sel_hi:[1,1,1] neg_lo:[0,1,0] neg_hi:[0,1,0]
    v_pk_fma_f32 v[176:177], v[80:81], v[212:213], v[176:177] op_sel_hi:[1,0,1]
    v_pk_fma_f32 v[178:179], v[82:83], v[212:213], v[178:179] op_sel_hi:[1,0,1]
    v_pk_fma_f32 v[180:181], v[108:109], v[214:215], v[180:181] op_sel_hi:[1,0,1]
    v_pk_fma_f32 v[182:183], v[110:111], v[214:215], v[182:183] op_sel_hi:[1,0,1]
    v_pk_mul_f32 v[184:185], v[176:177], v[176:177]
    s_mov_b32 s90, 372736
    s_add_u32 m0, s93, 30720
    v_pk_mul_f32 v[186:187], v[178:179], v[178:179]
    buffer_load_dwordx4 v7, s[20:23], s90 offen lds
    v_pk_mul_f32 v[188:189], v[180:181], v[180:181]
    v_pk_mul_f32 v[190:191], v[182:183], v[182:183]
    v_pk_fma_f32 v[184:185], v[184:185], v[62:63], v[62:63] op_sel:[0,1,0] op_sel_hi:[1,1,0]
    v_pk_fma_f32 v[186:187], v[186:187], v[62:63], v[62:63] op_sel:[0,1,0] op_sel_hi:[1,1,0]
    v_pk_fma_f32 v[188:189], v[188:189], v[62:63], v[62:63] op_sel:[0,1,0] op_sel_hi:[1,1,0]
    v_pk_fma_f32 v[190:191], v[190:191], v[62:63], v[62:63] op_sel:[0,1,0] op_sel_hi:[1,1,0]
    v_pk_mul_f32 v[184:185], v[184:185], v[176:177]
    v_pk_mul_f32 v[186:187], v[186:187], v[178:179]
    v_pk_mul_f32 v[188:189], v[188:189], v[180:181]
    v_pk_mul_f32 v[190:191], v[190:191], v[182:183]
    v_exp_f32 v184, v184
    v_exp_f32 v185, v185
    v_exp_f32 v186, v186
    v_exp_f32 v187, v187
    v_exp_f32 v188, v188
    s_mov_b32 s90, 1175552
    s_add_u32 m0, s93, 79872
    v_exp_f32 v189, v189
    buffer_load_dwordx4 v7, s[20:23], s90 offen lds
    v_exp_f32 v190, v190
    v_exp_f32 v191, v191
    v_pk_add_f32 v[184:185], v[184:185], 1.0 op_sel_hi:[1,0]
    v_pk_add_f32 v[186:187], v[186:187], 1.0 op_sel_hi:[1,0]
    v_pk_add_f32 v[188:189], v[188:189], 1.0 op_sel_hi:[1,0]
    v_pk_add_f32 v[190:191], v[190:191], 1.0 op_sel_hi:[1,0]
    v_rcp_f32 v184, v184
    v_rcp_f32 v185, v185
    v_rcp_f32 v186, v186
    v_rcp_f32 v187, v187
    v_rcp_f32 v188, v188
    v_rcp_f32 v189, v189
    s_mov_b32 s90, 401408
    s_add_u32 m0, s93, 34816
    v_rcp_f32 v190, v190
    buffer_load_dwordx4 v7, s[20:23], s90 offen lds
    v_rcp_f32 v191, v191
    v_pk_mul_f32 v[184:185], v[184:185], v[176:177]
    v_pk_mul_f32 v[186:187], v[186:187], v[178:179]
    v_pk_mul_f32 v[188:189], v[188:189], v[180:181]
    v_pk_mul_f32 v[190:191], v[190:191], v[182:183]
    v_cvt_pk_bf16_f32 v136, v184, v185
    v_cvt_pk_bf16_f32 v137, v186, v187
    v_cvt_pk_bf16_f32 v150, v188, v189
    v_cvt_pk_bf16_f32 v151, v190, v191
    ds_read_b128 v[160:163], v53 offset:768
    ds_read_b128 v[164:167], v53 offset:1216
    s_waitcnt lgkmcnt(2)
    v_pk_fma_f32 v[176:177], v[168:169], v[212:213], v[172:173] op_sel:[0,1,0] op_sel_hi:[1,1,1] neg_lo:[0,1,0] neg_hi:[0,1,0]
    v_pk_fma_f32 v[178:179], v[170:171], v[212:213], v[174:175] op_sel:[0,1,0] op_sel_hi:[1,1,1] neg_lo:[0,1,0] neg_hi:[0,1,0]
    v_pk_fma_f32 v[180:181], v[168:169], v[214:215], v[172:173] op_sel:[0,1,0] op_sel_hi:[1,1,1] neg_lo:[0,1,0] neg_hi:[0,1,0]
    v_pk_fma_f32 v[182:183], v[170:171], v[214:215], v[174:175] op_sel:[0,1,0] op_sel_hi:[1,1,1] neg_lo:[0,1,0] neg_hi:[0,1,0]
    v_pk_fma_f32 v[176:177], v[84:85], v[212:213], v[176:177] op_sel_hi:[1,0,1]
    v_pk_fma_f32 v[178:179], v[86:87], v[212:213], v[178:179] op_sel_hi:[1,0,1]
    v_pk_fma_f32 v[180:181], v[112:113], v[214:215], v[180:181] op_sel_hi:[1,0,1]
    s_mov_b32 s90, 1204224
    s_add_u32 m0, s93, 83968
    v_pk_fma_f32 v[182:183], v[114:115], v[214:215], v[182:183] op_sel_hi:[1,0,1]
    buffer_load_dwordx4 v7, s[20:23], s90 offen lds
    v_pk_mul_f32 v[184:185], v[176:177], v[176:177]
    v_pk_mul_f32 v[186:187], v[178:179], v[178:179]
    v_pk_mul_f32 v[188:189], v[180:181], v[180:181]
    v_pk_mul_f32 v[190:191], v[182:183], v[182:183]
    v_pk_fma_f32 v[184:185], v[184:185], v[62:63], v[62:63] op_sel:[0,1,0] op_sel_hi:[1,1,0]
    v_pk_fma_f32 v[186:187], v[186:187], v[62:63], v[62:63] op_sel:[0,1,0] op_sel_hi:[1,1,0]
    v_pk_fma_f32 v[188:189], v[188:189], v[62:63], v[62:63] op_sel:[0,1,0] op_sel_hi:[1,1,0]
    v_pk_fma_f32 v[190:191], v[190:191], v[62:63], v[62:63] op_sel:[0,1,0] op_sel_hi:[1,1,0]
    v_pk_mul_f32 v[184:185], v[184:185], v[176:177]
    v_pk_mul_f32 v[186:187], v[186:187], v[178:179]
    v_pk_mul_f32 v[188:189], v[188:189], v[180:181]
    v_pk_mul_f32 v[190:191], v[190:191], v[182:183]
    v_exp_f32 v184, v184
    v_exp_f32 v185, v185
    v_exp_f32 v186, v186
    v_exp_f32 v187, v187
    s_mov_b32 s90, 430080
    s_add_u32 m0, s93, 38912
    v_exp_f32 v188, v188
    buffer_load_dwordx4 v7, s[20:23], s90 offen lds
    v_exp_f32 v189, v189
    v_exp_f32 v190, v190
    v_exp_f32 v191, v191
    v_pk_add_f32 v[184:185], v[184:185], 1.0 op_sel_hi:[1,0]
    v_pk_add_f32 v[186:187], v[186:187], 1.0 op_sel_hi:[1,0]
    v_pk_add_f32 v[188:189], v[188:189], 1.0 op_sel_hi:[1,0]
    v_pk_add_f32 v[190:191], v[190:191], 1.0 op_sel_hi:[1,0]
    v_rcp_f32 v184, v184
    v_rcp_f32 v185, v185
    v_rcp_f32 v186, v186
    v_rcp_f32 v187, v187
    v_rcp_f32 v188, v188
    s_mov_b32 s90, 1232896
    s_add_u32 m0, s93, 88064
    v_rcp_f32 v189, v189
    buffer_load_dwordx4 v7, s[20:23], s90 offen lds
    v_rcp_f32 v190, v190
    v_rcp_f32 v191, v191
    v_pk_mul_f32 v[184:185], v[184:185], v[176:177]
    v_pk_mul_f32 v[186:187], v[186:187], v[178:179]
    v_pk_mul_f32 v[188:189], v[188:189], v[180:181]
    v_pk_mul_f32 v[190:191], v[190:191], v[182:183]
    v_cvt_pk_bf16_f32 v138, v184, v185
    v_cvt_pk_bf16_f32 v139, v186, v187
    v_cvt_pk_bf16_f32 v152, v188, v189
    v_cvt_pk_bf16_f32 v153, v190, v191
    s_waitcnt lgkmcnt(0)
    v_pk_fma_f32 v[176:177], v[160:161], v[212:213], v[164:165] op_sel:[0,1,0] op_sel_hi:[1,1,1] neg_lo:[0,1,0] neg_hi:[0,1,0]
    v_pk_fma_f32 v[178:179], v[162:163], v[212:213], v[166:167] op_sel:[0,1,0] op_sel_hi:[1,1,1] neg_lo:[0,1,0] neg_hi:[0,1,0]
    v_pk_fma_f32 v[180:181], v[160:161], v[214:215], v[164:165] op_sel:[0,1,0] op_sel_hi:[1,1,1] neg_lo:[0,1,0] neg_hi:[0,1,0]
    v_pk_fma_f32 v[182:183], v[162:163], v[214:215], v[166:167] op_sel:[0,1,0] op_sel_hi:[1,1,1] neg_lo:[0,1,0] neg_hi:[0,1,0]
    v_pk_fma_f32 v[176:177], v[88:89], v[212:213], v[176:177] op_sel_hi:[1,0,1]
    v_pk_fma_f32 v[178:179], v[90:91], v[212:213], v[178:179] op_sel_hi:[1,0,1]
    v_pk_fma_f32 v[180:181], v[116:117], v[214:215], v[180:181] op_sel_hi:[1,0,1]
    v_pk_fma_f32 v[182:183], v[118:119], v[214:215], v[182:183] op_sel_hi:[1,0,1]
    v_pk_mul_f32 v[184:185], v[176:177], v[176:177]
    v_pk_mul_f32 v[186:187], v[178:179], v[178:179]
    v_pk_mul_f32 v[188:189], v[180:181], v[180:181]
    v_pk_mul_f32 v[190:191], v[182:183], v[182:183]
    v_pk_fma_f32 v[184:185], v[184:185], v[62:63], v[62:63] op_sel:[0,1,0] op_sel_hi:[1,1,0]
    v_pk_fma_f32 v[186:187], v[186:187], v[62:63], v[62:63] op_sel:[0,1,0] op_sel_hi:[1,1,0]
    v_pk_fma_f32 v[188:189], v[188:189], v[62:63], v[62:63] op_sel:[0,1,0] op_sel_hi:[1,1,0]
    v_pk_fma_f32 v[190:191], v[190:191], v[62:63], v[62:63] op_sel:[0,1,0] op_sel_hi:[1,1,0]
    v_pk_mul_f32 v[184:185], v[184:185], v[176:177]
    v_pk_mul_f32 v[186:187], v[186:187], v[178:179]
    v_pk_mul_f32 v[188:189], v[188:189], v[180:181]
    v_pk_mul_f32 v[190:191], v[190:191], v[182:183]
    v_exp_f32 v184, v184
    v_exp_f32 v185, v185
    v_exp_f32 v186, v186
    v_exp_f32 v187, v187
    v_exp_f32 v188, v188
    v_exp_f32 v189, v189
    v_exp_f32 v190, v190
    v_exp_f32 v191, v191
    v_pk_add_f32 v[184:185], v[184:185], 1.0 op_sel_hi:[1,0]
    v_pk_add_f32 v[186:187], v[186:187], 1.0 op_sel_hi:[1,0]
    v_pk_add_f32 v[188:189], v[188:189], 1.0 op_sel_hi:[1,0]
    v_pk_add_f32 v[190:191], v[190:191], 1.0 op_sel_hi:[1,0]
    v_rcp_f32 v184, v184
    v_rcp_f32 v185, v185
    v_rcp_f32 v186, v186
    v_rcp_f32 v187, v187
    v_rcp_f32 v188, v188
    v_rcp_f32 v189, v189
    v_rcp_f32 v190, v190
    v_rcp_f32 v191, v191
    v_pk_mul_f32 v[184:185], v[184:185], v[176:177]
    v_pk_mul_f32 v[186:187], v[186:187], v[178:179]
    v_pk_mul_f32 v[188:189], v[188:189], v[180:181]
    v_pk_mul_f32 v[190:191], v[190:191], v[182:183]
    v_cvt_pk_bf16_f32 v140, v184, v185
    v_cvt_pk_bf16_f32 v141, v186, v187
    v_cvt_pk_bf16_f32 v154, v188, v189
    v_cvt_pk_bf16_f32 v155, v190, v191
    s_bitcmp1_b32 s41, 0
    s_cbranch_scc1 L_h_odd_90
    s_cmp_eq_u32 s44, 0
    s_cbranch_scc1 L_st_slow_92
    buffer_store_dwordx4 v[128:131], v2, s[24:27], s82 offen offset:0
    buffer_store_dwordx4 v[132:135], v2, s[24:27], s82 offen offset:1024
    buffer_store_dwordx4 v[136:139], v2, s[24:27], s82 offen offset:2048
    buffer_store_dwordx2 v[140:141], v2, s[24:27], s82 offen offset:3072
    buffer_store_dwordx4 v[142:145], v2, s[24:27], s83 offen offset:0
    buffer_store_dwordx4 v[146:149], v2, s[24:27], s83 offen offset:1024
    buffer_store_dwordx4 v[150:153], v2, s[24:27], s83 offen offset:2048
    buffer_store_dwordx2 v[154:155], v2, s[24:27], s83 offen offset:3072
    s_branch L_st_done_93
L_st_slow_92:
    buffer_store_dwordx4 v[128:131], v2, s[24:27], s82 offen offset:0 sc1
    buffer_store_dwordx4 v[132:135], v2, s[24:27], s82 offen offset:1024 sc1
    buffer_store_dwordx4 v[136:139], v2, s[24:27], s82 offen offset:2048 sc1
    buffer_store_dwordx2 v[140:141], v2, s[24:27], s82 offen offset:3072 sc1
    buffer_store_dwordx4 v[142:145], v2, s[24:27], s83 offen offset:0 sc1
    buffer_store_dwordx4 v[146:149], v2, s[24:27], s83 offen offset:1024 sc1
    buffer_store_dwordx4 v[150:153], v2, s[24:27], s83 offen offset:2048 sc1
    buffer_store_dwordx2 v[154:155], v2, s[24:27], s83 offen offset:3072 sc1
L_st_done_93:
    s_branch L_h_done_91
L_h_odd_90:
    s_cmp_eq_u32 s44, 0
    s_cbranch_scc1 L_st_slow_94
    buffer_store_dwordx2 v[128:129], v2, s[24:27], s82 offen offset:8
    buffer_store_dwordx4 v[130:133], v2, s[24:27], s82 offen offset:1024
    buffer_store_dwordx4 v[134:137], v2, s[24:27], s82 offen offset:2048
    buffer_store_dwordx4 v[138:141], v2, s[24:27], s82 offen offset:3072
    buffer_store_dwordx2 v[142:143], v2, s[24:27], s83 offen offset:8
    buffer_store_dwordx4 v[144:147], v2, s[24:27], s83 offen offset:1024
    buffer_store_dwordx4 v[148:151], v2, s[24:27], s83 offen offset:2048
    buffer_store_dwordx4 v[152:155], v2, s[24:27], s83 offen offset:3072
    s_branch L_st_done_95
L_st_slow_94:
    buffer_store_dwordx2 v[128:129], v2, s[24:27], s82 offen offset:8 sc1
    buffer_store_dwordx4 v[130:133], v2, s[24:27], s82 offen offset:1024 sc1
    buffer_store_dwordx4 v[134:137], v2, s[24:27], s82 offen offset:2048 sc1
    buffer_store_dwordx4 v[138:141], v2, s[24:27], s82 offen offset:3072 sc1
    buffer_store_dwordx2 v[142:143], v2, s[24:27], s83 offen offset:8 sc1
    buffer_store_dwordx4 v[144:147], v2, s[24:27], s83 offen offset:1024 sc1
    buffer_store_dwordx4 v[148:151], v2, s[24:27], s83 offen offset:2048 sc1
    buffer_store_dwordx4 v[152:155], v2, s[24:27], s83 offen offset:3072 sc1
L_st_done_95:
L_h_done_91:
    s_add_u32 s45, s45, 1
    v_mov_b32 v254, s45
    v_mov_b32 v255, 0
    s_waitcnt vmcnt(0)
    s_mov_b64 exec, 1
    s_cmp_eq_u32 s44, 0
    s_cbranch_scc1 L_sig_slow_96
    buffer_store_dword v254, v255, s[24:27], s94 offen
    s_branch L_sig_done_97
L_sig_slow_96:
    buffer_store_dword v254, v255, s[24:27], s94 offen sc1
L_sig_done_97:
    s_mov_b64 exec, -1
    s_mov_b32 s90, 458752
    s_add_u32 m0, s93, 43008
    s_nop 0
    buffer_load_dwordx4 v7, s[20:23], s90 offen lds
    s_mov_b32 s90, 1261568
    s_add_u32 m0, s93, 92160
    s_nop 0
    buffer_load_dwordx4 v7, s[20:23], s90 offen lds
    s_mov_b32 s90, 487424
    s_add_u32 m0, s93, 47104
    s_nop 0
    buffer_load_dwordx4 v7, s[20:23], s90 offen lds
    s_mov_b32 s90, 1290240
    s_add_u32 m0, s93, 96256
    s_nop 0
    buffer_load_dwordx4 v7, s[20:23], s90 offen lds
    s_mov_b32 s90, 516096
    s_add_u32 m0, s93, 51200
    s_nop 0
    buffer_load_dwordx4 v7, s[20:23], s90 offen lds
    s_mov_b32 s90, 1318912
    s_add_u32 m0, s93, 100352
    s_nop 0
    buffer_load_dwordx4 v7, s[20:23], s90 offen lds
    s_xor_b32 s79, s0, 1
    s_mul_i32 s78, s0, 57344
    s_mul_i32 s79, s79, 57344
    s_mul_i32 s81, s49, 28672
    s_add_u32 s81, s81, 4194304
    s_add_u32 s78, s78, s81
    s_add_u32 s79, s79, s81
    s_mul_i32 s82, s0, 14
    s_add_u32 s82, s82, s71
    s_lshl_b32 s82, s82, 10
    s_lshl_b32 s83, s0, 10
    s_lshl_b32 s84, s47, 3
    s_add_u32 s83, s83, s84
    s_add_u32 s72, s82, 2097152
    s_mov_b32 s96, 0
L_poll_100:
    buffer_load_dword v254, v3, s[24:27], s70 offen sc1
    s_add_u32 s96, s96, 1
    s_cmp_gt_u32 s96, 200000
    s_cbranch_scc1 L_end
    s_waitcnt vmcnt(0)
    v_cmp_gt_u32 vcc, s45, v254
    s_nop 3
    s_and_b64 vcc, vcc, s[68:69]
    s_cbranch_vccnz L_poll_100
    s_cmp_eq_u32 s66, 0
    s_cbranch_scc1 L_w2_idle_98
    buffer_load_dwordx4 v[100:103], v2, s[24:27], s79 offen offset:0 sc1
    buffer_load_dwordx4 v[96:99], v2, s[24:27], s78 offen offset:0 sc1
    buffer_load_dwordx4 v[108:111], v2, s[24:27], s79 offen offset:1024 sc1
    buffer_load_dwordx4 v[104:107], v2, s[24:27], s78 offen offset:1024 sc1
    buffer_load_dwordx4 v[116:119], v2, s[24:27], s79 offen offset:2048 sc1
    buffer_load_dwordx4 v[112:115], v2, s[24:27], s78 offen offset:2048 sc1
    buffer_load_dwordx4 v[124:127], v2, s[24:27], s79 offen offset:3072 sc1
    buffer_load_dwordx4 v[120:123], v2, s[24:27], s78 offen offset:3072 sc1
    s_add_u32 s78, s78, 4096
    s_add_u32 s79, s79, 4096
    buffer_load_dwordx4 v[132:135], v2, s[24:27], s79 offen offset:0 sc1
    buffer_load_dwordx4 v[128:131], v2, s[24:27], s78 offen offset:0 sc1
    s_barrier
    s_add_u32 s73, s93, 106496
    v_add_u32 v192, s73, v2
    s_add_u32 s73, s93, 6144
    v_add_u32 v193, s73, v2
    ds_read_b64_tr_b16 v[208:209], v8 offset:0
    ds_read_b64_tr_b16 v[210:211], v8 offset:2048
    ds_read_b64_tr_b16 v[212:213], v9 offset:0
    ds_read_b64_tr_b16 v[214:215], v9 offset:2048
    ds_read_b64_tr_b16 v[216:217], v10 offset:0
    ds_read_b64_tr_b16 v[218:219], v10 offset:2048
    ds_read_b64_tr_b16 v[220:221], v11 offset:0
    ds_read_b64_tr_b16 v[222:223], v11 offset:2048
    ds_read_b64_tr_b16 v[224:225], v8 offset:4096
    ds_read_b64_tr_b16 v[226:227], v8 offset:6144
    ds_read_b64_tr_b16 v[228:229], v9 offset:4096
    ds_read_b64_tr_b16 v[230:231], v9 offset:6144
    s_waitcnt lgkmcnt(8)
    s_waitcnt vmcnt(8)
    v_mfma_f32_16x16x32_bf16 v[64:67], v[208:211], v[96:99], 0
    ds_read_b64_tr_b16 v[232:233], v10 offset:4096
    v_mfma_f32_16x16x32_bf16 v[80:83], v[208:211], v[100:103], 0
    ds_read_b64_tr_b16 v[234:235], v10 offset:6144
    buffer_load_dwordx4 v[140:143], v2, s[24:27], s79 offen offset:1024 sc1
    v_mfma_f32_16x16x32_bf16 v[68:71], v[212:215], v[96:99], 0
    ds_read_b64_tr_b16 v[236:237], v11 offset:4096
    v_mfma_f32_16x16x32_bf16 v[84:87], v[212:215], v[100:103], 0
    ds_read_b64_tr_b16 v[238:239], v11 offset:6144
    s_waitcnt lgkmcnt(8)
    v_mfma_f32_16x16x32_bf16 v[72:75], v[216:219], v[96:99], 0
    ds_read_b64_tr_b16 v[208:209], v8 offset:8192
    v_mfma_f32_16x16x32_bf16 v[88:91], v[216:219], v[100:103], 0
    ds_read_b64_tr_b16 v[210:211], v8 offset:10240
    buffer_load_dwordx4 v[136:139], v2, s[24:27], s78 offen offset:1024 sc1
    v_mfma_f32_16x16x32_bf16 v[76:79], v[220:223], v[96:99], 0
    ds_read_b64_tr_b16 v[212:213], v9 offset:8192
    v_mfma_f32_16x16x32_bf16 v[92:95], v[220:223], v[100:103], 0
    ds_read_b64_tr_b16 v[214:215], v9 offset:10240
    s_waitcnt lgkmcnt(8)
    s_waitcnt vmcnt(8)
    v_mfma_f32_16x16x32_bf16 v[64:67], v[224:227], v[104:107], v[64:67]
    ds_read_b64_tr_b16 v[216:217], v10 offset:8192
    v_mfma_f32_16x16x32_bf16 v[80:83], v[224:227], v[108:111], v[80:83]
    ds_read_b64_tr_b16 v[218:219], v10 offset:10240
    buffer_load_dwordx4 v[148:151], v2, s[24:27], s79 offen offset:2048 sc1
    v_mfma_f32_16x16x32_bf16 v[68:71], v[228:231], v[104:107], v[68:71]
    ds_read_b64_tr_b16 v[220:221], v11 offset:8192
    v_mfma_f32_16x16x32_bf16 v[84:87], v[228:231], v[108:111], v[84:87]
    ds_read_b64_tr_b16 v[222:223], v11 offset:10240
    s_waitcnt lgkmcnt(8)
    v_mfma_f32_16x16x32_bf16 v[72:75], v[232:235], v[104:107], v[72:75]
    ds_read_b64_tr_b16 v[224:225], v8 offset:12288
    v_mfma_f32_16x16x32_bf16 v[88:91], v[232:235], v[108:111], v[88:91]
    ds_read_b64_tr_b16 v[226:227], v8 offset:14336
    buffer_load_dwordx4 v[144:147], v2, s[24:27], s78 offen offset:2048 sc1
    v_mfma_f32_16x16x32_bf16 v[76:79], v[236:239], v[104:107], v[76:79]
    ds_read_b64_tr_b16 v[228:229], v9 offset:12288
    v_mfma_f32_16x16x32_bf16 v[92:95], v[236:239], v[108:111], v[92:95]
    ds_read_b64_tr_b16 v[230:231], v9 offset:14336
    s_waitcnt lgkmcnt(8)
    s_waitcnt vmcnt(8)
    v_mfma_f32_16x16x32_bf16 v[64:67], v[208:211], v[112:115], v[64:67]
    ds_read_b64_tr_b16 v[232:233], v10 offset:12288
    v_mfma_f32_16x16x32_bf16 v[80:83], v[208:211], v[116:119], v[80:83]
    ds_read_b64_tr_b16 v[234:235], v10 offset:14336
    buffer_load_dwordx4 v[156:159], v2, s[24:27], s79 offen offset:3072 sc1
    v_mfma_f32_16x16x32_bf16 v[68:71], v[212:215], v[112:115], v[68:71]
    ds_read_b64_tr_b16 v[236:237], v11 offset:12288
    v_mfma_f32_16x16x32_bf16 v[84:87], v[212:215], v[116:119], v[84:87]
    ds_read_b64_tr_b16 v[238:239], v11 offset:14336
    s_waitcnt lgkmcnt(8)
    v_mfma_f32_16x16x32_bf16 v[72:75], v[216:219], v[112:115], v[72:75]
    ds_read_b64_tr_b16 v[208:209], v8 offset:16384
    v_mfma_f32_16x16x32_bf16 v[88:91], v[216:219], v[116:119], v[88:91]
    ds_read_b64_tr_b16 v[210:211], v8 offset:18432
    buffer_load_dwordx4 v[152:155], v2, s[24:27], s78 offen offset:3072 sc1
    v_mfma_f32_16x16x32_bf16 v[76:79], v[220:223], v[112:115], v[76:79]
    ds_read_b64_tr_b16 v[212:213], v9 offset:16384
    v_mfma_f32_16x16x32_bf16 v[92:95], v[220:223], v[116:119], v[92:95]
    ds_read_b64_tr_b16 v[214:215], v9 offset:18432
    s_waitcnt lgkmcnt(8)
    s_waitcnt vmcnt(8)
    v_mfma_f32_16x16x32_bf16 v[64:67], v[224:227], v[120:123], v[64:67]
    ds_read_b64_tr_b16 v[216:217], v10 offset:16384
    v_mfma_f32_16x16x32_bf16 v[80:83], v[224:227], v[124:127], v[80:83]
    ds_read_b64_tr_b16 v[218:219], v10 offset:18432
    s_add_u32 s78, s78, 4096
    s_add_u32 s79, s79, 4096
    buffer_load_dwordx4 v[164:167], v2, s[24:27], s79 offen offset:0 sc1
    v_mfma_f32_16x16x32_bf16 v[68:71], v[228:231], v[120:123], v[68:71]
    ds_read_b64_tr_b16 v[220:221], v11 offset:16384
    v_mfma_f32_16x16x32_bf16 v[84:87], v[228:231], v[124:127], v[84:87]
    ds_read_b64_tr_b16 v[222:223], v11 offset:18432
    s_waitcnt lgkmcnt(8)
    v_mfma_f32_16x16x32_bf16 v[72:75], v[232:235], v[120:123], v[72:75]
    ds_read_b64_tr_b16 v[224:225], v8 offset:20480
    v_mfma_f32_16x16x32_bf16 v[88:91], v[232:235], v[124:127], v[88:91]
    ds_read_b64_tr_b16 v[226:227], v8 offset:22528
    buffer_load_dwordx4 v[160:163], v2, s[24:27], s78 offen offset:0 sc1
    v_mfma_f32_16x16x32_bf16 v[76:79], v[236:239], v[120:123], v[76:79]
    ds_read_b64_tr_b16 v[228:229], v9 offset:20480
    v_mfma_f32_16x16x32_bf16 v[92:95], v[236:239], v[124:127], v[92:95]
    ds_read_b64_tr_b16 v[230:231], v9 offset:22528
    s_waitcnt lgkmcnt(8)
    s_waitcnt vmcnt(8)
    v_mfma_f32_16x16x32_bf16 v[64:67], v[208:211], v[128:131], v[64:67]
    ds_read_b64_tr_b16 v[232:233], v10 offset:20480
    v_mfma_f32_16x16x32_bf16 v[80:83], v[208:211], v[132:135], v[80:83]
    ds_read_b64_tr_b16 v[234:235], v10 offset:22528
    buffer_load_dwordx4 v[172:175], v2, s[24:27], s79 offen offset:1024 sc1
    v_mfma_f32_16x16x32_bf16 v[68:71], v[212:215], v[128:131], v[68:71]
    ds_read_b64_tr_b16 v[236:237], v11 offset:20480
    v_mfma_f32_16x16x32_bf16 v[84:87], v[212:215], v[132:135], v[84:87]
    ds_read_b64_tr_b16 v[238:239], v11 offset:22528
    s_waitcnt lgkmcnt(8)
    v_mfma_f32_16x16x32_bf16 v[72:75], v[216:219], v[128:131], v[72:75]
    ds_read_b64_tr_b16 v[208:209], v8 offset:24576
    v_mfma_f32_16x16x32_bf16 v[88:91], v[216:219], v[132:135], v[88:91]
    ds_read_b64_tr_b16 v[210:211], v8 offset:26624
    buffer_load_dwordx4 v[168:171], v2, s[24:27], s78 offen offset:1024 sc1
    v_mfma_f32_16x16x32_bf16 v[76:79], v[220:223], v[128:131], v[76:79]
    ds_read_b64_tr_b16 v[212:213], v9 offset:24576
    v_mfma_f32_16x16x32_bf16 v[92:95], v[220:223], v[132:135], v[92:95]
    ds_read_b64_tr_b16 v[214:215], v9 offset:26624
    s_waitcnt lgkmcnt(8)
    s_waitcnt vmcnt(8)
    v_mfma_f32_16x16x32_bf16 v[64:67], v[224:227], v[136:139], v[64:67]
    ds_read_b64_tr_b16 v[216:217], v10 offset:24576
    v_mfma_f32_16x16x32_bf16 v[80:83], v[224:227], v[140:143], v[80:83]
    ds_read_b64_tr_b16 v[218:219], v10 offset:26624
    buffer_load_dwordx4 v[180:183], v2, s[24:27], s79 offen offset:2048 sc1
    v_mfma_f32_16x16x32_bf16 v[68:71], v[228:231], v[136:139], v[68:71]
    ds_read_b64_tr_b16 v[220:221], v11 offset:24576
    v_mfma_f32_16x16x32_bf16 v[84:87], v[228:231], v[140:143], v[84:87]
    ds_read_b64_tr_b16 v[222:223], v11 offset:26624
    s_waitcnt lgkmcnt(8)
    v_mfma_f32_16x16x32_bf16 v[72:75], v[232:235], v[136:139], v[72:75]
    ds_read_b64_tr_b16 v[224:225], v21 offset:0
    v_mfma_f32_16x16x32_bf16 v[88:91], v[232:235], v[140:143], v[88:91]
    ds_read_b64_tr_b16 v[226:227], v21 offset:2048
    buffer_load_dwordx4 v[176:179], v2, s[24:27], s78 offen offset:2048 sc1
    v_mfma_f32_16x16x32_bf16 v[76:79], v[236:239], v[136:139], v[76:79]
    ds_read_b64_tr_b16 v[228:229], v22 offset:0
    v_mfma_f32_16x16x32_bf16 v[92:95], v[236:239], v[140:143], v[92:95]
    ds_read_b64_tr_b16 v[230:231], v22 offset:2048
    s_waitcnt lgkmcnt(8)
    s_waitcnt vmcnt(8)
    v_mfma_f32_16x16x32_bf16 v[64:67], v[208:211], v[144:147], v[64:67]
    ds_read_b64_tr_b16 v[232:233], v23 offset:0
    v_mfma_f32_16x16x32_bf16 v[80:83], v[208:211], v[148:151], v[80:83]
    ds_read_b64_tr_b16 v[234:235], v23 offset:2048
    buffer_load_dwordx4 v[188:191], v2, s[24:27], s79 offen offset:3072 sc1
    v_mfma_f32_16x16x32_bf16 v[68:71], v[212:215], v[144:147], v[68:71]
    ds_read_b64_tr_b16 v[236:237], v24 offset:0
    v_mfma_f32_16x16x32_bf16 v[84:87], v[212:215], v[148:151], v[84:87]
    ds_read_b64_tr_b16 v[238:239], v24 offset:2048
    s_waitcnt lgkmcnt(8)
    v_mfma_f32_16x16x32_bf16 v[72:75], v[216:219], v[144:147], v[72:75]
    ds_read_b64_tr_b16 v[208:209], v21 offset:4096
    v_mfma_f32_16x16x32_bf16 v[88:91], v[216:219], v[148:151], v[88:91]
    ds_read_b64_tr_b16 v[210:211], v21 offset:6144
    buffer_load_dwordx4 v[184:187], v2, s[24:27], s78 offen offset:3072 sc1
    v_mfma_f32_16x16x32_bf16 v[76:79], v[220:223], v[144:147], v[76:79]
    ds_read_b64_tr_b16 v[212:213], v22 offset:4096
    v_mfma_f32_16x16x32_bf16 v[92:95], v[220:223], v[148:151], v[92:95]
    ds_read_b64_tr_b16 v[214:215], v22 offset:6144
    s_waitcnt lgkmcnt(8)
    s_waitcnt vmcnt(8)
    v_mfma_f32_16x16x32_bf16 v[64:67], v[224:227], v[152:155], v[64:67]
    ds_read_b64_tr_b16 v[216:217], v23 offset:4096
    v_mfma_f32_16x16x32_bf16 v[80:83], v[224:227], v[156:159], v[80:83]
    ds_read_b64_tr_b16 v[218:219], v23 offset:6144
    s_add_u32 s78, s78, 4096
    s_add_u32 s79, s79, 4096
    buffer_load_dwordx4 v[100:103], v2, s[24:27], s79 offen offset:0 sc1
    v_mfma_f32_16x16x32_bf16 v[68:71], v[228:231], v[152:155], v[68:71]
    ds_read_b64_tr_b16 v[220:221], v24 offset:4096
    v_mfma_f32_16x16x32_bf16 v[84:87], v[228:231], v[156:159], v[84:87]
    ds_read_b64_tr_b16 v[222:223], v24 offset:6144
    s_waitcnt lgkmcnt(8)
    v_mfma_f32_16x16x32_bf16 v[72:75], v[232:235], v[152:155], v[72:75]
    ds_read_b64_tr_b16 v[224:225], v21 offset:8192
    v_mfma_f32_16x16x32_bf16 v[88:91], v[232:235], v[156:159], v[88:91]
    ds_read_b64_tr_b16 v[226:227], v21 offset:10240
    buffer_load_dwordx4 v[96:99], v2, s[24:27], s78 offen offset:0 sc1
    v_mfma_f32_16x16x32_bf16 v[76:79], v[236:239], v[152:155], v[76:79]
    ds_read_b64_tr_b16 v[228:229], v22 offset:8192
    v_mfma_f32_16x16x32_bf16 v[92:95], v[236:239], v[156:159], v[92:95]
    ds_read_b64_tr_b16 v[230:231], v22 offset:10240
    s_waitcnt lgkmcnt(8)
    s_waitcnt vmcnt(8)
    v_mfma_f32_16x16x32_bf16 v[64:67], v[208:211], v[160:163], v[64:67]
    ds_read_b64_tr_b16 v[232:233], v23 offset:8192
    v_mfma_f32_16x16x32_bf16 v[80:83], v[208:211], v[164:167], v[80:83]
    ds_read_b64_tr_b16 v[234:235], v23 offset:10240
    buffer_load_dwordx4 v[108:111], v2, s[24:27], s79 offen offset:1024 sc1
    v_mfma_f32_16x16x32_bf16 v[68:71], v[212:215], v[160:163], v[68:71]
    ds_read_b64_tr_b16 v[236:237], v24 offset:8192
    v_mfma_f32_16x16x32_bf16 v[84:87], v[212:215], v[164:167], v[84:87]
    ds_read_b64_tr_b16 v[238:239], v24 offset:10240
    s_waitcnt lgkmcnt(8)
    v_mfma_f32_16x16x32_bf16 v[72:75], v[216:219], v[160:163], v[72:75]
    ds_read_b64_tr_b16 v[208:209], v21 offset:12288
    v_mfma_f32_16x16x32_bf16 v[88:91], v[216:219], v[164:167], v[88:91]
    ds_read_b64_tr_b16 v[210:211], v21 offset:14336
    buffer_load_dwordx4 v[104:107], v2, s[24:27], s78 offen offset:1024 sc1
    v_mfma_f32_16x16x32_bf16 v[76:79], v[220:223], v[160:163], v[76:79]
    ds_read_b64_tr_b16 v[212:213], v22 offset:12288
    v_mfma_f32_16x16x32_bf16 v[92:95], v[220:223], v[164:167], v[92:95]
    ds_read_b64_tr_b16 v[214:215], v22 offset:14336
    s_barrier
    s_waitcnt lgkmcnt(8)
    s_waitcnt vmcnt(8)
    v_mfma_f32_16x16x32_bf16 v[64:67], v[224:227], v[168:171], v[64:67]
    ds_read_b64_tr_b16 v[216:217], v23 offset:12288
    v_mfma_f32_16x16x32_bf16 v[80:83], v[224:227], v[172:175], v[80:83]
    ds_read_b64_tr_b16 v[218:219], v23 offset:14336
    ds_write_b128 v192, a[0:3] offset:0
    buffer_load_dwordx4 v[116:119], v2, s[24:27], s79 offen offset:2048 sc1
    v_mfma_f32_16x16x32_bf16 v[68:71], v[228:231], v[168:171], v[68:71]
    ds_read_b64_tr_b16 v[220:221], v24 offset:12288
    v_mfma_f32_16x16x32_bf16 v[84:87], v[228:231], v[172:175], v[84:87]
    ds_read_b64_tr_b16 v[222:223], v24 offset:14336
    ds_write_b128 v192, a[4:7] offset:4096
    s_waitcnt lgkmcnt(8)
    v_mfma_f32_16x16x32_bf16 v[72:75], v[232:235], v[168:171], v[72:75]
    ds_read_b64_tr_b16 v[224:225], v21 offset:16384
    v_mfma_f32_16x16x32_bf16 v[88:91], v[232:235], v[172:175], v[88:91]
    ds_read_b64_tr_b16 v[226:227], v21 offset:18432
    buffer_load_dwordx4 v[112:115], v2, s[24:27], s78 offen offset:2048 sc1
    v_mfma_f32_16x16x32_bf16 v[76:79], v[236:239], v[168:171], v[76:79]
    ds_read_b64_tr_b16 v[228:229], v22 offset:16384
    v_mfma_f32_16x16x32_bf16 v[92:95], v[236:239], v[172:175], v[92:95]
    ds_read_b64_tr_b16 v[230:231], v22 offset:18432
    ds_write_b128 v192, a[8:11] offset:8192
    s_waitcnt lgkmcnt(8)
    s_waitcnt vmcnt(8)
    v_mfma_f32_16x16x32_bf16 v[64:67], v[208:211], v[176:179], v[64:67]
    ds_read_b64_tr_b16 v[232:233], v23 offset:16384
    v_mfma_f32_16x16x32_bf16 v[80:83], v[208:211], v[180:183], v[80:83]
    ds_read_b64_tr_b16 v[234:235], v23 offset:18432
    ds_write_b128 v192, a[12:15] offset:12288
    buffer_load_dwordx4 v[124:127], v2, s[24:27], s79 offen offset:3072 sc1
    v_mfma_f32_16x16x32_bf16 v[68:71], v[212:215], v[176:179], v[68:71]
    ds_read_b64_tr_b16 v[236:237], v24 offset:16384
    v_mfma_f32_16x16x32_bf16 v[84:87], v[212:215], v[180:183], v[84:87]
    ds_read_b64_tr_b16 v[238:239], v24 offset:18432
    s_waitcnt lgkmcnt(8)
    v_mfma_f32_16x16x32_bf16 v[72:75], v[216:219], v[176:179], v[72:75]
    ds_read_b64_tr_b16 v[208:209], v21 offset:20480
    v_mfma_f32_16x16x32_bf16 v[88:91], v[216:219], v[180:183], v[88:91]
    ds_read_b64_tr_b16 v[210:211], v21 offset:22528
    ds_write_b128 v192, a[16:19] offset:16384
    buffer_load_dwordx4 v[120:123], v2, s[24:27], s78 offen offset:3072 sc1
    v_mfma_f32_16x16x32_bf16 v[76:79], v[220:223], v[176:179], v[76:79]
    ds_read_b64_tr_b16 v[212:213], v22 offset:20480
    v_mfma_f32_16x16x32_bf16 v[92:95], v[220:223], v[180:183], v[92:95]
    ds_read_b64_tr_b16 v[214:215], v22 offset:22528
    ds_write_b128 v192, a[20:23] offset:20480
    s_waitcnt lgkmcnt(8)
    s_waitcnt vmcnt(8)
    v_mfma_f32_16x16x32_bf16 v[64:67], v[224:227], v[184:187], v[64:67]
    ds_read_b64_tr_b16 v[216:217], v23 offset:20480
    v_mfma_f32_16x16x32_bf16 v[80:83], v[224:227], v[188:191], v[80:83]
    ds_read_b64_tr_b16 v[218:219], v23 offset:22528
    s_add_u32 s78, s78, 4096
    s_add_u32 s79, s79, 4096
    buffer_load_dwordx4 v[132:135], v2, s[24:27], s79 offen offset:0 sc1
    v_mfma_f32_16x16x32_bf16 v[68:71], v[228:231], v[184:187], v[68:71]
    ds_read_b64_tr_b16 v[220:221], v24 offset:20480
    v_mfma_f32_16x16x32_bf16 v[84:87], v[228:231], v[188:191], v[84:87]
    ds_read_b64_tr_b16 v[222:223], v24 offset:22528
    ds_write_b128 v192, a[24:27] offset:24576
    s_waitcnt lgkmcnt(8)
    v_mfma_f32_16x16x32_bf16 v[72:75], v[232:235], v[184:187], v[72:75]
    ds_read_b64_tr_b16 v[224:225], v21 offset:24576
    v_mfma_f32_16x16x32_bf16 v[88:91], v[232:235], v[188:191], v[88:91]
    ds_read_b64_tr_b16 v[226:227], v21 offset:26624
    ds_write_b128 v193, a[28:31] offset:0
    buffer_load_dwordx4 v[128:131], v2, s[24:27], s78 offen offset:0 sc1
    v_mfma_f32_16x16x32_bf16 v[76:79], v[236:239], v[184:187], v[76:79]
    ds_read_b64_tr_b16 v[228:229], v22 offset:24576
    v_mfma_f32_16x16x32_bf16 v[92:95], v[236:239], v[188:191], v[92:95]
    ds_read_b64_tr_b16 v[230:231], v22 offset:26624
    s_waitcnt lgkmcnt(8)
    s_waitcnt vmcnt(8)
    v_mfma_f32_16x16x32_bf16 v[64:67], v[208:211], v[96:99], v[64:67]
    ds_read_b64_tr_b16 v[232:233], v23 offset:24576
    v_mfma_f32_16x16x32_bf16 v[80:83], v[208:211], v[100:103], v[80:83]
    ds_read_b64_tr_b16 v[234:235], v23 offset:26624
    ds_write_b128 v193, a[32:35] offset:4096
    buffer_load_dwordx4 v[140:143], v2, s[24:27], s79 offen offset:1024 sc1
    v_mfma_f32_16x16x32_bf16 v[68:71], v[212:215], v[96:99], v[68:71]
    ds_read_b64_tr_b16 v[236:237], v24 offset:24576
    v_mfma_f32_16x16x32_bf16 v[84:87], v[212:215], v[100:103], v[84:87]
    ds_read_b64_tr_b16 v[238:239], v24 offset:26624
    ds_write_b128 v192, a[36:39] offset:28672
    s_waitcnt lgkmcnt(8)
    v_mfma_f32_16x16x32_bf16 v[72:75], v[216:219], v[96:99], v[72:75]
    ds_read_b64_tr_b16 v[208:209], v21 offset:28672
    v_mfma_f32_16x16x32_bf16 v[88:91], v[216:219], v[100:103], v[88:91]
    ds_read_b64_tr_b16 v[210:211], v21 offset:30720
    buffer_load_dwordx4 v[136:139], v2, s[24:27], s78 offen offset:1024 sc1
    v_mfma_f32_16x16x32_bf16 v[76:79], v[220:223], v[96:99], v[76:79]
    ds_read_b64_tr_b16 v[212:213], v22 offset:28672
    v_mfma_f32_16x16x32_bf16 v[92:95], v[220:223], v[100:103], v[92:95]
    ds_read_b64_tr_b16 v[214:215], v22 offset:30720
    ds_write_b128 v192, a[40:43] offset:32768
    s_waitcnt lgkmcnt(8)
    s_waitcnt vmcnt(8)
    v_mfma_f32_16x16x32_bf16 v[64:67], v[224:227], v[104:107], v[64:67]
    ds_read_b64_tr_b16 v[216:217], v23 offset:28672
    v_mfma_f32_16x16x32_bf16 v[80:83], v[224:227], v[108:111], v[80:83]
    ds_read_b64_tr_b16 v[218:219], v23 offset:30720
    ds_write_b128 v192, a[44:47] offset:36864
    buffer_load_dwordx4 v[148:151], v2, s[24:27], s79 offen offset:2048 sc1
    v_mfma_f32_16x16x32_bf16 v[68:71], v[228:231], v[104:107], v[68:71]
    ds_read_b64_tr_b16 v[220:221], v24 offset:28672
    v_mfma_f32_16x16x32_bf16 v[84:87], v[228:231], v[108:111], v[84:87]
    ds_read_b64_tr_b16 v[222:223], v24 offset:30720
    s_waitcnt lgkmcnt(8)
    v_mfma_f32_16x16x32_bf16 v[72:75], v[232:235], v[104:107], v[72:75]
    ds_read_b64_tr_b16 v[224:225], v21 offset:32768
    v_mfma_f32_16x16x32_bf16 v[88:91], v[232:235], v[108:111], v[88:91]
    ds_read_b64_tr_b16 v[226:227], v21 offset:34816
    ds_write_b128 v192, a[48:51] offset:40960
    buffer_load_dwordx4 v[144:147], v2, s[24:27], s78 offen offset:2048 sc1
    v_mfma_f32_16x16x32_bf16 v[76:79], v[236:239], v[104:107], v[76:79]
    ds_read_b64_tr_b16 v[228:229], v22 offset:32768
    v_mfma_f32_16x16x32_bf16 v[92:95], v[236:239], v[108:111], v[92:95]
    ds_read_b64_tr_b16 v[230:231], v22 offset:34816
    ds_write_b128 v192, a[52:55] offset:45056
    s_waitcnt lgkmcnt(8)
    s_waitcnt vmcnt(8)
    v_mfma_f32_16x16x32_bf16 v[64:67], v[208:211], v[112:115], v[64:67]
    ds_read_b64_tr_b16 v[232:233], v23 offset:32768
    v_mfma_f32_16x16x32_bf16 v[80:83], v[208:211], v[116:119], v[80:83]
    ds_read_b64_tr_b16 v[234:235], v23 offset:34816
    buffer_load_dwordx4 v[156:159], v2, s[24:27], s79 offen offset:3072 sc1
    v_mfma_f32_16x16x32_bf16 v[68:71], v[212:215], v[112:115], v[68:71]
    ds_read_b64_tr_b16 v[236:237], v24 offset:32768
    v_mfma_f32_16x16x32_bf16 v[84:87], v[212:215], v[116:119], v[84:87]
    ds_read_b64_tr_b16 v[238:239], v24 offset:34816
    ds_write_b128 v192, a[56:59] offset:49152
    s_waitcnt lgkmcnt(8)
    v_mfma_f32_16x16x32_bf16 v[72:75], v[216:219], v[112:115], v[72:75]
    ds_read_b64_tr_b16 v[208:209], v21 offset:36864
    v_mfma_f32_16x16x32_bf16 v[88:91], v[216:219], v[116:119], v[88:91]
    ds_read_b64_tr_b16 v[210:211], v21 offset:38912
    ds_write_b128 v192, a[60:63] offset:53248
    buffer_load_dwordx4 v[152:155], v2, s[24:27], s78 offen offset:3072 sc1
    v_mfma_f32_16x16x32_bf16 v[76:79], v[220:223], v[112:115], v[76:79]
    ds_read_b64_tr_b16 v[212:213], v22 offset:36864
    v_mfma_f32_16x16x32_bf16 v[92:95], v[220:223], v[116:119], v[92:95]
    ds_read_b64_tr_b16 v[214:215], v22 offset:38912
    s_waitcnt lgkmcnt(8)
    s_waitcnt vmcnt(8)
    v_mfma_f32_16x16x32_bf16 v[64:67], v[224:227], v[120:123], v[64:67]
    ds_read_b64_tr_b16 v[216:217], v23 offset:36864
    v_mfma_f32_16x16x32_bf16 v[80:83], v[224:227], v[124:127], v[80:83]
    ds_read_b64_tr_b16 v[218:219], v23 offset:38912
    ds_write_b128 v193, a[64:67] offset:49152
    s_add_u32 s78, s78, 4096
    s_add_u32 s79, s79, 4096
    buffer_load_dwordx4 v[164:167], v2, s[24:27], s79 offen offset:0 sc1
    v_mfma_f32_16x16x32_bf16 v[68:71], v[228:231], v[120:123], v[68:71]
    ds_read_b64_tr_b16 v[220:221], v24 offset:36864
    v_mfma_f32_16x16x32_bf16 v[84:87], v[228:231], v[124:127], v[84:87]
    ds_read_b64_tr_b16 v[222:223], v24 offset:38912
    ds_write_b128 v193, a[68:71] offset:53248
    s_waitcnt lgkmcnt(8)
    v_mfma_f32_16x16x32_bf16 v[72:75], v[232:235], v[120:123], v[72:75]
    ds_read_b64_tr_b16 v[224:225], v21 offset:40960
    v_mfma_f32_16x16x32_bf16 v[88:91], v[232:235], v[124:127], v[88:91]
    ds_read_b64_tr_b16 v[226:227], v21 offset:43008
    buffer_load_dwordx4 v[160:163], v2, s[24:27], s78 offen offset:0 sc1
    v_mfma_f32_16x16x32_bf16 v[76:79], v[236:239], v[120:123], v[76:79]
    ds_read_b64_tr_b16 v[228:229], v22 offset:40960
    v_mfma_f32_16x16x32_bf16 v[92:95], v[236:239], v[124:127], v[92:95]
    ds_read_b64_tr_b16 v[230:231], v22 offset:43008
    s_waitcnt lgkmcnt(8)
    s_waitcnt vmcnt(8)
    v_mfma_f32_16x16x32_bf16 v[64:67], v[208:211], v[128:131], v[64:67]
    ds_read_b64_tr_b16 v[232:233], v23 offset:40960
    v_mfma_f32_16x16x32_bf16 v[80:83], v[208:211], v[132:135], v[80:83]
    ds_read_b64_tr_b16 v[234:235], v23 offset:43008
    buffer_load_dwordx4 v[172:175], v2, s[24:27], s79 offen offset:1024 sc1
    v_mfma_f32_16x16x32_bf16 v[68:71], v[212:215], v[128:131], v[68:71]
    ds_read_b64_tr_b16 v[236:237], v24 offset:40960
    v_mfma_f32_16x16x32_bf16 v[84:87], v[212:215], v[132:135], v[84:87]
    ds_read_b64_tr_b16 v[238:239], v24 offset:43008
    s_waitcnt lgkmcnt(8)
    v_mfma_f32_16x16x32_bf16 v[72:75], v[216:219], v[128:131], v[72:75]
    ds_read_b64_tr_b16 v[208:209], v21 offset:45056
    v_mfma_f32_16x16x32_bf16 v[88:91], v[216:219], v[132:135], v[88:91]
    ds_read_b64_tr_b16 v[210:211], v21 offset:47104
    buffer_load_dwordx4 v[168:171], v2, s[24:27], s78 offen offset:1024 sc1
    v_mfma_f32_16x16x32_bf16 v[76:79], v[220:223], v[128:131], v[76:79]
    ds_read_b64_tr_b16 v[212:213], v22 offset:45056
    v_mfma_f32_16x16x32_bf16 v[92:95], v[220:223], v[132:135], v[92:95]
    ds_read_b64_tr_b16 v[214:215], v22 offset:47104
    s_waitcnt lgkmcnt(8)
    s_waitcnt vmcnt(8)
    v_mfma_f32_16x16x32_bf16 v[64:67], v[224:227], v[136:139], v[64:67]
    ds_read_b64_tr_b16 v[216:217], v23 offset:45056
    v_mfma_f32_16x16x32_bf16 v[80:83], v[224:227], v[140:143], v[80:83]
    ds_read_b64_tr_b16 v[218:219], v23 offset:47104
    buffer_load_dwordx4 v[180:183], v2, s[24:27], s79 offen offset:2048 sc1
    v_mfma_f32_16x16x32_bf16 v[68:71], v[228:231], v[136:139], v[68:71]
    ds_read_b64_tr_b16 v[220:221], v24 offset:45056
    v_mfma_f32_16x16x32_bf16 v[84:87], v[228:231], v[140:143], v[84:87]
    ds_read_b64_tr_b16 v[222:223], v24 offset:47104
    s_waitcnt lgkmcnt(12)
    s_barrier
    s_waitcnt lgkmcnt(8)
    v_mfma_f32_16x16x32_bf16 v[72:75], v[232:235], v[136:139], v[72:75]
    ds_read_b64_tr_b16 v[224:225], v8 offset:0
    v_mfma_f32_16x16x32_bf16 v[88:91], v[232:235], v[140:143], v[88:91]
    ds_read_b64_tr_b16 v[226:227], v8 offset:2048
    buffer_load_dwordx4 v[176:179], v2, s[24:27], s78 offen offset:2048 sc1
    v_mfma_f32_16x16x32_bf16 v[76:79], v[236:239], v[136:139], v[76:79]
    ds_read_b64_tr_b16 v[228:229], v9 offset:0
    v_mfma_f32_16x16x32_bf16 v[92:95], v[236:239], v[140:143], v[92:95]
    ds_read_b64_tr_b16 v[230:231], v9 offset:2048
    s_waitcnt lgkmcnt(8)
    s_waitcnt vmcnt(8)
    v_mfma_f32_16x16x32_bf16 v[64:67], v[208:211], v[144:147], v[64:67]
    ds_read_b64_tr_b16 v[232:233], v10 offset:0
    v_mfma_f32_16x16x32_bf16 v[80:83], v[208:211], v[148:151], v[80:83]
    ds_read_b64_tr_b16 v[234:235], v10 offset:2048
    buffer_load_dwordx4 v[188:191], v2, s[24:27], s79 offen offset:3072 sc1
    v_mfma_f32_16x16x32_bf16 v[68:71], v[212:215], v[144:147], v[68:71]
    ds_read_b64_tr_b16 v[236:237], v11 offset:0
    v_mfma_f32_16x16x32_bf16 v[84:87], v[212:215], v[148:151], v[84:87]
    ds_read_b64_tr_b16 v[238:239], v11 offset:2048
    s_waitcnt lgkmcnt(8)
    v_mfma_f32_16x16x32_bf16 v[72:75], v[216:219], v[144:147], v[72:75]
    ds_read_b64_tr_b16 v[208:209], v8 offset:4096
    v_mfma_f32_16x16x32_bf16 v[88:91], v[216:219], v[148:151], v[88:91]
    ds_read_b64_tr_b16 v[210:211], v8 offset:6144
    buffer_load_dwordx4 v[184:187], v2, s[24:27], s78 offen offset:3072 sc1
    v_mfma_f32_16x16x32_bf16 v[76:79], v[220:223], v[144:147], v[76:79]
    ds_read_b64_tr_b16 v[212:213], v9 offset:4096
    v_mfma_f32_16x16x32_bf16 v[92:95], v[220:223], v[148:151], v[92:95]
    ds_read_b64_tr_b16 v[214:215], v9 offset:6144
    s_waitcnt lgkmcnt(8)
    s_waitcnt vmcnt(8)
    v_mfma_f32_16x16x32_bf16 v[64:67], v[224:227], v[152:155], v[64:67]
    ds_read_b64_tr_b16 v[216:217], v10 offset:4096
    v_mfma_f32_16x16x32_bf16 v[80:83], v[224:227], v[156:159], v[80:83]
    ds_read_b64_tr_b16 v[218:219], v10 offset:6144
    s_add_u32 s78, s78, 4096
    s_add_u32 s79, s79, 4096
    buffer_load_dwordx4 v[100:103], v2, s[24:27], s79 offen offset:0 sc1
    v_mfma_f32_16x16x32_bf16 v[68:71], v[228:231], v[152:155], v[68:71]
    ds_read_b64_tr_b16 v[220:221], v11 offset:4096
    v_mfma_f32_16x16x32_bf16 v[84:87], v[228:231], v[156:159], v[84:87]
    ds_read_b64_tr_b16 v[222:223], v11 offset:6144
    s_waitcnt lgkmcnt(8)
    v_mfma_f32_16x16x32_bf16 v[72:75], v[232:235], v[152:155], v[72:75]
    ds_read_b64_tr_b16 v[224:225], v8 offset:8192
    v_mfma_f32_16x16x32_bf16 v[88:91], v[232:235], v[156:159], v[88:91]
    ds_read_b64_tr_b16 v[226:227], v8 offset:10240
    buffer_load_dwordx4 v[96:99], v2, s[24:27], s78 offen offset:0 sc1
    v_mfma_f32_16x16x32_bf16 v[76:79], v[236:239], v[152:155], v[76:79]
    ds_read_b64_tr_b16 v[228:229], v9 offset:8192
    v_mfma_f32_16x16x32_bf16 v[92:95], v[236:239], v[156:159], v[92:95]
    ds_read_b64_tr_b16 v[230:231], v9 offset:10240
    s_waitcnt lgkmcnt(8)
    s_waitcnt vmcnt(8)
    v_mfma_f32_16x16x32_bf16 v[64:67], v[208:211], v[160:163], v[64:67]
    ds_read_b64_tr_b16 v[232:233], v10 offset:8192
    v_mfma_f32_16x16x32_bf16 v[80:83], v[208:211], v[164:167], v[80:83]
    ds_read_b64_tr_b16 v[234:235], v10 offset:10240
    buffer_load_dwordx4 v[108:111], v2, s[24:27], s79 offen offset:1024 sc1
    v_mfma_f32_16x16x32_bf16 v[68:71], v[212:215], v[160:163], v[68:71]
    ds_read_b64_tr_b16 v[236:237], v11 offset:8192
    v_mfma_f32_16x16x32_bf16 v[84:87], v[212:215], v[164:167], v[84:87]
    ds_read_b64_tr_b16 v[238:239], v11 offset:10240
    s_waitcnt lgkmcnt(8)
    v_mfma_f32_16x16x32_bf16 v[72:75], v[216:219], v[160:163], v[72:75]
    ds_read_b64_tr_b16 v[208:209], v8 offset:12288
    v_mfma_f32_16x16x32_bf16 v[88:91], v[216:219], v[164:167], v[88:91]
    ds_read_b64_tr_b16 v[210:211], v8 offset:14336
    buffer_load_dwordx4 v[104:107], v2, s[24:27], s78 offen offset:1024 sc1
    v_mfma_f32_16x16x32_bf16 v[76:79], v[220:223], v[160:163], v[76:79]
    ds_read_b64_tr_b16 v[212:213], v9 offset:12288
    v_mfma_f32_16x16x32_bf16 v[92:95], v[220:223], v[164:167], v[92:95]
    ds_read_b64_tr_b16 v[214:215], v9 offset:14336
    s_waitcnt lgkmcnt(8)
    s_waitcnt vmcnt(8)
    v_mfma_f32_16x16x32_bf16 v[64:67], v[224:227], v[168:171], v[64:67]
    ds_read_b64_tr_b16 v[216:217], v10 offset:12288
    v_mfma_f32_16x16x32_bf16 v[80:83], v[224:227], v[172:175], v[80:83]
    ds_read_b64_tr_b16 v[218:219], v10 offset:14336
    buffer_load_dwordx4 v[116:119], v2, s[24:27], s79 offen offset:2048 sc1
    v_mfma_f32_16x16x32_bf16 v[68:71], v[228:231], v[168:171], v[68:71]
    ds_read_b64_tr_b16 v[220:221], v11 offset:12288
    v_mfma_f32_16x16x32_bf16 v[84:87], v[228:231], v[172:175], v[84:87]
    ds_read_b64_tr_b16 v[222:223], v11 offset:14336
    s_waitcnt lgkmcnt(8)
    v_mfma_f32_16x16x32_bf16 v[72:75], v[232:235], v[168:171], v[72:75]
    ds_read_b64_tr_b16 v[224:225], v8 offset:16384
    v_mfma_f32_16x16x32_bf16 v[88:91], v[232:235], v[172:175], v[88:91]
    ds_read_b64_tr_b16 v[226:227], v8 offset:18432
    buffer_load_dwordx4 v[112:115], v2, s[24:27], s78 offen offset:2048 sc1
    v_mfma_f32_16x16x32_bf16 v[76:79], v[236:239], v[168:171], v[76:79]
    ds_read_b64_tr_b16 v[228:229], v9 offset:16384
    v_mfma_f32_16x16x32_bf16 v[92:95], v[236:239], v[172:175], v[92:95]
    ds_read_b64_tr_b16 v[230:231], v9 offset:18432
    s_waitcnt lgkmcnt(8)
    s_waitcnt vmcnt(8)
    v_mfma_f32_16x16x32_bf16 v[64:67], v[208:211], v[176:179], v[64:67]
    ds_read_b64_tr_b16 v[232:233], v10 offset:16384
    v_mfma_f32_16x16x32_bf16 v[80:83], v[208:211], v[180:183], v[80:83]
    ds_read_b64_tr_b16 v[234:235], v10 offset:18432
    buffer_load_dwordx4 v[124:127], v2, s[24:27], s79 offen offset:3072 sc1
    v_mfma_f32_16x16x32_bf16 v[68:71], v[212:215], v[176:179], v[68:71]
    ds_read_b64_tr_b16 v[236:237], v11 offset:16384
    v_mfma_f32_16x16x32_bf16 v[84:87], v[212:215], v[180:183], v[84:87]
    ds_read_b64_tr_b16 v[238:239], v11 offset:18432
    s_waitcnt lgkmcnt(8)
    v_mfma_f32_16x16x32_bf16 v[72:75], v[216:219], v[176:179], v[72:75]
    ds_read_b64_tr_b16 v[208:209], v8 offset:20480
    v_mfma_f32_16x16x32_bf16 v[88:91], v[216:219], v[180:183], v[88:91]
    ds_read_b64_tr_b16 v[210:211], v8 offset:22528
    buffer_load_dwordx4 v[120:123], v2, s[24:27], s78 offen offset:3072 sc1
    v_mfma_f32_16x16x32_bf16 v[76:79], v[220:223], v[176:179], v[76:79]
    ds_read_b64_tr_b16 v[212:213], v9 offset:20480
    v_mfma_f32_16x16x32_bf16 v[92:95], v[220:223], v[180:183], v[92:95]
    ds_read_b64_tr_b16 v[214:215], v9 offset:22528
    s_waitcnt lgkmcnt(8)
    s_waitcnt vmcnt(8)
    v_mfma_f32_16x16x32_bf16 v[64:67], v[224:227], v[184:187], v[64:67]
    ds_read_b64_tr_b16 v[216:217], v10 offset:20480
    v_mfma_f32_16x16x32_bf16 v[80:83], v[224:227], v[188:191], v[80:83]
    ds_read_b64_tr_b16 v[218:219], v10 offset:22528
    buffer_load_dwordx4 v[200:203], v2, s[24:27], s72 offen offset:0 sc1
    v_mfma_f32_16x16x32_bf16 v[68:71], v[228:231], v[184:187], v[68:71]
    ds_read_b64_tr_b16 v[220:221], v11 offset:20480
    v_mfma_f32_16x16x32_bf16 v[84:87], v[228:231], v[188:191], v[84:87]
    ds_read_b64_tr_b16 v[222:223], v11 offset:22528
    s_waitcnt lgkmcnt(8)
    v_mfma_f32_16x16x32_bf16 v[72:75], v[232:235], v[184:187], v[72:75]
    ds_read_b64_tr_b16 v[224:225], v8 offset:24576
    v_mfma_f32_16x16x32_bf16 v[88:91], v[232:235], v[188:191], v[88:91]
    ds_read_b64_tr_b16 v[226:227], v8 offset:26624
    buffer_load_dwordx4 v[204:207], v2, s[24:27], s72 offen offset:1024 sc1
    v_mfma_f32_16x16x32_bf16 v[76:79], v[236:239], v[184:187], v[76:79]
    ds_read_b64_tr_b16 v[228:229], v9 offset:24576
    v_mfma_f32_16x16x32_bf16 v[92:95], v[236:239], v[188:191], v[92:95]
    ds_read_b64_tr_b16 v[230:231], v9 offset:26624
    s_waitcnt lgkmcnt(8)
    s_waitcnt vmcnt(8)
    v_mfma_f32_16x16x32_bf16 v[64:67], v[208:211], v[96:99], v[64:67]
    ds_read_b64_tr_b16 v[232:233], v10 offset:24576
    v_mfma_f32_16x16x32_bf16 v[80:83], v[208:211], v[100:103], v[80:83]
    ds_read_b64_tr_b16 v[234:235], v10 offset:26624
    v_mfma_f32_16x16x32_bf16 v[68:71], v[212:215], v[96:99], v[68:71]
    ds_read_b64_tr_b16 v[236:237], v11 offset:24576
    v_mfma_f32_16x16x32_bf16 v[84:87], v[212:215], v[100:103], v[84:87]
    ds_read_b64_tr_b16 v[238:239], v11 offset:26624
    s_waitcnt lgkmcnt(8)
    v_mfma_f32_16x16x32_bf16 v[72:75], v[216:219], v[96:99], v[72:75]
    ds_read_b64_tr_b16 v[208:209], v21 offset:0
    v_mfma_f32_16x16x32_bf16 v[88:91], v[216:219], v[100:103], v[88:91]
    ds_read_b64_tr_b16 v[210:211], v21 offset:2048
    v_mfma_f32_16x16x32_bf16 v[76:79], v[220:223], v[96:99], v[76:79]
    ds_read_b64_tr_b16 v[212:213], v22 offset:0
    v_mfma_f32_16x16x32_bf16 v[92:95], v[220:223], v[100:103], v[92:95]
    ds_read_b64_tr_b16 v[214:215], v22 offset:2048
    s_waitcnt lgkmcnt(8)
    s_waitcnt vmcnt(6)
    v_mfma_f32_16x16x32_bf16 v[64:67], v[224:227], v[104:107], v[64:67]
    ds_read_b64_tr_b16 v[216:217], v23 offset:0
    v_mfma_f32_16x16x32_bf16 v[80:83], v[224:227], v[108:111], v[80:83]
    ds_read_b64_tr_b16 v[218:219], v23 offset:2048
    v_mfma_f32_16x16x32_bf16 v[68:71], v[228:231], v[104:107], v[68:71]
    ds_read_b64_tr_b16 v[220:221], v24 offset:0
    v_mfma_f32_16x16x32_bf16 v[84:87], v[228:231], v[108:111], v[84:87]
    ds_read_b64_tr_b16 v[222:223], v24 offset:2048
    s_waitcnt lgkmcnt(8)
    v_mfma_f32_16x16x32_bf16 v[72:75], v[232:235], v[104:107], v[72:75]
    ds_read_b64_tr_b16 v[224:225], v21 offset:4096
    v_mfma_f32_16x16x32_bf16 v[88:91], v[232:235], v[108:111], v[88:91]
    ds_read_b64_tr_b16 v[226:227], v21 offset:6144
    v_mfma_f32_16x16x32_bf16 v[76:79], v[236:239], v[104:107], v[76:79]
    ds_read_b64_tr_b16 v[228:229], v22 offset:4096
    v_mfma_f32_16x16x32_bf16 v[92:95], v[236:239], v[108:111], v[92:95]
    ds_read_b64_tr_b16 v[230:231], v22 offset:6144
    s_waitcnt lgkmcnt(8)
    s_waitcnt vmcnt(4)
    v_mfma_f32_16x16x32_bf16 v[64:67], v[208:211], v[112:115], v[64:67]
    ds_read_b64_tr_b16 v[232:233], v23 offset:4096
    v_mfma_f32_16x16x32_bf16 v[80:83], v[208:211], v[116:119], v[80:83]
    ds_read_b64_tr_b16 v[234:235], v23 offset:6144
    v_mfma_f32_16x16x32_bf16 v[68:71], v[212:215], v[112:115], v[68:71]
    ds_read_b64_tr_b16 v[236:237], v24 offset:4096
    v_mfma_f32_16x16x32_bf16 v[84:87], v[212:215], v[116:119], v[84:87]
    ds_read_b64_tr_b16 v[238:239], v24 offset:6144
    s_waitcnt lgkmcnt(8)
    v_mfma_f32_16x16x32_bf16 v[72:75], v[216:219], v[112:115], v[72:75]
    v_mfma_f32_16x16x32_bf16 v[88:91], v[216:219], v[116:119], v[88:91]
    v_mfma_f32_16x16x32_bf16 v[76:79], v[220:223], v[112:115], v[76:79]
    v_mfma_f32_16x16x32_bf16 v[92:95], v[220:223], v[116:119], v[92:95]
    s_waitcnt lgkmcnt(4)
    s_waitcnt vmcnt(2)
    v_mfma_f32_16x16x32_bf16 v[64:67], v[224:227], v[120:123], v[64:67]
    v_mfma_f32_16x16x32_bf16 v[80:83], v[224:227], v[124:127], v[80:83]
    v_mfma_f32_16x16x32_bf16 v[68:71], v[228:231], v[120:123], v[68:71]
    v_mfma_f32_16x16x32_bf16 v[84:87], v[228:231], v[124:127], v[84:87]
    s_waitcnt lgkmcnt(0)
    v_mfma_f32_16x16x32_bf16 v[72:75], v[232:235], v[120:123], v[72:75]
    v_mfma_f32_16x16x32_bf16 v[88:91], v[232:235], v[124:127], v[88:91]
    v_mfma_f32_16x16x32_bf16 v[76:79], v[236:239], v[120:123], v[76:79]
    v_mfma_f32_16x16x32_bf16 v[92:95], v[236:239], v[124:127], v[92:95]
    s_barrier
    ds_write_b128 v49, v[80:83] offset:0
    s_nop 0
    ds_write_b128 v49, v[84:87] offset:1024
    s_nop 1
    ds_write_b128 v49, v[88:91] offset:2048
    s_nop 0
    ds_write_b128 v49, v[92:95] offset:3072
    s_waitcnt vmcnt(1)
    v_lshlrev_b32 v160, 16, v200
    v_and_b32 v161, 0xffff0000, v200
    v_lshlrev_b32 v162, 16, v201
    v_and_b32 v163, 0xffff0000, v201
    v_lshlrev_b32 v164, 16, v202
    v_and_b32 v165, 0xffff0000, v202
    v_lshlrev_b32 v166, 16, v203
    v_and_b32 v167, 0xffff0000, v203
    s_waitcnt vmcnt(0)
    v_lshlrev_b32 v168, 16, v204
    v_and_b32 v169, 0xffff0000, v204
    v_lshlrev_b32 v170, 16, v205
    v_and_b32 v171, 0xffff0000, v205
    v_lshlrev_b32 v172, 16, v206
    v_and_b32 v173, 0xffff0000, v206
    v_lshlrev_b32 v174, 16, v207
    v_and_b32 v175, 0xffff0000, v207
    ds_read_b128 v[144:147], v53 offset:1280
    ds_read_b128 v[148:151], v53 offset:1344
    ds_read_b128 v[152:155], v53 offset:1408
    ds_read_b128 v[156:159], v53 offset:1472
    v_pk_add_f32 v[64:65], v[64:65], v[160:161]
    v_pk_add_f32 v[66:67], v[66:67], v[162:163]
    v_pk_add_f32 v[68:69], v[68:69], v[164:165]
    v_pk_add_f32 v[70:71], v[70:71], v[166:167]
    v_pk_add_f32 v[72:73], v[72:73], v[168:169]
    v_pk_add_f32 v[74:75], v[74:75], v[170:171]
    v_pk_add_f32 v[76:77], v[76:77], v[172:173]
    v_pk_add_f32 v[78:79], v[78:79], v[174:175]
    s_waitcnt lgkmcnt(3)
    v_pk_add_f32 v[64:65], v[64:65], v[144:145]
    v_pk_add_f32 v[66:67], v[66:67], v[146:147]
    s_waitcnt lgkmcnt(2)
    v_pk_add_f32 v[68:69], v[68:69], v[148:149]
    v_pk_add_f32 v[70:71], v[70:71], v[150:151]
    s_waitcnt lgkmcnt(1)
    v_pk_add_f32 v[72:73], v[72:73], v[152:153]
    v_pk_add_f32 v[74:75], v[74:75], v[154:155]
    s_waitcnt lgkmcnt(0)
    v_pk_add_f32 v[76:77], v[76:77], v[156:157]
    v_pk_add_f32 v[78:79], v[78:79], v[158:159]
    s_waitcnt lgkmcnt(0)
    s_barrier
    ds_read_b128 v[128:131], v50 offset:0
    ds_read_b128 v[132:135], v50 offset:1024
    ds_read_b128 v[136:139], v50 offset:2048
    ds_read_b128 v[140:143], v50 offset:3072
    v_and_b32 v190, 15, v57
    v_lshlrev_b32 v190, 6, v190
    s_waitcnt lgkmcnt(3)
    v_pk_add_f32 v[64:65], v[64:65], v[128:129]
    v_pk_add_f32 v[66:67], v[66:67], v[130:131]
    s_waitcnt lgkmcnt(2)
    v_pk_add_f32 v[68:69], v[68:69], v[132:133]
    v_pk_add_f32 v[70:71], v[70:71], v[134:135]
    s_waitcnt lgkmcnt(1)
    v_pk_add_f32 v[72:73], v[72:73], v[136:137]
    v_pk_add_f32 v[74:75], v[74:75], v[138:139]
    s_waitcnt lgkmcnt(0)
    v_pk_add_f32 v[76:77], v[76:77], v[140:141]
    v_pk_add_f32 v[78:79], v[78:79], v[142:143]
    v_cvt_pk_bf16_f32 v176, v64, v65
    v_cvt_pk_bf16_f32 v177, v66, v67
    v_cvt_pk_bf16_f32 v178, v68, v69
    v_cvt_pk_bf16_f32 v179, v70, v71
    v_cvt_pk_bf16_f32 v180, v72, v73
    v_cvt_pk_bf16_f32 v181, v74, v75
    v_cvt_pk_bf16_f32 v182, v76, v77
    v_cvt_pk_bf16_f32 v183, v78, v79
    s_lshl_b32 s87, s47, 7
    v_lshrrev_b32 v186, 4, v57
    v_lshlrev_b32 v187, 3, v186
    v_sub_u32 v187, v51, v187
    v_and_b32 v188, 1, v186
    v_lshl_add_u32 v187, v188, 5, v187
    v_lshrrev_b32 v186, 1, v186
    v_lshl_add_u32 v187, v186, 4, v187
    v_permlane16_swap_b32 v176, v178
    v_permlane16_swap_b32 v177, v179
    v_permlane16_swap_b32 v180, v182
    v_permlane16_swap_b32 v181, v183
    buffer_store_dwordx4 v[176:179], v187, s[28:31], s87 offen offset:0
    buffer_store_dwordx4 v[180:183], v187, s[28:31], s87 offen offset:64
L_w2_idle_98:
L_end:
    s_endpgm
.section .rodata,"a"
.p2align 6
.amdhsa_kernel interleave_layers__sliding_local_dilated__mixer_channel_mlp__prompt_kernel
  .amdhsa_next_free_vgpr 512
  .amdhsa_next_free_sgpr 102
  .amdhsa_accum_offset 256
  .amdhsa_group_segment_fixed_size 0
  .amdhsa_kernarg_size 88
  .amdhsa_user_sgpr_count 2
  .amdhsa_user_sgpr_kernarg_segment_ptr 1
  .amdhsa_system_sgpr_workgroup_id_x 1
.end_amdhsa_kernel
```
